```python
import torch

def _softmax(x, axis=-1):
    return torch.softmax(x, dim=axis)

def _gelu(x):
    return torch.nn.functional.gelu(x, approximate='tanh')

def _silu(x):
    return torch.nn.functional.silu(x)

def _sigmoid(x):
    return torch.sigmoid(x)

def _layernorm(x, axis=-1, eps=1e-05):
    m = x.mean(dim=axis, keepdim=True)
    v = x.var(dim=axis, keepdim=True, unbiased=False)
    return (x - m) / torch.sqrt(v + eps)

def _scatter_add(tgt, idx, src, axis=0):
    return tgt.clone().index_add_(axis, idx, src)

def _segment_sum(src, seg, n):
    out = torch.zeros((n,) + src.shape[1:], dtype=src.dtype)
    return out.index_add_(0, seg, src)

def _pad(x, pw):
    flat = tuple((v for pair in reversed(pw) for v in pair))
    return torch.nn.functional.pad(x, flat)
kernel_name = 'standalone__tree_speculative_verify_tree_attention_over_candidate_token_tree__prompt'

def setup_inputs():

    _w = lambda a: (lambda t: t.to(torch.bfloat16) if t.is_floating_point() else t)(torch.as_tensor(a))
    B, Hq, Hkv, T, C, D = (1, 32, 16, 2048, 2048, 128)
    tree_mask = torch.zeros((B, T, T), dtype=float)
    for b in range(B):
        parent = torch.zeros(T, dtype=torch.int64)
        for i in range(1, T):
            parent[i] = int(torch.randint(0, i, (1,)).item())
        for i in range(T):
            j = i
            tree_mask[b, i, j] = 1.0
            while j > 0:
                j = parent[j]
                tree_mask[b, i, j] = 1.0
    return {'q': _w((lambda *s: torch.randn(*s, dtype=torch.bfloat16) * 0.8)(B, Hq, T, D)), 'k_cache': _w((lambda *s: torch.randn(*s, dtype=torch.bfloat16) * 0.8)(B, Hkv, C, D)), 'v_cache': _w((lambda *s: torch.randn(*s, dtype=torch.bfloat16) * 0.05)(B, Hkv, C, D)), 'k_tree': _w((lambda *s: torch.randn(*s, dtype=torch.bfloat16) * 0.8)(B, Hkv, T, D)), 'v_tree': _w((lambda *s: torch.randn(*s, dtype=torch.bfloat16) * 0.05)(B, Hkv, T, D)), 'tree_mask': _w(tree_mask)}

def reference(q, k_cache, v_cache, k_tree, v_tree, tree_mask):
    B, Hq, T, D = q.shape
    Hkv, C = (k_cache.shape[1], k_cache.shape[2])
    rep = Hq // Hkv
    kc = (lambda x, n, axis: torch.repeat_interleave(x, n, dim=axis))(k_cache, rep, axis=1)
    vc = (lambda x, n, axis: torch.repeat_interleave(x, n, dim=axis))(v_cache, rep, axis=1)
    kt = (lambda x, n, axis: torch.repeat_interleave(x, n, dim=axis))(k_tree, rep, axis=1)
    vt = (lambda x, n, axis: torch.repeat_interleave(x, n, dim=axis))(v_tree, rep, axis=1)
    k = torch.concatenate([kc, kt], axis=2)
    v = torch.concatenate([vc, vt], axis=2)
    scale = D ** (-0.5)
    scores = torch.einsum('bhqd,bhkd->bhqk', q, k) * scale
    ctx_mask = torch.ones((B, 1, T, C), dtype=scores.dtype)
    tm = tree_mask[:, None, :, :].clone()
    full_mask = torch.concatenate([ctx_mask, tm], axis=-1)
    scores = scores + (1.0 - full_mask) * -1000000000.0
    p = _softmax(scores, axis=-1)
    return torch.einsum('bhqk,bhkd->bhqd', p, v)
```

```asm
; @launch grid=(256,1,1) block=(256,1,1) lds=163840
.amdgcn_target "amdgcn-amd-amdhsa--gfx950"
.text
.globl standalone__tree_speculative_verify_tree_attention_over_candidate_token_tree__prompt_kernel
.p2align 8
.type standalone__tree_speculative_verify_tree_attention_over_candidate_token_tree__prompt_kernel,@function
standalone__tree_speculative_verify_tree_attention_over_candidate_token_tree__prompt_kernel:
  s_cmp_ge_u32 s2, 256
  s_cbranch_scc1 L_end
  s_getpc_b64 s[100:101]
L_pc0:
  v_lshlrev_b32 v2, 7, v0
  v_min_u32 v3, L_code_end - L_pc0 - 4, v2
  v_add_u32 v2, 0x8000, v2
  v_min_u32 v2, L_code_end - L_pc0 - 4, v2
  global_load_dword v13, v3, s[100:101]
  global_load_dword v12, v2, s[100:101]
  s_load_dwordx8 s[48:55], s[0:1], 0
  s_load_dwordx4 s[56:59], s[0:1], 32
  s_load_dwordx2 s[60:61], s[0:1], 48
  s_load_dwordx4 s[92:95], s[0:1], 56
  v_and_b32 v1, 63, v0
  v_lshrrev_b32 v2, 6, v0
  s_and_b32 s96, s2, 7
  v_readfirstlane_b32 s40, v2
  s_lshl_b32 s96, s96, 1
  s_bfe_u32 s97, s2, 0x10003
  s_or_b32 s96, s96, s97
  s_lshr_b32 s65, s2, 4
  s_lshl_b32 s98, s96, 19
  s_lshl_b32 s99, s96, 20
  s_lshl_b32 s43, s40, 12
  s_lshl_b32 s41, s40, 11
  s_lshl_b32 s64, s40, 14
  s_add_u32 s64, s64, 65536
  s_lshl_b32 s66, s65, 4
  s_lshl_b32 s97, s40, 2
  s_add_u32 s66, s66, s97
  s_lshl_b32 s45, s66, 8
  v_and_b32 v2, 15, v1
  v_lshrrev_b32 v3, 4, v1
  v_lshlrev_b32 v15, 4, v1
  s_and_b32 s97, s40, 1
  s_lshl_b32 s97, s97, 3
  v_lshlrev_b32 v4, 8, v3
  v_xor_b32 v5, v2, v3
  v_xor_b32 v5, s97, v5
  v_lshlrev_b32 v6, 4, v5
  v_add_u32 v80, v4, v6
  v_xor_b32 v81, 64, v80
  v_lshlrev_b32 v5, 1, v3
  v_xor_b32 v5, v2, v5
  v_lshlrev_b32 v6, 4, v5
  v_add_u32 v82, v4, v6
  v_xor_b32 v83, 128, v82
  v_add_u32 v4, 0, v3
  v_xor_b32 v5, v2, v4
  v_lshlrev_b32 v5, 4, v5
  v_and_b32 v4, 7, v4
  v_lshl_add_u32 v5, v4, 16, v5
  v_mov_b32 v8, v5
  v_add_u32 v4, 4, v3
  v_xor_b32 v5, v2, v4
  v_lshlrev_b32 v5, 4, v5
  v_and_b32 v4, 7, v4
  v_lshl_add_u32 v5, v4, 16, v5
  v_mov_b32 v9, v5
  v_add_u32 v4, 8, v3
  v_xor_b32 v5, v2, v4
  v_lshlrev_b32 v5, 4, v5
  v_and_b32 v4, 7, v4
  v_lshl_add_u32 v5, v4, 16, v5
  v_add_u32 v10, 524288, v5
  v_add_u32 v4, 12, v3
  v_xor_b32 v5, v2, v4
  v_lshlrev_b32 v5, 4, v5
  v_and_b32 v4, 7, v4
  v_lshl_add_u32 v5, v4, 16, v5
  v_add_u32 v11, 524288, v5
  v_subrev_u32 v9, 1024, v9
  v_subrev_u32 v10, 2048, v10
  v_subrev_u32 v11, 3072, v11
  s_waitcnt lgkmcnt(0)
  s_add_u32 s8, s50, s98
  s_addc_u32 s9, s51, 0
  s_mov_b32 s10, 524288
  s_mov_b32 s11, 0x20000
  s_add_u32 s4, s48, s99
  s_addc_u32 s5, s49, 0
  s_mov_b32 s6, 1048576
  s_mov_b32 s7, 0x20000
  s_add_u32 s12, s52, s98
  s_addc_u32 s13, s53, 0
  s_mov_b32 s14, 524288
  s_mov_b32 s15, 0x20000
  s_add_u32 s16, s60, s99
  s_addc_u32 s17, s61, 0
  s_mov_b32 s18, 1048576
  s_mov_b32 s19, 0x20000
  s_mov_b32 s62, s41
  s_add_u32 m0, s43, 131072
  s_nop 0
  buffer_load_dwordx4 v80, s[8:11], s62 offen lds
  buffer_load_dwordx4 v81, s[8:11], s62 offen offset:1024 lds
  s_add_u32 m0, s64, 0
  s_add_u32 s60, s45, 0
  buffer_load_dwordx4 v8, s[4:7], s60 offen offset:0 nt lds
  buffer_load_dwordx4 v9, s[4:7], s60 offen offset:1024 nt lds
  buffer_load_dwordx4 v10, s[4:7], s60 offen offset:2048 nt lds
  buffer_load_dwordx4 v11, s[4:7], s60 offen offset:3072 nt lds
  s_add_u32 s61, s62, 8192
  s_add_u32 m0, s43, 0
  s_nop 0
  buffer_load_dwordx4 v80, s[8:11], s61 offen lds
  buffer_load_dwordx4 v81, s[8:11], s61 offen offset:1024 lds
  s_add_u32 s61, s62, 0
  s_add_u32 m0, s43, 2048
  s_nop 0
  buffer_load_dwordx4 v82, s[12:15], s61 offen lds
  buffer_load_dwordx4 v83, s[12:15], s61 offen offset:1024 lds
  s_add_u32 m0, s64, 4096
  s_add_u32 s60, s45, 256
  buffer_load_dwordx4 v8, s[4:7], s60 offen offset:0 nt lds
  buffer_load_dwordx4 v9, s[4:7], s60 offen offset:1024 nt lds
  buffer_load_dwordx4 v10, s[4:7], s60 offen offset:2048 nt lds
  buffer_load_dwordx4 v11, s[4:7], s60 offen offset:3072 nt lds
  s_add_u32 s20, s54, s98
  s_addc_u32 s21, s55, 0
  s_mov_b32 s22, 524288
  s_mov_b32 s23, 0x20000
  s_add_u32 s24, s56, s98
  s_addc_u32 s25, s57, 0
  s_mov_b32 s26, 524288
  s_mov_b32 s27, 0x20000
  s_mov_b32 s28, s58
  s_mov_b32 s29, s59
  s_mov_b32 s30, 8388608
  s_mov_b32 s31, 0x20000
  s_mov_b32 s36, s92
  s_mov_b32 s37, s93
  s_mov_b32 s38, 256
  s_mov_b32 s39, 0x20000
  s_mov_b32 s32, s94
  s_mov_b32 s33, s95
  s_mov_b32 s34, 268435456
  s_mov_b32 s35, 0x20000
  s_mov_b32 s46, 0x3e0293ee
  s_mov_b32 s47, 0x3e0293ee
  s_mul_i32 s93, s66, 3072
  s_add_u32 s93, s93, 524288
  s_lshl_b32 s94, s2, 11
  s_mov_b32 s95, 0
  v_and_b32 v2, 15, v1
  v_lshrrev_b32 v3, 4, v1
  v_lshrrev_b32 v4, 3, v2
  v_lshlrev_b32 v4, 12, v4
  v_and_b32 v5, 7, v2
  v_lshlrev_b32 v5, 8, v5
  v_xor_b32 v6, v2, v3
  v_lshlrev_b32 v6, 4, v6
  v_add3_u32 v4, v4, v5, v6
  v_xor_b32 v68, 0, v4
  v_xor_b32 v69, 64, v4
  v_xor_b32 v70, 128, v4
  v_xor_b32 v71, 192, v4
  v_lshl_add_u32 v4, v2, 8, v6
  v_add_u32 v4, s64, v4
  v_xor_b32 v84, 0, v4
  v_xor_b32 v85, 64, v4
  v_xor_b32 v86, 128, v4
  v_xor_b32 v87, 192, v4
  v_lshrrev_b32 v4, 2, v2
  v_lshl_add_u32 v4, v3, 2, v4
  v_lshrrev_b32 v5, 3, v4
  v_lshlrev_b32 v5, 12, v5
  v_and_b32 v7, 7, v4
  v_mul_u32_u24 v6, 288, v7
  v_and_b32 v7, 3, v2
  v_lshlrev_b32 v7, 3, v7
  v_add3_u32 v5, v5, v6, v7
  v_add_u32 v5, 2048, v5
  v_xor_b32 v72, 0, v5
  v_xor_b32 v73, 32, v5
  v_xor_b32 v74, 64, v5
  v_xor_b32 v75, 96, v5
  v_xor_b32 v76, 128, v5
  v_xor_b32 v77, 160, v5
  v_xor_b32 v78, 192, v5
  v_xor_b32 v79, 224, v5
  v_bfe_u32 v5, v2, 1, 1
  v_xor_b32 v5, v5, v4
  v_lshlrev_b32 v5, 4, v5
  v_lshl_add_u32 v5, v4, 8, v5
  v_and_b32 v6, 1, v2
  v_lshl_add_u32 v5, v6, 3, v5
  v_add_u32 v5, s64, v5
  v_add_u32 v5, 8192, v5
  v_xor_b32 v88, 0, v5
  v_xor_b32 v89, 32, v5
  v_xor_b32 v90, 64, v5
  v_xor_b32 v91, 96, v5
  v_xor_b32 v92, 128, v5
  v_xor_b32 v93, 160, v5
  v_xor_b32 v94, 192, v5
  v_xor_b32 v95, 224, v5
  v_mov_b32 v48, 0
  v_mov_b32 v49, 0
  v_mov_b32 v50, 0
  v_mov_b32 v51, 0
  v_mov_b32 v120, 0
  v_mov_b32 v121, 0
  v_mov_b32 v122, 0
  v_mov_b32 v123, 0
  v_and_b32 v2, 3, v1
  v_mov_b32 v3, 0x3f803f80
  v_cmp_eq_u32 vcc, 0, v2
  s_nop 1
  v_cndmask_b32 v124, 0, v3, vcc
  v_cndmask_b32 v125, 0, v3, vcc
  v_cndmask_b32 v126, 0, v3, vcc
  v_cndmask_b32 v127, 0, v3, vcc
  v_add_u32 v4, 131072, v68
  v_add_u32 v5, 131072, v69
  v_add_u32 v6, 131072, v70
  v_add_u32 v7, 131072, v71
  s_waitcnt vmcnt(12)
  s_barrier
  ds_read_b128 a[64:67], v4 offset:0
  ds_read_b128 a[68:71], v5 offset:0
  ds_read_b128 a[72:75], v6 offset:0
  ds_read_b128 a[76:79], v7 offset:0
  ds_read_b128 a[80:83], v4 offset:8192
  ds_read_b128 a[84:87], v5 offset:8192
  ds_read_b128 a[88:91], v6 offset:8192
  ds_read_b128 a[92:95], v7 offset:8192
  s_waitcnt vmcnt(8)
  ds_read_b128 v[96:99], v84 offset:0
  ds_read_b128 v[100:103], v85 offset:0
  ds_read_b128 v[104:107], v86 offset:0
  ds_read_b128 v[108:111], v87 offset:0
  s_waitcnt lgkmcnt(0)
  v_lshlrev_b32 v2, 16, v96
  v_and_b32 v3, 0xffff0000, v96
  v_pk_mul_f32 v[2:3], v[2:3], s[46:47]
  s_add_u32 m0, s64, 8192
  s_add_u32 s60, s45, 512
  buffer_load_dwordx4 v8, s[4:7], s60 offen offset:0 nt lds
  v_cvt_pk_bf16_f32 v2, v2, v3
  v_accvgpr_write_b32 a0, v2
  v_lshlrev_b32 v4, 16, v97
  v_and_b32 v5, 0xffff0000, v97
  v_pk_mul_f32 v[4:5], v[4:5], s[46:47]
  v_cvt_pk_bf16_f32 v4, v4, v5
  v_accvgpr_write_b32 a1, v4
  v_lshlrev_b32 v2, 16, v98
  v_and_b32 v3, 0xffff0000, v98
  v_pk_mul_f32 v[2:3], v[2:3], s[46:47]
  buffer_load_dwordx4 v9, s[4:7], s60 offen offset:1024 nt lds
  v_cvt_pk_bf16_f32 v2, v2, v3
  v_accvgpr_write_b32 a2, v2
  v_lshlrev_b32 v4, 16, v99
  v_and_b32 v5, 0xffff0000, v99
  v_pk_mul_f32 v[4:5], v[4:5], s[46:47]
  v_cvt_pk_bf16_f32 v4, v4, v5
  v_accvgpr_write_b32 a3, v4
  v_lshlrev_b32 v2, 16, v100
  v_and_b32 v3, 0xffff0000, v100
  v_pk_mul_f32 v[2:3], v[2:3], s[46:47]
  buffer_load_dwordx4 v10, s[4:7], s60 offen offset:2048 nt lds
  v_cvt_pk_bf16_f32 v2, v2, v3
  v_accvgpr_write_b32 a4, v2
  v_lshlrev_b32 v4, 16, v101
  v_and_b32 v5, 0xffff0000, v101
  v_pk_mul_f32 v[4:5], v[4:5], s[46:47]
  v_cvt_pk_bf16_f32 v4, v4, v5
  v_accvgpr_write_b32 a5, v4
  v_lshlrev_b32 v2, 16, v102
  v_and_b32 v3, 0xffff0000, v102
  v_pk_mul_f32 v[2:3], v[2:3], s[46:47]
  buffer_load_dwordx4 v11, s[4:7], s60 offen offset:3072 nt lds
  v_cvt_pk_bf16_f32 v2, v2, v3
  v_accvgpr_write_b32 a6, v2
  v_lshlrev_b32 v4, 16, v103
  v_and_b32 v5, 0xffff0000, v103
  v_pk_mul_f32 v[4:5], v[4:5], s[46:47]
  v_cvt_pk_bf16_f32 v4, v4, v5
  v_accvgpr_write_b32 a7, v4
  v_lshlrev_b32 v2, 16, v104
  v_and_b32 v3, 0xffff0000, v104
  v_pk_mul_f32 v[2:3], v[2:3], s[46:47]
  s_add_u32 m0, s43, 16384
  s_add_u32 s61, s62, 16384
  buffer_load_dwordx4 v80, s[8:11], s61 offen lds
  v_cvt_pk_bf16_f32 v2, v2, v3
  v_accvgpr_write_b32 a8, v2
  v_lshlrev_b32 v4, 16, v105
  v_and_b32 v5, 0xffff0000, v105
  v_pk_mul_f32 v[4:5], v[4:5], s[46:47]
  v_cvt_pk_bf16_f32 v4, v4, v5
  v_accvgpr_write_b32 a9, v4
  v_lshlrev_b32 v2, 16, v106
  v_and_b32 v3, 0xffff0000, v106
  v_pk_mul_f32 v[2:3], v[2:3], s[46:47]
  buffer_load_dwordx4 v81, s[8:11], s61 offen offset:1024 lds
  v_cvt_pk_bf16_f32 v2, v2, v3
  v_accvgpr_write_b32 a10, v2
  v_lshlrev_b32 v4, 16, v107
  v_and_b32 v5, 0xffff0000, v107
  v_pk_mul_f32 v[4:5], v[4:5], s[46:47]
  v_cvt_pk_bf16_f32 v4, v4, v5
  v_accvgpr_write_b32 a11, v4
  v_lshlrev_b32 v2, 16, v108
  v_and_b32 v3, 0xffff0000, v108
  v_pk_mul_f32 v[2:3], v[2:3], s[46:47]
  s_add_u32 m0, s43, 18432
  s_add_u32 s61, s62, 8192
  buffer_load_dwordx4 v82, s[12:15], s61 offen lds
  v_cvt_pk_bf16_f32 v2, v2, v3
  v_accvgpr_write_b32 a12, v2
  v_lshlrev_b32 v4, 16, v109
  v_and_b32 v5, 0xffff0000, v109
  v_pk_mul_f32 v[4:5], v[4:5], s[46:47]
  v_cvt_pk_bf16_f32 v4, v4, v5
  v_accvgpr_write_b32 a13, v4
  v_lshlrev_b32 v2, 16, v110
  v_and_b32 v3, 0xffff0000, v110
  v_pk_mul_f32 v[2:3], v[2:3], s[46:47]
  buffer_load_dwordx4 v83, s[12:15], s61 offen offset:1024 lds
  v_cvt_pk_bf16_f32 v2, v2, v3
  v_accvgpr_write_b32 a14, v2
  v_lshlrev_b32 v4, 16, v111
  v_and_b32 v5, 0xffff0000, v111
  v_pk_mul_f32 v[4:5], v[4:5], s[46:47]
  v_cvt_pk_bf16_f32 v4, v4, v5
  v_accvgpr_write_b32 a15, v4
  s_waitcnt lgkmcnt(0)
  s_nop 1
  v_mfma_f32_16x16x32_bf16 v[40:43], a[64:67], a[0:3], 0
  v_mfma_f32_16x16x32_bf16 v[40:43], a[68:71], a[4:7], v[40:43]
  v_mfma_f32_16x16x32_bf16 v[40:43], a[72:75], a[8:11], v[40:43]
  v_mfma_f32_16x16x32_bf16 v[40:43], a[76:79], a[12:15], v[40:43]
  s_waitcnt vmcnt(12)
  s_barrier
  ds_read_b64_tr_b16 a[128:129], v72 offset:0
  ds_read_b64_tr_b16 a[130:131], v72 offset:8192
  ds_read_b64_tr_b16 a[132:133], v73 offset:0
  ds_read_b64_tr_b16 a[134:135], v73 offset:8192
  ds_read_b64_tr_b16 a[136:137], v74 offset:0
  ds_read_b64_tr_b16 a[138:139], v74 offset:8192
  ds_read_b64_tr_b16 a[140:141], v75 offset:0
  ds_read_b64_tr_b16 a[142:143], v75 offset:8192
  ds_read_b64_tr_b16 a[144:145], v76 offset:0
  ds_read_b64_tr_b16 a[146:147], v76 offset:8192
  ds_read_b64_tr_b16 a[148:149], v77 offset:0
  s_waitcnt vmcnt(8)
  ds_read_b128 v[96:99], v84 offset:4096
  ds_read_b128 v[100:103], v85 offset:4096
  ds_read_b128 v[104:107], v86 offset:4096
  ds_read_b128 v[108:111], v87 offset:4096
  v_max3_f32 v6, v40, v41, v42
  v_max_f32 v6, v6, v43
  v_mov_b32 v7, v6
  s_nop 1
  v_permlane16_swap_b32 v6, v7
  v_max_f32 v6, v6, v7
  v_mov_b32 v7, v6
  s_nop 1
  v_permlane32_swap_b32 v6, v7
  v_max_f32 v6, v6, v7
  v_sub_f32 v52, 0, v6
  v_sub_f32 v53, 0, v6
  v_sub_f32 v54, 0, v6
  v_sub_f32 v55, 0, v6
  s_nop 1
  v_mfma_f32_16x16x32_bf16 v[16:19], a[64:67], a[0:3], v[52:55]
  v_mfma_f32_16x16x32_bf16 v[16:19], a[68:71], a[4:7], v[16:19]
  v_mfma_f32_16x16x32_bf16 v[16:19], a[72:75], a[8:11], v[16:19]
  v_mfma_f32_16x16x32_bf16 v[16:19], a[76:79], a[12:15], v[16:19]
  v_mfma_f32_16x16x32_bf16 v[20:23], a[80:83], a[0:3], v[52:55]
  v_mfma_f32_16x16x32_bf16 v[20:23], a[84:87], a[4:7], v[20:23]
  v_mfma_f32_16x16x32_bf16 v[20:23], a[88:91], a[8:11], v[20:23]
  v_mfma_f32_16x16x32_bf16 v[20:23], a[92:95], a[12:15], v[20:23]
  s_waitcnt lgkmcnt(0)
  ds_read_b64_tr_b16 a[150:151], v77 offset:8192
  ds_read_b64_tr_b16 a[152:153], v78 offset:0
  ds_read_b64_tr_b16 a[154:155], v78 offset:8192
  ds_read_b64_tr_b16 a[156:157], v79 offset:0
  ds_read_b64_tr_b16 a[158:159], v79 offset:8192
  ds_read_b128 a[96:99], v68 offset:0
  ds_read_b128 a[100:103], v69 offset:0
  ds_read_b128 a[104:107], v70 offset:0
  ds_read_b128 a[108:111], v71 offset:0
  v_lshlrev_b32 v2, 16, v96
  v_and_b32 v3, 0xffff0000, v96
  s_add_u32 m0, s64, 12288
  s_add_u32 s60, s45, 768
  buffer_load_dwordx4 v8, s[4:7], s60 offen offset:0 nt lds
  v_pk_mul_f32 v[2:3], v[2:3], s[46:47]
  v_cvt_pk_bf16_f32 v2, v2, v3
  v_accvgpr_write_b32 a16, v2
  v_lshlrev_b32 v4, 16, v97
  v_and_b32 v5, 0xffff0000, v97
  v_pk_mul_f32 v[4:5], v[4:5], s[46:47]
  buffer_load_dwordx4 v9, s[4:7], s60 offen offset:1024 nt lds
  v_cvt_pk_bf16_f32 v4, v4, v5
  v_accvgpr_write_b32 a17, v4
  v_lshlrev_b32 v2, 16, v98
  v_and_b32 v3, 0xffff0000, v98
  v_pk_mul_f32 v[2:3], v[2:3], s[46:47]
  v_cvt_pk_bf16_f32 v2, v2, v3
  buffer_load_dwordx4 v10, s[4:7], s60 offen offset:2048 nt lds
  v_accvgpr_write_b32 a18, v2
  v_lshlrev_b32 v4, 16, v99
  v_and_b32 v5, 0xffff0000, v99
  v_pk_mul_f32 v[4:5], v[4:5], s[46:47]
  v_cvt_pk_bf16_f32 v4, v4, v5
  v_accvgpr_write_b32 a19, v4
  buffer_load_dwordx4 v11, s[4:7], s60 offen offset:3072 nt lds
  v_lshlrev_b32 v2, 16, v100
  v_and_b32 v3, 0xffff0000, v100
  v_pk_mul_f32 v[2:3], v[2:3], s[46:47]
  v_cvt_pk_bf16_f32 v2, v2, v3
  v_accvgpr_write_b32 a20, v2
  v_lshlrev_b32 v4, 16, v101
  s_add_u32 m0, s43, 32768
  s_add_u32 s61, s62, 24576
  buffer_load_dwordx4 v80, s[8:11], s61 offen lds
  v_and_b32 v5, 0xffff0000, v101
  v_pk_mul_f32 v[4:5], v[4:5], s[46:47]
  v_cvt_pk_bf16_f32 v4, v4, v5
  v_accvgpr_write_b32 a21, v4
  v_lshlrev_b32 v2, 16, v102
  v_and_b32 v3, 0xffff0000, v102
  buffer_load_dwordx4 v81, s[8:11], s61 offen offset:1024 lds
  v_pk_mul_f32 v[2:3], v[2:3], s[46:47]
  v_cvt_pk_bf16_f32 v2, v2, v3
  v_accvgpr_write_b32 a22, v2
  v_lshlrev_b32 v4, 16, v103
  v_and_b32 v5, 0xffff0000, v103
  v_pk_mul_f32 v[4:5], v[4:5], s[46:47]
  s_add_u32 m0, s43, 34816
  s_add_u32 s61, s62, 16384
  buffer_load_dwordx4 v82, s[12:15], s61 offen lds
  v_cvt_pk_bf16_f32 v4, v4, v5
  v_accvgpr_write_b32 a23, v4
  v_lshlrev_b32 v2, 16, v104
  v_and_b32 v3, 0xffff0000, v104
  v_pk_mul_f32 v[2:3], v[2:3], s[46:47]
  v_cvt_pk_bf16_f32 v2, v2, v3
  buffer_load_dwordx4 v83, s[12:15], s61 offen offset:1024 lds
  v_accvgpr_write_b32 a24, v2
  v_lshlrev_b32 v4, 16, v105
  v_and_b32 v5, 0xffff0000, v105
  v_pk_mul_f32 v[4:5], v[4:5], s[46:47]
  v_cvt_pk_bf16_f32 v4, v4, v5
  v_accvgpr_write_b32 a25, v4
  s_add_u32 m0, s43, 49152
  s_add_u32 s61, s62, 32768
  buffer_load_dwordx4 v80, s[8:11], s61 offen lds
  v_lshlrev_b32 v2, 16, v106
  v_and_b32 v3, 0xffff0000, v106
  v_pk_mul_f32 v[2:3], v[2:3], s[46:47]
  v_cvt_pk_bf16_f32 v2, v2, v3
  v_accvgpr_write_b32 a26, v2
  v_lshlrev_b32 v4, 16, v107
  buffer_load_dwordx4 v81, s[8:11], s61 offen offset:1024 lds
  v_and_b32 v5, 0xffff0000, v107
  v_pk_mul_f32 v[4:5], v[4:5], s[46:47]
  v_cvt_pk_bf16_f32 v4, v4, v5
  v_accvgpr_write_b32 a27, v4
  v_lshlrev_b32 v2, 16, v108
  v_and_b32 v3, 0xffff0000, v108
  s_add_u32 m0, s43, 51200
  s_add_u32 s61, s62, 24576
  buffer_load_dwordx4 v82, s[12:15], s61 offen lds
  v_pk_mul_f32 v[2:3], v[2:3], s[46:47]
  v_cvt_pk_bf16_f32 v2, v2, v3
  v_accvgpr_write_b32 a28, v2
  v_lshlrev_b32 v4, 16, v109
  v_and_b32 v5, 0xffff0000, v109
  v_pk_mul_f32 v[4:5], v[4:5], s[46:47]
  buffer_load_dwordx4 v83, s[12:15], s61 offen offset:1024 lds
  v_cvt_pk_bf16_f32 v4, v4, v5
  v_accvgpr_write_b32 a29, v4
  v_lshlrev_b32 v2, 16, v110
  v_and_b32 v3, 0xffff0000, v110
  v_pk_mul_f32 v[2:3], v[2:3], s[46:47]
  v_cvt_pk_bf16_f32 v2, v2, v3
  v_accvgpr_write_b32 a30, v2
  v_lshlrev_b32 v4, 16, v111
  v_and_b32 v5, 0xffff0000, v111
  v_pk_mul_f32 v[4:5], v[4:5], s[46:47]
  v_cvt_pk_bf16_f32 v4, v4, v5
  v_accvgpr_write_b32 a31, v4
  s_nop 1
  v_mfma_f32_16x16x32_bf16 v[40:43], a[64:67], a[16:19], 0
  v_mfma_f32_16x16x32_bf16 v[40:43], a[68:71], a[20:23], v[40:43]
  v_mfma_f32_16x16x32_bf16 v[40:43], a[72:75], a[24:27], v[40:43]
  v_mfma_f32_16x16x32_bf16 v[40:43], a[76:79], a[28:31], v[40:43]
  s_nop 5
  s_add_u32 s42, s62, 32768
  s_add_u32 s41, s62, 40960
  v_max3_f32 v6, v40, v41, v42
  v_max_f32 v6, v6, v43
  v_mov_b32 v7, v6
  s_nop 1
  v_permlane16_swap_b32 v6, v7
  v_max_f32 v6, v6, v7
  v_mov_b32 v7, v6
  s_nop 1
  v_permlane32_swap_b32 v6, v7
  v_max_f32 v6, v6, v7
  v_sub_f32 v56, 0, v6
  v_sub_f32 v57, 0, v6
  v_sub_f32 v58, 0, v6
  v_sub_f32 v59, 0, v6
  v_and_b32 v2, 3, v1
  v_mov_b32 v3, 0x3f803f80
  v_cmp_eq_u32 vcc, 1, v2
  s_nop 1
  v_cndmask_b32 v8, 0, v3, vcc
  v_cndmask_b32 v9, 0, v3, vcc
  v_cndmask_b32 v10, 0, v3, vcc
  v_cndmask_b32 v11, 0, v3, vcc
  s_waitcnt lgkmcnt(0)
  s_nop 1
  v_mfma_f32_16x16x32_bf16 v[24:27], a[64:67], a[16:19], v[56:59]
  v_exp_f32 v40, v16
  v_mfma_f32_16x16x32_bf16 v[24:27], a[68:71], a[20:23], v[24:27]
  ds_read_b128 a[112:115], v68 offset:8192
  v_mfma_f32_16x16x32_bf16 v[24:27], a[72:75], a[24:27], v[24:27]
  v_exp_f32 v41, v17
  v_mfma_f32_16x16x32_bf16 v[24:27], a[76:79], a[28:31], v[24:27]
  ds_read_b128 a[116:119], v69 offset:8192
  v_cvt_pk_bf16_f32 v32, v40, v41
  v_mfma_f32_16x16x32_bf16 v[28:31], a[80:83], a[16:19], v[56:59]
  v_exp_f32 v42, v18
  v_mfma_f32_16x16x32_bf16 v[28:31], a[84:87], a[20:23], v[28:31]
  ds_read_b128 a[120:123], v70 offset:8192
  v_mfma_f32_16x16x32_bf16 v[28:31], a[88:91], a[24:27], v[28:31]
  v_exp_f32 v43, v19
  v_mfma_f32_16x16x32_bf16 v[28:31], a[92:95], a[28:31], v[28:31]
  ds_read_b128 a[124:127], v71 offset:8192
  v_cvt_pk_bf16_f32 v33, v42, v43
  s_nop 0
  v_exp_f32 v44, v20
  s_nop 0
  s_nop 0
  v_exp_f32 v45, v21
  s_nop 0
  v_cvt_pk_bf16_f32 v34, v44, v45
  s_nop 0
  v_exp_f32 v46, v22
  s_nop 0
  s_nop 0
  s_waitcnt vmcnt(12) lgkmcnt(0)
  v_exp_f32 v47, v23
  s_nop 0
  v_cvt_pk_bf16_f32 v35, v46, v47
  s_nop 0
  s_barrier
  s_waitcnt vmcnt(16)
  ds_read_b128 v[96:99], v84 offset:8192
  ds_read_b128 v[100:103], v85 offset:8192
  ds_read_b128 v[104:107], v86 offset:8192
  ds_read_b128 v[108:111], v87 offset:8192
  s_waitcnt lgkmcnt(0)
  v_lshlrev_b32 v2, 16, v96
  v_and_b32 v3, 0xffff0000, v96
  s_lshl_b32 s60, s2, 12
  s_lshl_b32 s59, s40, 10
  s_add_u32 m0, s64, 0
  s_add_u32 s60, s60, s59
  buffer_load_dwordx4 v15, s[28:31], s60 offen nt lds
  v_pk_mul_f32 v[2:3], v[2:3], s[46:47]
  v_cvt_pk_bf16_f32 v2, v2, v3
  v_accvgpr_write_b32 a32, v2
  v_lshlrev_b32 v4, 16, v97
  v_and_b32 v5, 0xffff0000, v97
  v_pk_mul_f32 v[4:5], v[4:5], s[46:47]
  v_cvt_pk_bf16_f32 v4, v4, v5
  v_accvgpr_write_b32 a33, v4
  v_lshlrev_b32 v2, 16, v98
  s_add_u32 m0, s64, 1024
  s_add_u32 s60, s60, 1048576
  buffer_load_dwordx4 v15, s[28:31], s60 offen nt lds
  v_and_b32 v3, 0xffff0000, v98
  v_pk_mul_f32 v[2:3], v[2:3], s[46:47]
  v_cvt_pk_bf16_f32 v2, v2, v3
  v_accvgpr_write_b32 a34, v2
  v_lshlrev_b32 v4, 16, v99
  v_and_b32 v5, 0xffff0000, v99
  v_pk_mul_f32 v[4:5], v[4:5], s[46:47]
  v_cvt_pk_bf16_f32 v4, v4, v5
  v_accvgpr_write_b32 a35, v4
  s_add_u32 m0, s64, 2048
  s_add_u32 s60, s60, 1048576
  buffer_load_dwordx4 v15, s[28:31], s60 offen nt lds
  v_lshlrev_b32 v2, 16, v100
  v_and_b32 v3, 0xffff0000, v100
  v_pk_mul_f32 v[2:3], v[2:3], s[46:47]
  v_cvt_pk_bf16_f32 v2, v2, v3
  v_accvgpr_write_b32 a36, v2
  v_lshlrev_b32 v4, 16, v101
  v_and_b32 v5, 0xffff0000, v101
  v_pk_mul_f32 v[4:5], v[4:5], s[46:47]
  v_cvt_pk_bf16_f32 v4, v4, v5
  s_add_u32 m0, s64, 3072
  s_add_u32 s60, s60, 1048576
  buffer_load_dwordx4 v15, s[28:31], s60 offen nt lds
  v_accvgpr_write_b32 a37, v4
  v_lshlrev_b32 v2, 16, v102
  v_and_b32 v3, 0xffff0000, v102
  v_pk_mul_f32 v[2:3], v[2:3], s[46:47]
  v_cvt_pk_bf16_f32 v2, v2, v3
  v_accvgpr_write_b32 a38, v2
  v_lshlrev_b32 v4, 16, v103
  v_and_b32 v5, 0xffff0000, v103
  v_pk_mul_f32 v[4:5], v[4:5], s[46:47]
  s_add_u32 m0, s64, 4096
  s_add_u32 s60, s60, 1048576
  buffer_load_dwordx4 v15, s[28:31], s60 offen nt lds
  v_cvt_pk_bf16_f32 v4, v4, v5
  v_accvgpr_write_b32 a39, v4
  v_lshlrev_b32 v2, 16, v104
  v_and_b32 v3, 0xffff0000, v104
  v_pk_mul_f32 v[2:3], v[2:3], s[46:47]
  v_cvt_pk_bf16_f32 v2, v2, v3
  v_accvgpr_write_b32 a40, v2
  v_lshlrev_b32 v4, 16, v105
  v_and_b32 v5, 0xffff0000, v105
  s_add_u32 m0, s64, 5120
  s_add_u32 s60, s60, 1048576
  buffer_load_dwordx4 v15, s[28:31], s60 offen nt lds
  v_pk_mul_f32 v[4:5], v[4:5], s[46:47]
  v_cvt_pk_bf16_f32 v4, v4, v5
  v_accvgpr_write_b32 a41, v4
  v_lshlrev_b32 v2, 16, v106
  v_and_b32 v3, 0xffff0000, v106
  v_pk_mul_f32 v[2:3], v[2:3], s[46:47]
  v_cvt_pk_bf16_f32 v2, v2, v3
  v_accvgpr_write_b32 a42, v2
  v_lshlrev_b32 v4, 16, v107
  s_add_u32 m0, s64, 6144
  s_add_u32 s60, s60, 1048576
  buffer_load_dwordx4 v15, s[28:31], s60 offen nt lds
  v_and_b32 v5, 0xffff0000, v107
  v_pk_mul_f32 v[4:5], v[4:5], s[46:47]
  v_cvt_pk_bf16_f32 v4, v4, v5
  v_accvgpr_write_b32 a43, v4
  v_lshlrev_b32 v2, 16, v108
  v_and_b32 v3, 0xffff0000, v108
  v_pk_mul_f32 v[2:3], v[2:3], s[46:47]
  v_cvt_pk_bf16_f32 v2, v2, v3
  v_accvgpr_write_b32 a44, v2
  s_add_u32 m0, s64, 7168
  s_add_u32 s60, s60, 1048576
  buffer_load_dwordx4 v15, s[28:31], s60 offen nt lds
  v_lshlrev_b32 v4, 16, v109
  v_and_b32 v5, 0xffff0000, v109
  v_pk_mul_f32 v[4:5], v[4:5], s[46:47]
  v_cvt_pk_bf16_f32 v4, v4, v5
  v_accvgpr_write_b32 a45, v4
  v_lshlrev_b32 v2, 16, v110
  v_and_b32 v3, 0xffff0000, v110
  v_pk_mul_f32 v[2:3], v[2:3], s[46:47]
  v_cvt_pk_bf16_f32 v2, v2, v3
  v_accvgpr_write_b32 a46, v2
  v_lshlrev_b32 v4, 16, v111
  v_and_b32 v5, 0xffff0000, v111
  v_pk_mul_f32 v[4:5], v[4:5], s[46:47]
  v_cvt_pk_bf16_f32 v4, v4, v5
  v_accvgpr_write_b32 a47, v4
  s_nop 1
  v_mfma_f32_16x16x32_bf16 v[40:43], a[64:67], a[32:35], 0
  v_mfma_f32_16x16x32_bf16 v[40:43], a[68:71], a[36:39], v[40:43]
  v_mfma_f32_16x16x32_bf16 v[40:43], a[72:75], a[40:43], v[40:43]
  v_mfma_f32_16x16x32_bf16 v[40:43], a[76:79], a[44:47], v[40:43]
  s_nop 7
  v_max3_f32 v6, v40, v41, v42
  v_max_f32 v6, v6, v43
  v_mov_b32 v7, v6
  s_nop 1
  v_permlane16_swap_b32 v6, v7
  v_max_f32 v6, v6, v7
  v_mov_b32 v7, v6
  s_nop 1
  v_permlane32_swap_b32 v6, v7
  v_max_f32 v6, v6, v7
  v_sub_f32 v60, 0, v6
  v_sub_f32 v61, 0, v6
  v_sub_f32 v62, 0, v6
  v_sub_f32 v63, 0, v6
  s_nop 1
  v_mfma_f32_16x16x32_bf16 v[16:19], a[64:67], a[32:35], v[60:63]
  v_exp_f32 v40, v24
  v_mfma_f32_16x16x32_bf16 v[16:19], a[68:71], a[36:39], v[16:19]
  ds_read_b64_tr_b16 a[160:161], v72 offset:16384
  v_mfma_f32_16x16x32_bf16 v[16:19], a[72:75], a[40:43], v[16:19]
  s_add_u32 m0, s43, 0
  v_exp_f32 v41, v25
  v_mfma_f32_16x16x32_bf16 v[16:19], a[76:79], a[44:47], v[16:19]
  ds_read_b64_tr_b16 a[162:163], v72 offset:24576
  v_cvt_pk_bf16_f32 v36, v40, v41
  v_mfma_f32_16x16x32_bf16 v[20:23], a[80:83], a[32:35], v[60:63]
  v_exp_f32 v42, v26
  v_mfma_f32_16x16x32_bf16 v[20:23], a[84:87], a[36:39], v[20:23]
  buffer_load_dwordx4 v80, s[8:11], s41 offen lds
  v_mfma_f32_16x16x32_bf16 v[20:23], a[88:91], a[40:43], v[20:23]
  v_exp_f32 v43, v27
  v_mfma_f32_16x16x32_bf16 v[20:23], a[92:95], a[44:47], v[20:23]
  ds_read_b64_tr_b16 a[164:165], v73 offset:16384
  v_cvt_pk_bf16_f32 v37, v42, v43
  v_mfma_f32_16x16x32_bf16 v[48:51], v[124:127], v[32:35], v[48:51]
  v_exp_f32 v44, v28
  v_mfma_f32_16x16x32_bf16 v[128:131], a[128:131], v[32:35], 0
  buffer_load_dwordx4 v81, s[8:11], s41 offen offset:1024 lds
  v_mfma_f32_16x16x32_bf16 v[132:135], a[132:135], v[32:35], 0
  s_add_u32 s41, s41, 8192
  v_exp_f32 v45, v29
  v_mfma_f32_16x16x32_bf16 v[136:139], a[136:139], v[32:35], 0
  ds_read_b64_tr_b16 a[166:167], v73 offset:24576
  v_cvt_pk_bf16_f32 v38, v44, v45
  v_mfma_f32_16x16x32_bf16 v[140:143], a[140:143], v[32:35], 0
  v_exp_f32 v46, v30
  v_mfma_f32_16x16x32_bf16 v[144:147], a[144:147], v[32:35], 0
  ds_read_b64_tr_b16 a[168:169], v74 offset:16384
  v_mfma_f32_16x16x32_bf16 v[148:151], a[148:151], v[32:35], 0
  v_exp_f32 v47, v31
  v_mfma_f32_16x16x32_bf16 v[152:155], a[152:155], v[32:35], 0
  ds_read_b64_tr_b16 a[170:171], v74 offset:24576
  v_cvt_pk_bf16_f32 v39, v46, v47
  v_mfma_f32_16x16x32_bf16 v[156:159], a[156:159], v[32:35], 0
  s_waitcnt vmcnt(18)
  ds_read_b128 v[96:99], v84 offset:12288
  ds_read_b128 v[100:103], v85 offset:12288
  ds_read_b128 v[104:107], v86 offset:12288
  ds_read_b128 v[108:111], v87 offset:12288
  s_waitcnt lgkmcnt(0)
  v_lshlrev_b32 v2, 16, v96
  v_and_b32 v3, 0xffff0000, v96
  v_pk_mul_f32 v[2:3], v[2:3], s[46:47]
  v_cvt_pk_bf16_f32 v2, v2, v3
  v_accvgpr_write_b32 a48, v2
  v_lshlrev_b32 v4, 16, v97
  v_and_b32 v5, 0xffff0000, v97
  v_pk_mul_f32 v[4:5], v[4:5], s[46:47]
  v_cvt_pk_bf16_f32 v4, v4, v5
  v_accvgpr_write_b32 a49, v4
  v_lshlrev_b32 v2, 16, v98
  v_and_b32 v3, 0xffff0000, v98
  v_pk_mul_f32 v[2:3], v[2:3], s[46:47]
  v_cvt_pk_bf16_f32 v2, v2, v3
  v_accvgpr_write_b32 a50, v2
  v_lshlrev_b32 v4, 16, v99
  v_and_b32 v5, 0xffff0000, v99
  v_pk_mul_f32 v[4:5], v[4:5], s[46:47]
  v_cvt_pk_bf16_f32 v4, v4, v5
  v_accvgpr_write_b32 a51, v4
  v_lshlrev_b32 v2, 16, v100
  v_and_b32 v3, 0xffff0000, v100
  v_pk_mul_f32 v[2:3], v[2:3], s[46:47]
  v_cvt_pk_bf16_f32 v2, v2, v3
  v_accvgpr_write_b32 a52, v2
  v_lshlrev_b32 v4, 16, v101
  v_and_b32 v5, 0xffff0000, v101
  v_pk_mul_f32 v[4:5], v[4:5], s[46:47]
  v_cvt_pk_bf16_f32 v4, v4, v5
  v_accvgpr_write_b32 a53, v4
  v_lshlrev_b32 v2, 16, v102
  v_and_b32 v3, 0xffff0000, v102
  v_pk_mul_f32 v[2:3], v[2:3], s[46:47]
  v_cvt_pk_bf16_f32 v2, v2, v3
  v_accvgpr_write_b32 a54, v2
  v_lshlrev_b32 v4, 16, v103
  v_and_b32 v5, 0xffff0000, v103
  v_pk_mul_f32 v[4:5], v[4:5], s[46:47]
  v_cvt_pk_bf16_f32 v4, v4, v5
  v_accvgpr_write_b32 a55, v4
  v_lshlrev_b32 v2, 16, v104
  v_and_b32 v3, 0xffff0000, v104
  v_pk_mul_f32 v[2:3], v[2:3], s[46:47]
  v_cvt_pk_bf16_f32 v2, v2, v3
  v_accvgpr_write_b32 a56, v2
  v_lshlrev_b32 v4, 16, v105
  v_and_b32 v5, 0xffff0000, v105
  v_pk_mul_f32 v[4:5], v[4:5], s[46:47]
  v_cvt_pk_bf16_f32 v4, v4, v5
  v_accvgpr_write_b32 a57, v4
  v_lshlrev_b32 v2, 16, v106
  v_and_b32 v3, 0xffff0000, v106
  v_pk_mul_f32 v[2:3], v[2:3], s[46:47]
  v_cvt_pk_bf16_f32 v2, v2, v3
  v_accvgpr_write_b32 a58, v2
  v_lshlrev_b32 v4, 16, v107
  v_and_b32 v5, 0xffff0000, v107
  v_pk_mul_f32 v[4:5], v[4:5], s[46:47]
  v_cvt_pk_bf16_f32 v4, v4, v5
  v_accvgpr_write_b32 a59, v4
  v_lshlrev_b32 v2, 16, v108
  v_and_b32 v3, 0xffff0000, v108
  v_pk_mul_f32 v[2:3], v[2:3], s[46:47]
  v_cvt_pk_bf16_f32 v2, v2, v3
  v_accvgpr_write_b32 a60, v2
  v_lshlrev_b32 v4, 16, v109
  v_and_b32 v5, 0xffff0000, v109
  v_pk_mul_f32 v[4:5], v[4:5], s[46:47]
  v_cvt_pk_bf16_f32 v4, v4, v5
  v_accvgpr_write_b32 a61, v4
  v_lshlrev_b32 v2, 16, v110
  v_and_b32 v3, 0xffff0000, v110
  v_pk_mul_f32 v[2:3], v[2:3], s[46:47]
  v_cvt_pk_bf16_f32 v2, v2, v3
  v_accvgpr_write_b32 a62, v2
  v_lshlrev_b32 v4, 16, v111
  v_and_b32 v5, 0xffff0000, v111
  v_pk_mul_f32 v[4:5], v[4:5], s[46:47]
  v_cvt_pk_bf16_f32 v4, v4, v5
  v_accvgpr_write_b32 a63, v4
  s_nop 1
  v_mfma_f32_16x16x32_bf16 v[40:43], a[64:67], a[48:51], 0
  v_mfma_f32_16x16x32_bf16 v[40:43], a[68:71], a[52:55], v[40:43]
  v_mfma_f32_16x16x32_bf16 v[40:43], a[72:75], a[56:59], v[40:43]
  v_mfma_f32_16x16x32_bf16 v[40:43], a[76:79], a[60:63], v[40:43]
  s_nop 7
  v_max3_f32 v6, v40, v41, v42
  v_max_f32 v6, v6, v43
  v_mov_b32 v7, v6
  s_nop 1
  v_permlane16_swap_b32 v6, v7
  v_max_f32 v6, v6, v7
  v_mov_b32 v7, v6
  s_nop 1
  v_permlane32_swap_b32 v6, v7
  v_max_f32 v6, v6, v7
  v_sub_f32 v64, 0, v6
  v_sub_f32 v65, 0, v6
  v_sub_f32 v66, 0, v6
  v_sub_f32 v67, 0, v6
  s_nop 1
  v_mfma_f32_16x16x32_bf16 v[24:27], a[64:67], a[48:51], v[64:67]
  s_add_u32 m0, s43, 2048
  v_exp_f32 v40, v16
  v_mfma_f32_16x16x32_bf16 v[24:27], a[68:71], a[52:55], v[24:27]
  buffer_load_dwordx4 v82, s[12:15], s42 offen lds
  v_mfma_f32_16x16x32_bf16 v[24:27], a[72:75], a[56:59], v[24:27]
  v_exp_f32 v41, v17
  v_mfma_f32_16x16x32_bf16 v[24:27], a[76:79], a[60:63], v[24:27]
  ds_read_b64_tr_b16 a[172:173], v75 offset:16384
  v_cvt_pk_bf16_f32 v32, v40, v41
  v_mfma_f32_16x16x32_bf16 v[28:31], a[80:83], a[48:51], v[64:67]
  v_exp_f32 v42, v18
  v_mfma_f32_16x16x32_bf16 v[28:31], a[84:87], a[52:55], v[28:31]
  buffer_load_dwordx4 v83, s[12:15], s42 offen offset:1024 lds
  v_mfma_f32_16x16x32_bf16 v[28:31], a[88:91], a[56:59], v[28:31]
  s_add_u32 s42, s42, 8192
  v_exp_f32 v43, v19
  v_mfma_f32_16x16x32_bf16 v[28:31], a[92:95], a[60:63], v[28:31]
  ds_read_b64_tr_b16 a[174:175], v75 offset:24576
  v_cvt_pk_bf16_f32 v33, v42, v43
  v_mfma_f32_16x16x32_bf16 v[48:51], v[8:11], v[36:39], v[48:51]
  v_exp_f32 v44, v20
  v_mfma_f32_16x16x32_bf16 v[160:163], a[128:131], v[36:39], 0
  ds_read_b64_tr_b16 a[176:177], v76 offset:16384
  v_mfma_f32_16x16x32_bf16 v[164:167], a[132:135], v[36:39], 0
  v_exp_f32 v45, v21
  v_mfma_f32_16x16x32_bf16 v[168:171], a[136:139], v[36:39], 0
  ds_read_b64_tr_b16 a[178:179], v76 offset:24576
  v_cvt_pk_bf16_f32 v34, v44, v45
  v_mfma_f32_16x16x32_bf16 v[172:175], a[140:143], v[36:39], 0
  v_exp_f32 v46, v22
  v_mfma_f32_16x16x32_bf16 v[176:179], a[144:147], v[36:39], 0
  ds_read_b64_tr_b16 a[180:181], v77 offset:16384
  v_mfma_f32_16x16x32_bf16 v[180:183], a[148:151], v[36:39], 0
  v_exp_f32 v47, v23
  v_mfma_f32_16x16x32_bf16 v[184:187], a[152:155], v[36:39], 0
  ds_read_b64_tr_b16 a[182:183], v77 offset:24576
  v_cvt_pk_bf16_f32 v35, v46, v47
  v_mfma_f32_16x16x32_bf16 v[188:191], a[156:159], v[36:39], 0
  v_mfma_f32_16x16x32_bf16 v[16:19], a[96:99], a[0:3], v[52:55]
  v_exp_f32 v40, v24
  v_mfma_f32_16x16x32_bf16 v[16:19], a[100:103], a[4:7], v[16:19]
  ds_read_b64_tr_b16 a[184:185], v78 offset:16384
  v_mfma_f32_16x16x32_bf16 v[16:19], a[104:107], a[8:11], v[16:19]
  v_exp_f32 v41, v25
  v_mfma_f32_16x16x32_bf16 v[16:19], a[108:111], a[12:15], v[16:19]
  ds_read_b64_tr_b16 a[186:187], v78 offset:24576
  v_cvt_pk_bf16_f32 v36, v40, v41
  v_mfma_f32_16x16x32_bf16 v[20:23], a[112:115], a[0:3], v[52:55]
  v_exp_f32 v42, v26
  v_mfma_f32_16x16x32_bf16 v[20:23], a[116:119], a[4:7], v[20:23]
  ds_read_b64_tr_b16 a[188:189], v79 offset:16384
  v_mfma_f32_16x16x32_bf16 v[20:23], a[120:123], a[8:11], v[20:23]
  v_exp_f32 v43, v27
  v_mfma_f32_16x16x32_bf16 v[20:23], a[124:127], a[12:15], v[20:23]
  ds_read_b64_tr_b16 a[190:191], v79 offset:24576
  v_cvt_pk_bf16_f32 v37, v42, v43
  v_mfma_f32_16x16x32_bf16 v[120:123], v[124:127], v[32:35], v[120:123]
  v_exp_f32 v44, v28
  v_mfma_f32_16x16x32_bf16 v[192:195], a[128:131], v[32:35], 0
  ds_read_b128 a[64:67], v68 offset:16384
  v_mfma_f32_16x16x32_bf16 v[196:199], a[132:135], v[32:35], 0
  v_exp_f32 v45, v29
  v_mfma_f32_16x16x32_bf16 v[200:203], a[136:139], v[32:35], 0
  ds_read_b128 a[68:71], v69 offset:16384
  v_cvt_pk_bf16_f32 v38, v44, v45
  v_mfma_f32_16x16x32_bf16 v[204:207], a[140:143], v[32:35], 0
  v_exp_f32 v46, v30
  v_mfma_f32_16x16x32_bf16 v[208:211], a[144:147], v[32:35], 0
  ds_read_b128 a[72:75], v70 offset:16384
  v_mfma_f32_16x16x32_bf16 v[212:215], a[148:151], v[32:35], 0
  v_exp_f32 v47, v31
  v_mfma_f32_16x16x32_bf16 v[216:219], a[152:155], v[32:35], 0
  ds_read_b128 a[76:79], v71 offset:16384
  v_cvt_pk_bf16_f32 v39, v46, v47
  v_mfma_f32_16x16x32_bf16 v[220:223], a[156:159], v[32:35], 0
.p2align 3
  v_mfma_f32_16x16x32_bf16 v[24:27], a[96:99], a[16:19], v[56:59]
  v_exp_f32 v40, v16
  v_mfma_f32_16x16x32_bf16 v[24:27], a[100:103], a[20:23], v[24:27]
  ds_read_b128 a[80:83], v68 offset:24576
  v_mfma_f32_16x16x32_bf16 v[24:27], a[104:107], a[24:27], v[24:27]
  v_exp_f32 v41, v17
  v_mfma_f32_16x16x32_bf16 v[24:27], a[108:111], a[28:31], v[24:27]
  ds_read_b128 a[84:87], v69 offset:24576
  v_cvt_pk_bf16_f32 v32, v40, v41
  v_mfma_f32_16x16x32_bf16 v[28:31], a[112:115], a[16:19], v[56:59]
  v_exp_f32 v42, v18
  v_mfma_f32_16x16x32_bf16 v[28:31], a[116:119], a[20:23], v[28:31]
  ds_read_b128 a[88:91], v70 offset:24576
  v_mfma_f32_16x16x32_bf16 v[28:31], a[120:123], a[24:27], v[28:31]
  v_exp_f32 v43, v19
  v_mfma_f32_16x16x32_bf16 v[28:31], a[124:127], a[28:31], v[28:31]
  ds_read_b128 a[92:95], v71 offset:24576
  v_cvt_pk_bf16_f32 v33, v42, v43
  v_mfma_f32_16x16x32_bf16 v[120:123], v[8:11], v[36:39], v[120:123]
  v_exp_f32 v44, v20
  v_mfma_f32_16x16x32_bf16 v[224:227], a[128:131], v[36:39], 0
  v_mfma_f32_16x16x32_bf16 v[228:231], a[132:135], v[36:39], 0
  v_exp_f32 v45, v21
  v_mfma_f32_16x16x32_bf16 v[232:235], a[136:139], v[36:39], 0
  v_cvt_pk_bf16_f32 v34, v44, v45
  v_mfma_f32_16x16x32_bf16 v[236:239], a[140:143], v[36:39], 0
  v_exp_f32 v46, v22
  v_mfma_f32_16x16x32_bf16 v[240:243], a[144:147], v[36:39], 0
  v_mfma_f32_16x16x32_bf16 v[244:247], a[148:151], v[36:39], 0
  s_waitcnt vmcnt(16) lgkmcnt(0)
  v_exp_f32 v47, v23
  v_mfma_f32_16x16x32_bf16 v[248:251], a[152:155], v[36:39], 0
  v_cvt_pk_bf16_f32 v35, v46, v47
  v_mfma_f32_16x16x32_bf16 v[252:255], a[156:159], v[36:39], 0
  s_barrier
  v_mfma_f32_16x16x32_bf16 v[16:19], a[96:99], a[32:35], v[60:63]
  v_exp_f32 v40, v24
  v_mfma_f32_16x16x32_bf16 v[16:19], a[100:103], a[36:39], v[16:19]
  ds_read_b64_tr_b16 a[128:129], v72 offset:32768
  v_mfma_f32_16x16x32_bf16 v[16:19], a[104:107], a[40:43], v[16:19]
  s_add_u32 m0, s43, 16384
  v_exp_f32 v41, v25
  v_mfma_f32_16x16x32_bf16 v[16:19], a[108:111], a[44:47], v[16:19]
  ds_read_b64_tr_b16 a[130:131], v72 offset:40960
  v_cvt_pk_bf16_f32 v36, v40, v41
  v_mfma_f32_16x16x32_bf16 v[20:23], a[112:115], a[32:35], v[60:63]
  v_exp_f32 v42, v26
  v_mfma_f32_16x16x32_bf16 v[20:23], a[116:119], a[36:39], v[20:23]
  buffer_load_dwordx4 v80, s[8:11], s41 offen lds
  v_mfma_f32_16x16x32_bf16 v[20:23], a[120:123], a[40:43], v[20:23]
  v_exp_f32 v43, v27
  v_mfma_f32_16x16x32_bf16 v[20:23], a[124:127], a[44:47], v[20:23]
  ds_read_b64_tr_b16 a[132:133], v73 offset:32768
  v_cvt_pk_bf16_f32 v37, v42, v43
  v_mfma_f32_16x16x32_bf16 v[48:51], v[124:127], v[32:35], v[48:51]
  v_exp_f32 v44, v28
  v_mfma_f32_16x16x32_bf16 v[128:131], a[160:163], v[32:35], v[128:131]
  buffer_load_dwordx4 v81, s[8:11], s41 offen offset:1024 lds
  v_mfma_f32_16x16x32_bf16 v[132:135], a[164:167], v[32:35], v[132:135]
  s_add_u32 s41, s41, 8192
  v_exp_f32 v45, v29
  v_mfma_f32_16x16x32_bf16 v[136:139], a[168:171], v[32:35], v[136:139]
  ds_read_b64_tr_b16 a[134:135], v73 offset:40960
  v_cvt_pk_bf16_f32 v38, v44, v45
  v_mfma_f32_16x16x32_bf16 v[140:143], a[172:175], v[32:35], v[140:143]
  v_exp_f32 v46, v30
  v_mfma_f32_16x16x32_bf16 v[144:147], a[176:179], v[32:35], v[144:147]
  ds_read_b64_tr_b16 a[136:137], v74 offset:32768
  v_mfma_f32_16x16x32_bf16 v[148:151], a[180:183], v[32:35], v[148:151]
  v_exp_f32 v47, v31
  v_mfma_f32_16x16x32_bf16 v[152:155], a[184:187], v[32:35], v[152:155]
  ds_read_b64_tr_b16 a[138:139], v74 offset:40960
  v_cvt_pk_bf16_f32 v39, v46, v47
  v_mfma_f32_16x16x32_bf16 v[156:159], a[188:191], v[32:35], v[156:159]
  v_mfma_f32_16x16x32_bf16 v[24:27], a[96:99], a[48:51], v[64:67]
  s_add_u32 m0, s43, 18432
  v_exp_f32 v40, v16
  v_mfma_f32_16x16x32_bf16 v[24:27], a[100:103], a[52:55], v[24:27]
  buffer_load_dwordx4 v82, s[12:15], s42 offen lds
  v_mfma_f32_16x16x32_bf16 v[24:27], a[104:107], a[56:59], v[24:27]
  v_exp_f32 v41, v17
  v_mfma_f32_16x16x32_bf16 v[24:27], a[108:111], a[60:63], v[24:27]
  ds_read_b64_tr_b16 a[140:141], v75 offset:32768
  v_cvt_pk_bf16_f32 v32, v40, v41
  v_mfma_f32_16x16x32_bf16 v[28:31], a[112:115], a[48:51], v[64:67]
  v_exp_f32 v42, v18
  v_mfma_f32_16x16x32_bf16 v[28:31], a[116:119], a[52:55], v[28:31]
  buffer_load_dwordx4 v83, s[12:15], s42 offen offset:1024 lds
  v_mfma_f32_16x16x32_bf16 v[28:31], a[120:123], a[56:59], v[28:31]
  s_add_u32 s42, s42, 8192
  v_exp_f32 v43, v19
  v_mfma_f32_16x16x32_bf16 v[28:31], a[124:127], a[60:63], v[28:31]
  ds_read_b64_tr_b16 a[142:143], v75 offset:40960
  v_cvt_pk_bf16_f32 v33, v42, v43
  v_mfma_f32_16x16x32_bf16 v[48:51], v[8:11], v[36:39], v[48:51]
  v_exp_f32 v44, v20
  v_mfma_f32_16x16x32_bf16 v[160:163], a[160:163], v[36:39], v[160:163]
  ds_read_b64_tr_b16 a[144:145], v76 offset:32768
  v_mfma_f32_16x16x32_bf16 v[164:167], a[164:167], v[36:39], v[164:167]
  v_exp_f32 v45, v21
  v_mfma_f32_16x16x32_bf16 v[168:171], a[168:171], v[36:39], v[168:171]
  ds_read_b64_tr_b16 a[146:147], v76 offset:40960
  v_cvt_pk_bf16_f32 v34, v44, v45
  v_mfma_f32_16x16x32_bf16 v[172:175], a[172:175], v[36:39], v[172:175]
  v_exp_f32 v46, v22
  v_mfma_f32_16x16x32_bf16 v[176:179], a[176:179], v[36:39], v[176:179]
  ds_read_b64_tr_b16 a[148:149], v77 offset:32768
  v_mfma_f32_16x16x32_bf16 v[180:183], a[180:183], v[36:39], v[180:183]
  v_exp_f32 v47, v23
  v_mfma_f32_16x16x32_bf16 v[184:187], a[184:187], v[36:39], v[184:187]
  ds_read_b64_tr_b16 a[150:151], v77 offset:40960
  v_cvt_pk_bf16_f32 v35, v46, v47
  v_mfma_f32_16x16x32_bf16 v[188:191], a[188:191], v[36:39], v[188:191]
  v_mfma_f32_16x16x32_bf16 v[16:19], a[64:67], a[0:3], v[52:55]
  v_exp_f32 v40, v24
  v_mfma_f32_16x16x32_bf16 v[16:19], a[68:71], a[4:7], v[16:19]
  ds_read_b64_tr_b16 a[152:153], v78 offset:32768
  v_mfma_f32_16x16x32_bf16 v[16:19], a[72:75], a[8:11], v[16:19]
  v_exp_f32 v41, v25
  v_mfma_f32_16x16x32_bf16 v[16:19], a[76:79], a[12:15], v[16:19]
  ds_read_b64_tr_b16 a[154:155], v78 offset:40960
  v_cvt_pk_bf16_f32 v36, v40, v41
  v_mfma_f32_16x16x32_bf16 v[20:23], a[80:83], a[0:3], v[52:55]
  v_exp_f32 v42, v26
  v_mfma_f32_16x16x32_bf16 v[20:23], a[84:87], a[4:7], v[20:23]
  ds_read_b64_tr_b16 a[156:157], v79 offset:32768
  v_mfma_f32_16x16x32_bf16 v[20:23], a[88:91], a[8:11], v[20:23]
  v_exp_f32 v43, v27
  v_mfma_f32_16x16x32_bf16 v[20:23], a[92:95], a[12:15], v[20:23]
  ds_read_b64_tr_b16 a[158:159], v79 offset:40960
  v_cvt_pk_bf16_f32 v37, v42, v43
  v_mfma_f32_16x16x32_bf16 v[120:123], v[124:127], v[32:35], v[120:123]
  v_exp_f32 v44, v28
  v_mfma_f32_16x16x32_bf16 v[192:195], a[160:163], v[32:35], v[192:195]
  ds_read_b128 a[96:99], v68 offset:32768
  v_mfma_f32_16x16x32_bf16 v[196:199], a[164:167], v[32:35], v[196:199]
  v_exp_f32 v45, v29
  v_mfma_f32_16x16x32_bf16 v[200:203], a[168:171], v[32:35], v[200:203]
  ds_read_b128 a[100:103], v69 offset:32768
  v_cvt_pk_bf16_f32 v38, v44, v45
  v_mfma_f32_16x16x32_bf16 v[204:207], a[172:175], v[32:35], v[204:207]
  v_exp_f32 v46, v30
  v_mfma_f32_16x16x32_bf16 v[208:211], a[176:179], v[32:35], v[208:211]
  ds_read_b128 a[104:107], v70 offset:32768
  v_mfma_f32_16x16x32_bf16 v[212:215], a[180:183], v[32:35], v[212:215]
  v_exp_f32 v47, v31
  v_mfma_f32_16x16x32_bf16 v[216:219], a[184:187], v[32:35], v[216:219]
  ds_read_b128 a[108:111], v71 offset:32768
  v_cvt_pk_bf16_f32 v39, v46, v47
  v_mfma_f32_16x16x32_bf16 v[220:223], a[188:191], v[32:35], v[220:223]
  s_waitcnt vmcnt(8)
  v_add_u32 v2, s64, v15
  ds_read_b128 v[44:47], v2 offset:7168
  ds_read_b128 v[40:43], v2 offset:6144
  ds_read_b128 v[116:119], v2 offset:5120
  ds_read_b128 v[112:115], v2 offset:4096
  ds_read_b128 v[108:111], v2 offset:3072
  ds_read_b128 v[104:107], v2 offset:2048
  ds_read_b128 v[100:103], v2 offset:1024
  ds_read_b128 v[96:99], v2 offset:0
  v_mov_b32 v4, 0x40000000
  v_mov_b32 v5, 0x40000000
  v_mov_b32 v6, 0x40000000
  v_mov_b32 v7, 0x40000000
  buffer_store_dwordx4 v[4:7], v15, s[32:35], s94 offen sc1
  buffer_store_dwordx4 v[4:7], v15, s[32:35], s94 offen offset:1024 sc1
  s_mov_b32 s60, 0x3f803f80
  s_mov_b32 s61, 0x00010001
  s_waitcnt lgkmcnt(7)
  v_xor_b32 v44, s60, v44
  v_pk_min_u16 v44, v44, s61
  v_mov_b32 v4, v44
  v_xor_b32 v45, s60, v45
  v_pk_min_u16 v45, v45, s61
  v_mov_b32 v5, v45
  v_xor_b32 v46, s60, v46
  v_pk_min_u16 v46, v46, s61
  v_mov_b32 v6, v46
  v_xor_b32 v47, s60, v47
  v_pk_min_u16 v47, v47, s61
  v_mov_b32 v7, v47
  s_waitcnt lgkmcnt(6)
  v_xor_b32 v40, s60, v40
  v_pk_min_u16 v40, v40, s61
  v_lshl_or_b32 v4, v4, 1, v40
  v_xor_b32 v41, s60, v41
  v_pk_min_u16 v41, v41, s61
  v_lshl_or_b32 v5, v5, 1, v41
  v_xor_b32 v42, s60, v42
  v_pk_min_u16 v42, v42, s61
  v_lshl_or_b32 v6, v6, 1, v42
  v_xor_b32 v43, s60, v43
  v_pk_min_u16 v43, v43, s61
  v_lshl_or_b32 v7, v7, 1, v43
  s_waitcnt lgkmcnt(5)
  v_xor_b32 v116, s60, v116
  v_pk_min_u16 v116, v116, s61
  v_lshl_or_b32 v4, v4, 1, v116
  v_xor_b32 v117, s60, v117
  v_pk_min_u16 v117, v117, s61
  v_lshl_or_b32 v5, v5, 1, v117
  v_xor_b32 v118, s60, v118
  v_pk_min_u16 v118, v118, s61
  v_lshl_or_b32 v6, v6, 1, v118
  v_xor_b32 v119, s60, v119
  v_pk_min_u16 v119, v119, s61
  v_lshl_or_b32 v7, v7, 1, v119
  s_waitcnt lgkmcnt(4)
  v_xor_b32 v112, s60, v112
  v_pk_min_u16 v112, v112, s61
  v_lshl_or_b32 v4, v4, 1, v112
  v_xor_b32 v113, s60, v113
  v_pk_min_u16 v113, v113, s61
  v_lshl_or_b32 v5, v5, 1, v113
  v_xor_b32 v114, s60, v114
  v_pk_min_u16 v114, v114, s61
  v_lshl_or_b32 v6, v6, 1, v114
  v_xor_b32 v115, s60, v115
  v_pk_min_u16 v115, v115, s61
  v_lshl_or_b32 v7, v7, 1, v115
  s_waitcnt lgkmcnt(3)
  v_xor_b32 v108, s60, v108
  v_pk_min_u16 v108, v108, s61
  v_lshl_or_b32 v4, v4, 1, v108
  v_xor_b32 v109, s60, v109
  v_pk_min_u16 v109, v109, s61
  v_lshl_or_b32 v5, v5, 1, v109
  v_xor_b32 v110, s60, v110
  v_pk_min_u16 v110, v110, s61
  v_lshl_or_b32 v6, v6, 1, v110
  v_xor_b32 v111, s60, v111
  v_pk_min_u16 v111, v111, s61
  v_lshl_or_b32 v7, v7, 1, v111
  s_waitcnt lgkmcnt(2)
  v_xor_b32 v104, s60, v104
  v_pk_min_u16 v104, v104, s61
  v_lshl_or_b32 v4, v4, 1, v104
  v_xor_b32 v105, s60, v105
  v_pk_min_u16 v105, v105, s61
  v_lshl_or_b32 v5, v5, 1, v105
  v_xor_b32 v106, s60, v106
  v_pk_min_u16 v106, v106, s61
  v_lshl_or_b32 v6, v6, 1, v106
  v_xor_b32 v107, s60, v107
  v_pk_min_u16 v107, v107, s61
  v_lshl_or_b32 v7, v7, 1, v107
  s_waitcnt lgkmcnt(1)
  v_xor_b32 v100, s60, v100
  v_pk_min_u16 v100, v100, s61
  v_lshl_or_b32 v4, v4, 1, v100
  v_xor_b32 v101, s60, v101
  v_pk_min_u16 v101, v101, s61
  v_lshl_or_b32 v5, v5, 1, v101
  v_xor_b32 v102, s60, v102
  v_pk_min_u16 v102, v102, s61
  v_lshl_or_b32 v6, v6, 1, v102
  v_xor_b32 v103, s60, v103
  v_pk_min_u16 v103, v103, s61
  v_lshl_or_b32 v7, v7, 1, v103
  s_waitcnt lgkmcnt(0)
  v_xor_b32 v96, s60, v96
  v_pk_min_u16 v96, v96, s61
  v_lshl_or_b32 v4, v4, 1, v96
  v_xor_b32 v97, s60, v97
  v_pk_min_u16 v97, v97, s61
  v_lshl_or_b32 v5, v5, 1, v97
  v_xor_b32 v98, s60, v98
  v_pk_min_u16 v98, v98, s61
  v_lshl_or_b32 v6, v6, 1, v98
  v_xor_b32 v99, s60, v99
  v_pk_min_u16 v99, v99, s61
  v_lshl_or_b32 v7, v7, 1, v99
  v_xor_b32 v4, 0x00ff00ff, v4
  v_xor_b32 v5, 0x00ff00ff, v5
  v_xor_b32 v6, 0x00ff00ff, v6
  v_xor_b32 v7, 0x00ff00ff, v7
  s_lshl_b32 s60, s40, 17
  v_lshl_add_u32 v3, v1, 11, s60
  v_and_b32 v12, 0xff, v4
  v_cmp_ne_u32 s[76:77], 0, v12
  v_or_b32 v112, v3, v12
  v_add_u32 v3, 256, v3
  v_lshrrev_b32 v12, 16, v4
  v_cmp_ne_u32 s[78:79], 0, v12
  v_or_b32 v113, v3, v12
  v_add_u32 v3, 256, v3
  v_and_b32 v12, 0xff, v5
  v_cmp_ne_u32 s[80:81], 0, v12
  v_or_b32 v114, v3, v12
  v_add_u32 v3, 256, v3
  v_lshrrev_b32 v12, 16, v5
  v_cmp_ne_u32 s[82:83], 0, v12
  v_or_b32 v115, v3, v12
  v_add_u32 v3, 256, v3
  v_and_b32 v12, 0xff, v6
  v_cmp_ne_u32 s[84:85], 0, v12
  v_or_b32 v116, v3, v12
  v_add_u32 v3, 256, v3
  v_lshrrev_b32 v12, 16, v6
  v_cmp_ne_u32 s[86:87], 0, v12
  v_or_b32 v117, v3, v12
  v_add_u32 v3, 256, v3
  v_and_b32 v12, 0xff, v7
  v_cmp_ne_u32 s[88:89], 0, v12
  v_or_b32 v118, v3, v12
  v_add_u32 v3, 256, v3
  v_lshrrev_b32 v12, 16, v7
  v_cmp_ne_u32 s[90:91], 0, v12
  v_or_b32 v119, v3, v12
  s_mov_b32 s60, 0
  s_bcnt1_i32_b64 s61, s[76:77]
  s_add_u32 s60, s60, s61
  s_bcnt1_i32_b64 s61, s[78:79]
  s_add_u32 s60, s60, s61
  s_bcnt1_i32_b64 s61, s[80:81]
  s_add_u32 s60, s60, s61
  s_bcnt1_i32_b64 s61, s[82:83]
  s_add_u32 s60, s60, s61
  s_bcnt1_i32_b64 s61, s[84:85]
  s_add_u32 s60, s60, s61
  s_bcnt1_i32_b64 s61, s[86:87]
  s_add_u32 s60, s60, s61
  s_bcnt1_i32_b64 s61, s[88:89]
  s_add_u32 s60, s60, s61
  s_bcnt1_i32_b64 s61, s[90:91]
  s_add_u32 s60, s60, s61
  v_mov_b32 v12, s60
  s_lshl_b32 s61, s40, 2
  s_add_u32 s61, s61, 155904
  v_mov_b32 v14, s61
  ds_write_b32 v14, v12
  v_mov_b32 v13, 0
  v_mbcnt_lo_u32_b32 v13, s76, v13
  v_mbcnt_hi_u32_b32 v13, s77, v13
  v_mbcnt_lo_u32_b32 v13, s78, v13
  v_mbcnt_hi_u32_b32 v13, s79, v13
  v_mbcnt_lo_u32_b32 v13, s80, v13
  v_mbcnt_hi_u32_b32 v13, s81, v13
  v_mbcnt_lo_u32_b32 v13, s82, v13
  v_mbcnt_hi_u32_b32 v13, s83, v13
  v_mbcnt_lo_u32_b32 v13, s84, v13
  v_mbcnt_hi_u32_b32 v13, s85, v13
  v_mbcnt_lo_u32_b32 v13, s86, v13
  v_mbcnt_hi_u32_b32 v13, s87, v13
  v_mbcnt_lo_u32_b32 v13, s88, v13
  v_mbcnt_hi_u32_b32 v13, s89, v13
  v_mbcnt_lo_u32_b32 v13, s90, v13
  v_mbcnt_hi_u32_b32 v13, s91, v13
  v_mov_b32 v14, 155904
  s_waitcnt lgkmcnt(0)
  s_barrier
  ds_read_b128 v[96:99], v14
  v_and_b32 v2, 15, v1
  v_lshrrev_b32 v3, 4, v1
  v_add_u32 v4, 0, v3
  v_xor_b32 v4, v2, v4
  v_lshlrev_b32 v4, 4, v4
  v_subrev_u32 v100, 0, v4
  v_add_u32 v4, 4, v3
  v_xor_b32 v4, v2, v4
  v_lshlrev_b32 v4, 4, v4
  v_subrev_u32 v101, 1024, v4
  v_add_u32 v4, 8, v3
  v_xor_b32 v4, v2, v4
  v_lshlrev_b32 v4, 4, v4
  v_subrev_u32 v102, 2048, v4
  v_add_u32 v4, 12, v3
  v_xor_b32 v4, v2, v4
  v_lshlrev_b32 v4, 4, v4
  v_subrev_u32 v103, 3072, v4
  v_and_b32 v40, 7, v2
  v_lshlrev_b32 v41, 2, v3
  v_add_u32 v41, 147456, v41
  v_lshlrev_b32 v42, 4, v3
  v_add_u32 v42, 147456, v42
  s_waitcnt lgkmcnt(0)
  v_readfirstlane_b32 s56, v96
  v_readfirstlane_b32 s57, v97
  v_readfirstlane_b32 s58, v98
  v_readfirstlane_b32 s59, v99
  v_mov_b32 v12, 0x40000000
  s_nop 2
  s_add_u32 s60, s56, s57
  s_add_u32 s61, s60, s58
  s_add_u32 s62, s61, s59
  s_mov_b32 s63, 0
  s_cmp_eq_u32 s40, 1
  s_cselect_b32 s63, s56, s63
  s_cmp_eq_u32 s40, 2
  s_cselect_b32 s63, s60, s63
  s_cmp_eq_u32 s40, 3
  s_cselect_b32 s63, s61, s63
  v_add_u32 v13, s63, v13
  v_lshlrev_b32 v13, 2, v13
  v_add_u32 v13, 147456, v13
  s_mov_b64 exec, s[76:77]
  ds_write_b32 v13, v112
  v_add_u32 v13, 4, v13
  s_mov_b64 exec, s[78:79]
  ds_write_b32 v13, v113
  v_add_u32 v13, 4, v13
  s_mov_b64 exec, s[80:81]
  ds_write_b32 v13, v114
  v_add_u32 v13, 4, v13
  s_mov_b64 exec, s[82:83]
  ds_write_b32 v13, v115
  v_add_u32 v13, 4, v13
  s_mov_b64 exec, s[84:85]
  ds_write_b32 v13, v116
  v_add_u32 v13, 4, v13
  s_mov_b64 exec, s[86:87]
  ds_write_b32 v13, v117
  v_add_u32 v13, 4, v13
  s_mov_b64 exec, s[88:89]
  ds_write_b32 v13, v118
  v_add_u32 v13, 4, v13
  s_mov_b64 exec, s[90:91]
  ds_write_b32 v13, v119
  v_add_u32 v13, 4, v13
  s_mov_b64 exec, -1
  v_add_u32 v14, s62, v1
  v_lshlrev_b32 v14, 2, v14
  v_add_u32 v14, 147456, v14
  ds_write_b32 v14, v12
  s_add_u32 s62, s62, 31
  s_lshr_b32 s62, s62, 5
  s_and_b32 s60, s2, 3
  s_mul_i32 s60, s60, 7
  s_lshl_b32 s92, s62, s60
  s_or_b32 s92, s92, 0x10000000
  s_mov_b32 s59, 0xffffff00
  s_mov_b32 s58, 0x0000ffff
  s_mul_i32 s60, s2, 3072
  s_add_u32 s60, s60, 524288
  s_mov_b32 s67, s40
  s_waitcnt lgkmcnt(0)
  s_barrier
L_rec:
  s_cmp_ge_u32 s67, s62
  s_cbranch_scc1 L_rec_done
  s_lshl_b32 s61, s67, 7
  v_add_u32 v4, s61, v41
  v_add_u32 v5, s61, v42
  ds_read2_b32 v[104:105], v4 offset0:0 offset1:4
  ds_read2_b32 v[106:107], v4 offset0:8 offset1:12
  ds_read2_b32 v[108:109], v4 offset0:16 offset1:20
  ds_read2_b32 v[110:111], v4 offset0:24 offset1:28
  ds_read_b128 v[112:115], v5
  ds_read_b128 v[116:119], v5 offset:64
  s_waitcnt lgkmcnt(2)
  v_and_b32 v104, s59, v104
  v_add_u32 v104, v104, v100
  v_and_b32 v105, s59, v105
  v_add_u32 v105, v105, v101
  v_and_b32 v106, s59, v106
  v_add_u32 v106, v106, v102
  v_and_b32 v107, s59, v107
  v_add_u32 v107, v107, v103
  v_and_b32 v108, s59, v108
  v_add_u32 v108, v108, v100
  v_and_b32 v109, s59, v109
  v_add_u32 v109, v109, v101
  v_and_b32 v110, s59, v110
  v_add_u32 v110, v110, v102
  v_and_b32 v111, s59, v111
  v_add_u32 v111, v111, v103
  s_waitcnt lgkmcnt(0)
  v_bfe_i32 v112, v112, v40, 1
  v_bfe_i32 v113, v113, v40, 1
  v_bfe_i32 v114, v114, v40, 1
  v_bfe_i32 v115, v115, v40, 1
  v_bfe_i32 v116, v116, v40, 1
  v_bfe_i32 v117, v117, v40, 1
  v_bfe_i32 v118, v118, v40, 1
  v_bfe_i32 v119, v119, v40, 1
  v_bfi_b32 v96, s58, v112, v113
  v_bfi_b32 v97, s58, v114, v115
  v_bfi_b32 v98, s58, v116, v117
  v_bfi_b32 v99, s58, v118, v119
  s_mul_i32 s61, s67, 786432
  s_add_u32 s61, s61, s60
  buffer_store_dwordx4 v[104:107], v15, s[32:35], s61 offen sc1
  buffer_store_dwordx4 v[108:111], v15, s[32:35], s61 offen offset:1024 sc1
  buffer_store_dwordx4 v[96:99], v15, s[32:35], s61 offen offset:2048 sc1
  s_add_u32 s67, s67, 4
  s_cmp_ge_u32 s67, s62
  s_cbranch_scc1 L_rec_done
  s_waitcnt vmcnt(0)
  s_branch L_rec
L_rec_done:
.p2align 3
  v_mfma_f32_16x16x32_bf16 v[24:27], a[64:67], a[16:19], v[56:59]
  v_exp_f32 v40, v16
  v_mfma_f32_16x16x32_bf16 v[24:27], a[68:71], a[20:23], v[24:27]
  ds_read_b128 a[112:115], v68 offset:40960
  v_mfma_f32_16x16x32_bf16 v[24:27], a[72:75], a[24:27], v[24:27]
  v_exp_f32 v41, v17
  v_mfma_f32_16x16x32_bf16 v[24:27], a[76:79], a[28:31], v[24:27]
  ds_read_b128 a[116:119], v69 offset:40960
  v_cvt_pk_bf16_f32 v32, v40, v41
  v_mfma_f32_16x16x32_bf16 v[28:31], a[80:83], a[16:19], v[56:59]
  v_exp_f32 v42, v18
  v_mfma_f32_16x16x32_bf16 v[28:31], a[84:87], a[20:23], v[28:31]
  ds_read_b128 a[120:123], v70 offset:40960
  v_mfma_f32_16x16x32_bf16 v[28:31], a[88:91], a[24:27], v[28:31]
  v_exp_f32 v43, v19
  v_mfma_f32_16x16x32_bf16 v[28:31], a[92:95], a[28:31], v[28:31]
  ds_read_b128 a[124:127], v71 offset:40960
  v_cvt_pk_bf16_f32 v33, v42, v43
  v_mfma_f32_16x16x32_bf16 v[120:123], v[8:11], v[36:39], v[120:123]
  v_exp_f32 v44, v20
  v_mfma_f32_16x16x32_bf16 v[224:227], a[160:163], v[36:39], v[224:227]
  v_mfma_f32_16x16x32_bf16 v[228:231], a[164:167], v[36:39], v[228:231]
  v_exp_f32 v45, v21
  v_mfma_f32_16x16x32_bf16 v[232:235], a[168:171], v[36:39], v[232:235]
  v_cvt_pk_bf16_f32 v34, v44, v45
  v_mfma_f32_16x16x32_bf16 v[236:239], a[172:175], v[36:39], v[236:239]
  v_exp_f32 v46, v22
  v_mfma_f32_16x16x32_bf16 v[240:243], a[176:179], v[36:39], v[240:243]
  v_mfma_f32_16x16x32_bf16 v[244:247], a[180:183], v[36:39], v[244:247]
  s_waitcnt vmcnt(18) lgkmcnt(0)
  v_exp_f32 v47, v23
  v_mfma_f32_16x16x32_bf16 v[248:251], a[184:187], v[36:39], v[248:251]
  v_cvt_pk_bf16_f32 v35, v46, v47
  v_mfma_f32_16x16x32_bf16 v[252:255], a[188:191], v[36:39], v[252:255]
  s_barrier
  v_mfma_f32_16x16x32_bf16 v[16:19], a[64:67], a[32:35], v[60:63]
  v_exp_f32 v40, v24
  v_mfma_f32_16x16x32_bf16 v[16:19], a[68:71], a[36:39], v[16:19]
  ds_read_b64_tr_b16 a[160:161], v72 offset:49152
  v_mfma_f32_16x16x32_bf16 v[16:19], a[72:75], a[40:43], v[16:19]
  s_add_u32 m0, s43, 32768
  v_exp_f32 v41, v25
  v_mfma_f32_16x16x32_bf16 v[16:19], a[76:79], a[44:47], v[16:19]
  ds_read_b64_tr_b16 a[162:163], v72 offset:57344
  v_cvt_pk_bf16_f32 v36, v40, v41
  v_mfma_f32_16x16x32_bf16 v[20:23], a[80:83], a[32:35], v[60:63]
  v_exp_f32 v42, v26
  v_mfma_f32_16x16x32_bf16 v[20:23], a[84:87], a[36:39], v[20:23]
  buffer_load_dwordx4 v80, s[8:11], s41 offen lds
  v_mfma_f32_16x16x32_bf16 v[20:23], a[88:91], a[40:43], v[20:23]
  v_exp_f32 v43, v27
  v_mfma_f32_16x16x32_bf16 v[20:23], a[92:95], a[44:47], v[20:23]
  ds_read_b64_tr_b16 a[164:165], v73 offset:49152
  v_cvt_pk_bf16_f32 v37, v42, v43
  v_mfma_f32_16x16x32_bf16 v[48:51], v[124:127], v[32:35], v[48:51]
  v_exp_f32 v44, v28
  v_mfma_f32_16x16x32_bf16 v[128:131], a[128:131], v[32:35], v[128:131]
  buffer_load_dwordx4 v81, s[8:11], s41 offen offset:1024 lds
  v_mfma_f32_16x16x32_bf16 v[132:135], a[132:135], v[32:35], v[132:135]
  s_add_u32 s41, s41, 8192
  v_exp_f32 v45, v29
  v_mfma_f32_16x16x32_bf16 v[136:139], a[136:139], v[32:35], v[136:139]
  ds_read_b64_tr_b16 a[166:167], v73 offset:57344
  v_cvt_pk_bf16_f32 v38, v44, v45
  v_mfma_f32_16x16x32_bf16 v[140:143], a[140:143], v[32:35], v[140:143]
  v_exp_f32 v46, v30
  v_mfma_f32_16x16x32_bf16 v[144:147], a[144:147], v[32:35], v[144:147]
  ds_read_b64_tr_b16 a[168:169], v74 offset:49152
  v_mfma_f32_16x16x32_bf16 v[148:151], a[148:151], v[32:35], v[148:151]
  v_exp_f32 v47, v31
  v_mfma_f32_16x16x32_bf16 v[152:155], a[152:155], v[32:35], v[152:155]
  ds_read_b64_tr_b16 a[170:171], v74 offset:57344
  v_cvt_pk_bf16_f32 v39, v46, v47
  v_mfma_f32_16x16x32_bf16 v[156:159], a[156:159], v[32:35], v[156:159]
  v_mfma_f32_16x16x32_bf16 v[24:27], a[64:67], a[48:51], v[64:67]
  s_add_u32 m0, s43, 34816
  v_exp_f32 v40, v16
  v_mfma_f32_16x16x32_bf16 v[24:27], a[68:71], a[52:55], v[24:27]
  buffer_load_dwordx4 v82, s[12:15], s42 offen lds
  v_mfma_f32_16x16x32_bf16 v[24:27], a[72:75], a[56:59], v[24:27]
  v_exp_f32 v41, v17
  v_mfma_f32_16x16x32_bf16 v[24:27], a[76:79], a[60:63], v[24:27]
  ds_read_b64_tr_b16 a[172:173], v75 offset:49152
  v_cvt_pk_bf16_f32 v32, v40, v41
  v_mfma_f32_16x16x32_bf16 v[28:31], a[80:83], a[48:51], v[64:67]
  v_exp_f32 v42, v18
  v_mfma_f32_16x16x32_bf16 v[28:31], a[84:87], a[52:55], v[28:31]
  buffer_load_dwordx4 v83, s[12:15], s42 offen offset:1024 lds
  v_mfma_f32_16x16x32_bf16 v[28:31], a[88:91], a[56:59], v[28:31]
  s_add_u32 s42, s42, 8192
  v_exp_f32 v43, v19
  v_mfma_f32_16x16x32_bf16 v[28:31], a[92:95], a[60:63], v[28:31]
  ds_read_b64_tr_b16 a[174:175], v75 offset:57344
  v_cvt_pk_bf16_f32 v33, v42, v43
  v_mfma_f32_16x16x32_bf16 v[48:51], v[8:11], v[36:39], v[48:51]
  v_exp_f32 v44, v20
  v_mfma_f32_16x16x32_bf16 v[160:163], a[128:131], v[36:39], v[160:163]
  ds_read_b64_tr_b16 a[176:177], v76 offset:49152
  v_mfma_f32_16x16x32_bf16 v[164:167], a[132:135], v[36:39], v[164:167]
  v_exp_f32 v45, v21
  v_mfma_f32_16x16x32_bf16 v[168:171], a[136:139], v[36:39], v[168:171]
  ds_read_b64_tr_b16 a[178:179], v76 offset:57344
  v_cvt_pk_bf16_f32 v34, v44, v45
  v_mfma_f32_16x16x32_bf16 v[172:175], a[140:143], v[36:39], v[172:175]
  v_exp_f32 v46, v22
  v_mfma_f32_16x16x32_bf16 v[176:179], a[144:147], v[36:39], v[176:179]
  ds_read_b64_tr_b16 a[180:181], v77 offset:49152
  v_mfma_f32_16x16x32_bf16 v[180:183], a[148:151], v[36:39], v[180:183]
  v_exp_f32 v47, v23
  v_mfma_f32_16x16x32_bf16 v[184:187], a[152:155], v[36:39], v[184:187]
  ds_read_b64_tr_b16 a[182:183], v77 offset:57344
  v_cvt_pk_bf16_f32 v35, v46, v47
  v_mfma_f32_16x16x32_bf16 v[188:191], a[156:159], v[36:39], v[188:191]
  v_mfma_f32_16x16x32_bf16 v[16:19], a[96:99], a[0:3], v[52:55]
  v_exp_f32 v40, v24
  v_mfma_f32_16x16x32_bf16 v[16:19], a[100:103], a[4:7], v[16:19]
  ds_read_b64_tr_b16 a[184:185], v78 offset:49152
  v_mfma_f32_16x16x32_bf16 v[16:19], a[104:107], a[8:11], v[16:19]
  v_exp_f32 v41, v25
  v_mfma_f32_16x16x32_bf16 v[16:19], a[108:111], a[12:15], v[16:19]
  ds_read_b64_tr_b16 a[186:187], v78 offset:57344
  v_cvt_pk_bf16_f32 v36, v40, v41
  v_mfma_f32_16x16x32_bf16 v[20:23], a[112:115], a[0:3], v[52:55]
  v_exp_f32 v42, v26
  v_mfma_f32_16x16x32_bf16 v[20:23], a[116:119], a[4:7], v[20:23]
  ds_read_b64_tr_b16 a[188:189], v79 offset:49152
  v_mfma_f32_16x16x32_bf16 v[20:23], a[120:123], a[8:11], v[20:23]
  v_exp_f32 v43, v27
  v_mfma_f32_16x16x32_bf16 v[20:23], a[124:127], a[12:15], v[20:23]
  ds_read_b64_tr_b16 a[190:191], v79 offset:57344
  v_cvt_pk_bf16_f32 v37, v42, v43
  v_mfma_f32_16x16x32_bf16 v[120:123], v[124:127], v[32:35], v[120:123]
  v_exp_f32 v44, v28
  v_mfma_f32_16x16x32_bf16 v[192:195], a[128:131], v[32:35], v[192:195]
  ds_read_b128 a[64:67], v68 offset:49152
  v_mfma_f32_16x16x32_bf16 v[196:199], a[132:135], v[32:35], v[196:199]
  v_exp_f32 v45, v29
  v_mfma_f32_16x16x32_bf16 v[200:203], a[136:139], v[32:35], v[200:203]
  ds_read_b128 a[68:71], v69 offset:49152
  v_cvt_pk_bf16_f32 v38, v44, v45
  v_mfma_f32_16x16x32_bf16 v[204:207], a[140:143], v[32:35], v[204:207]
  v_exp_f32 v46, v30
  v_mfma_f32_16x16x32_bf16 v[208:211], a[144:147], v[32:35], v[208:211]
  ds_read_b128 a[72:75], v70 offset:49152
  v_mfma_f32_16x16x32_bf16 v[212:215], a[148:151], v[32:35], v[212:215]
  v_exp_f32 v47, v31
  v_mfma_f32_16x16x32_bf16 v[216:219], a[152:155], v[32:35], v[216:219]
  ds_read_b128 a[76:79], v71 offset:49152
  v_cvt_pk_bf16_f32 v39, v46, v47
  v_mfma_f32_16x16x32_bf16 v[220:223], a[156:159], v[32:35], v[220:223]
  v_mfma_f32_16x16x32_bf16 v[24:27], a[96:99], a[16:19], v[56:59]
  v_exp_f32 v40, v16
  v_mfma_f32_16x16x32_bf16 v[24:27], a[100:103], a[20:23], v[24:27]
  ds_read_b128 a[80:83], v68 offset:57344
  v_mfma_f32_16x16x32_bf16 v[24:27], a[104:107], a[24:27], v[24:27]
  v_exp_f32 v41, v17
  v_mfma_f32_16x16x32_bf16 v[24:27], a[108:111], a[28:31], v[24:27]
  ds_read_b128 a[84:87], v69 offset:57344
  v_cvt_pk_bf16_f32 v32, v40, v41
  v_mfma_f32_16x16x32_bf16 v[28:31], a[112:115], a[16:19], v[56:59]
  v_exp_f32 v42, v18
  v_mfma_f32_16x16x32_bf16 v[28:31], a[116:119], a[20:23], v[28:31]
  ds_read_b128 a[88:91], v70 offset:57344
  v_mfma_f32_16x16x32_bf16 v[28:31], a[120:123], a[24:27], v[28:31]
  v_exp_f32 v43, v19
  v_mfma_f32_16x16x32_bf16 v[28:31], a[124:127], a[28:31], v[28:31]
  ds_read_b128 a[92:95], v71 offset:57344
  v_cvt_pk_bf16_f32 v33, v42, v43
  v_mfma_f32_16x16x32_bf16 v[120:123], v[8:11], v[36:39], v[120:123]
  v_exp_f32 v44, v20
  v_mfma_f32_16x16x32_bf16 v[224:227], a[128:131], v[36:39], v[224:227]
  v_mfma_f32_16x16x32_bf16 v[228:231], a[132:135], v[36:39], v[228:231]
  v_exp_f32 v45, v21
  v_mfma_f32_16x16x32_bf16 v[232:235], a[136:139], v[36:39], v[232:235]
  v_cvt_pk_bf16_f32 v34, v44, v45
  v_mfma_f32_16x16x32_bf16 v[236:239], a[140:143], v[36:39], v[236:239]
  v_exp_f32 v46, v22
  v_mfma_f32_16x16x32_bf16 v[240:243], a[144:147], v[36:39], v[240:243]
  v_mfma_f32_16x16x32_bf16 v[244:247], a[148:151], v[36:39], v[244:247]
  s_waitcnt vmcnt(10) lgkmcnt(0)
  v_exp_f32 v47, v23
  v_mfma_f32_16x16x32_bf16 v[248:251], a[152:155], v[36:39], v[248:251]
  v_cvt_pk_bf16_f32 v35, v46, v47
  v_mfma_f32_16x16x32_bf16 v[252:255], a[156:159], v[36:39], v[252:255]
  s_barrier
  v_mfma_f32_16x16x32_bf16 v[16:19], a[96:99], a[32:35], v[60:63]
  v_exp_f32 v40, v24
  v_mfma_f32_16x16x32_bf16 v[16:19], a[100:103], a[36:39], v[16:19]
  ds_read_b64_tr_b16 a[128:129], v72 offset:0
  v_mfma_f32_16x16x32_bf16 v[16:19], a[104:107], a[40:43], v[16:19]
  s_add_u32 m0, s43, 49152
  v_exp_f32 v41, v25
  v_mfma_f32_16x16x32_bf16 v[16:19], a[108:111], a[44:47], v[16:19]
  ds_read_b64_tr_b16 a[130:131], v72 offset:8192
  v_cvt_pk_bf16_f32 v36, v40, v41
  v_mfma_f32_16x16x32_bf16 v[20:23], a[112:115], a[32:35], v[60:63]
  v_exp_f32 v42, v26
  v_mfma_f32_16x16x32_bf16 v[20:23], a[116:119], a[36:39], v[20:23]
  buffer_load_dwordx4 v80, s[8:11], s41 offen lds
  v_mfma_f32_16x16x32_bf16 v[20:23], a[120:123], a[40:43], v[20:23]
  v_exp_f32 v43, v27
  v_mfma_f32_16x16x32_bf16 v[20:23], a[124:127], a[44:47], v[20:23]
  ds_read_b64_tr_b16 a[132:133], v73 offset:0
  v_cvt_pk_bf16_f32 v37, v42, v43
  v_mfma_f32_16x16x32_bf16 v[48:51], v[124:127], v[32:35], v[48:51]
  v_exp_f32 v44, v28
  v_mfma_f32_16x16x32_bf16 v[128:131], a[160:163], v[32:35], v[128:131]
  buffer_load_dwordx4 v81, s[8:11], s41 offen offset:1024 lds
  v_mfma_f32_16x16x32_bf16 v[132:135], a[164:167], v[32:35], v[132:135]
  s_add_u32 s41, s41, 8192
  v_exp_f32 v45, v29
  v_mfma_f32_16x16x32_bf16 v[136:139], a[168:171], v[32:35], v[136:139]
  ds_read_b64_tr_b16 a[134:135], v73 offset:8192
  v_cvt_pk_bf16_f32 v38, v44, v45
  v_mfma_f32_16x16x32_bf16 v[140:143], a[172:175], v[32:35], v[140:143]
  v_exp_f32 v46, v30
  v_mfma_f32_16x16x32_bf16 v[144:147], a[176:179], v[32:35], v[144:147]
  ds_read_b64_tr_b16 a[136:137], v74 offset:0
  v_mfma_f32_16x16x32_bf16 v[148:151], a[180:183], v[32:35], v[148:151]
  v_exp_f32 v47, v31
  v_mfma_f32_16x16x32_bf16 v[152:155], a[184:187], v[32:35], v[152:155]
  ds_read_b64_tr_b16 a[138:139], v74 offset:8192
  v_cvt_pk_bf16_f32 v39, v46, v47
  v_mfma_f32_16x16x32_bf16 v[156:159], a[188:191], v[32:35], v[156:159]
  v_mfma_f32_16x16x32_bf16 v[24:27], a[96:99], a[48:51], v[64:67]
  s_add_u32 m0, s43, 51200
  v_exp_f32 v40, v16
  v_mfma_f32_16x16x32_bf16 v[24:27], a[100:103], a[52:55], v[24:27]
  buffer_load_dwordx4 v82, s[12:15], s42 offen lds
  v_mfma_f32_16x16x32_bf16 v[24:27], a[104:107], a[56:59], v[24:27]
  v_exp_f32 v41, v17
  v_mfma_f32_16x16x32_bf16 v[24:27], a[108:111], a[60:63], v[24:27]
  ds_read_b64_tr_b16 a[140:141], v75 offset:0
  v_cvt_pk_bf16_f32 v32, v40, v41
  v_mfma_f32_16x16x32_bf16 v[28:31], a[112:115], a[48:51], v[64:67]
  v_exp_f32 v42, v18
  v_mfma_f32_16x16x32_bf16 v[28:31], a[116:119], a[52:55], v[28:31]
  buffer_load_dwordx4 v83, s[12:15], s42 offen offset:1024 lds
  v_mfma_f32_16x16x32_bf16 v[28:31], a[120:123], a[56:59], v[28:31]
  s_add_u32 s42, s42, 8192
  v_exp_f32 v43, v19
  v_mfma_f32_16x16x32_bf16 v[28:31], a[124:127], a[60:63], v[28:31]
  ds_read_b64_tr_b16 a[142:143], v75 offset:8192
  v_cvt_pk_bf16_f32 v33, v42, v43
  v_mfma_f32_16x16x32_bf16 v[48:51], v[8:11], v[36:39], v[48:51]
  v_exp_f32 v44, v20
  v_mfma_f32_16x16x32_bf16 v[160:163], a[160:163], v[36:39], v[160:163]
  ds_read_b64_tr_b16 a[144:145], v76 offset:0
  v_mfma_f32_16x16x32_bf16 v[164:167], a[164:167], v[36:39], v[164:167]
  v_exp_f32 v45, v21
  v_mfma_f32_16x16x32_bf16 v[168:171], a[168:171], v[36:39], v[168:171]
  ds_read_b64_tr_b16 a[146:147], v76 offset:8192
  v_cvt_pk_bf16_f32 v34, v44, v45
  v_mfma_f32_16x16x32_bf16 v[172:175], a[172:175], v[36:39], v[172:175]
  v_exp_f32 v46, v22
  v_mfma_f32_16x16x32_bf16 v[176:179], a[176:179], v[36:39], v[176:179]
  ds_read_b64_tr_b16 a[148:149], v77 offset:0
  v_mfma_f32_16x16x32_bf16 v[180:183], a[180:183], v[36:39], v[180:183]
  v_exp_f32 v47, v23
  v_mfma_f32_16x16x32_bf16 v[184:187], a[184:187], v[36:39], v[184:187]
  ds_read_b64_tr_b16 a[150:151], v77 offset:8192
  v_cvt_pk_bf16_f32 v35, v46, v47
  v_mfma_f32_16x16x32_bf16 v[188:191], a[188:191], v[36:39], v[188:191]
  v_mfma_f32_16x16x32_bf16 v[16:19], a[64:67], a[0:3], v[52:55]
  v_exp_f32 v40, v24
  v_mfma_f32_16x16x32_bf16 v[16:19], a[68:71], a[4:7], v[16:19]
  ds_read_b64_tr_b16 a[152:153], v78 offset:0
  v_mfma_f32_16x16x32_bf16 v[16:19], a[72:75], a[8:11], v[16:19]
  v_exp_f32 v41, v25
  v_mfma_f32_16x16x32_bf16 v[16:19], a[76:79], a[12:15], v[16:19]
  ds_read_b64_tr_b16 a[154:155], v78 offset:8192
  v_cvt_pk_bf16_f32 v36, v40, v41
  v_mfma_f32_16x16x32_bf16 v[20:23], a[80:83], a[0:3], v[52:55]
  v_exp_f32 v42, v26
  v_mfma_f32_16x16x32_bf16 v[20:23], a[84:87], a[4:7], v[20:23]
  ds_read_b64_tr_b16 a[156:157], v79 offset:0
  v_mfma_f32_16x16x32_bf16 v[20:23], a[88:91], a[8:11], v[20:23]
  v_exp_f32 v43, v27
  v_mfma_f32_16x16x32_bf16 v[20:23], a[92:95], a[12:15], v[20:23]
  ds_read_b64_tr_b16 a[158:159], v79 offset:8192
  v_cvt_pk_bf16_f32 v37, v42, v43
  v_mfma_f32_16x16x32_bf16 v[120:123], v[124:127], v[32:35], v[120:123]
  v_exp_f32 v44, v28
  v_mfma_f32_16x16x32_bf16 v[192:195], a[160:163], v[32:35], v[192:195]
  ds_read_b128 a[96:99], v68 offset:0
  v_mfma_f32_16x16x32_bf16 v[196:199], a[164:167], v[32:35], v[196:199]
  v_exp_f32 v45, v29
  v_mfma_f32_16x16x32_bf16 v[200:203], a[168:171], v[32:35], v[200:203]
  ds_read_b128 a[100:103], v69 offset:0
  v_cvt_pk_bf16_f32 v38, v44, v45
  v_mfma_f32_16x16x32_bf16 v[204:207], a[172:175], v[32:35], v[204:207]
  v_exp_f32 v46, v30
  v_mfma_f32_16x16x32_bf16 v[208:211], a[176:179], v[32:35], v[208:211]
  ds_read_b128 a[104:107], v70 offset:0
  v_mfma_f32_16x16x32_bf16 v[212:215], a[180:183], v[32:35], v[212:215]
  v_exp_f32 v47, v31
  v_mfma_f32_16x16x32_bf16 v[216:219], a[184:187], v[32:35], v[216:219]
  ds_read_b128 a[108:111], v71 offset:0
  v_cvt_pk_bf16_f32 v39, v46, v47
  v_mfma_f32_16x16x32_bf16 v[220:223], a[188:191], v[32:35], v[220:223]
  v_mfma_f32_16x16x32_bf16 v[24:27], a[64:67], a[16:19], v[56:59]
  v_exp_f32 v40, v16
  v_mfma_f32_16x16x32_bf16 v[24:27], a[68:71], a[20:23], v[24:27]
  ds_read_b128 a[112:115], v68 offset:8192
  v_mfma_f32_16x16x32_bf16 v[24:27], a[72:75], a[24:27], v[24:27]
  v_exp_f32 v41, v17
  v_mfma_f32_16x16x32_bf16 v[24:27], a[76:79], a[28:31], v[24:27]
  ds_read_b128 a[116:119], v69 offset:8192
  v_cvt_pk_bf16_f32 v32, v40, v41
  v_mfma_f32_16x16x32_bf16 v[28:31], a[80:83], a[16:19], v[56:59]
  v_exp_f32 v42, v18
  v_mfma_f32_16x16x32_bf16 v[28:31], a[84:87], a[20:23], v[28:31]
  ds_read_b128 a[120:123], v70 offset:8192
  v_mfma_f32_16x16x32_bf16 v[28:31], a[88:91], a[24:27], v[28:31]
  v_exp_f32 v43, v19
  v_mfma_f32_16x16x32_bf16 v[28:31], a[92:95], a[28:31], v[28:31]
  ds_read_b128 a[124:127], v71 offset:8192
  v_cvt_pk_bf16_f32 v33, v42, v43
  v_mfma_f32_16x16x32_bf16 v[120:123], v[8:11], v[36:39], v[120:123]
  v_exp_f32 v44, v20
  v_mfma_f32_16x16x32_bf16 v[224:227], a[160:163], v[36:39], v[224:227]
  v_mfma_f32_16x16x32_bf16 v[228:231], a[164:167], v[36:39], v[228:231]
  v_exp_f32 v45, v21
  v_mfma_f32_16x16x32_bf16 v[232:235], a[168:171], v[36:39], v[232:235]
  v_cvt_pk_bf16_f32 v34, v44, v45
  v_mfma_f32_16x16x32_bf16 v[236:239], a[172:175], v[36:39], v[236:239]
  v_exp_f32 v46, v22
  v_mfma_f32_16x16x32_bf16 v[240:243], a[176:179], v[36:39], v[240:243]
  v_mfma_f32_16x16x32_bf16 v[244:247], a[180:183], v[36:39], v[244:247]
  s_waitcnt vmcnt(8) lgkmcnt(0)
  v_exp_f32 v47, v23
  v_mfma_f32_16x16x32_bf16 v[248:251], a[184:187], v[36:39], v[248:251]
  v_cvt_pk_bf16_f32 v35, v46, v47
  v_mfma_f32_16x16x32_bf16 v[252:255], a[188:191], v[36:39], v[252:255]
  s_barrier
  v_mfma_f32_16x16x32_bf16 v[16:19], a[64:67], a[32:35], v[60:63]
  v_exp_f32 v40, v24
  s_cmp_lg_u32 s40, 0
  s_cbranch_scc1 L_sig_done
  s_lshr_b32 s60, s2, 2
  s_lshl_b32 s60, s60, 2
  v_mov_b32 v2, s92
  s_mov_b64 exec, 1
  buffer_atomic_add v2, off, s[36:39], s60
  s_mov_b64 exec, -1
L_sig_done:
  v_mfma_f32_16x16x32_bf16 v[16:19], a[68:71], a[36:39], v[16:19]
  ds_read_b64_tr_b16 a[160:161], v72 offset:16384
  v_mfma_f32_16x16x32_bf16 v[16:19], a[72:75], a[40:43], v[16:19]
  s_add_u32 m0, s43, 0
  v_exp_f32 v41, v25
  v_mfma_f32_16x16x32_bf16 v[16:19], a[76:79], a[44:47], v[16:19]
  ds_read_b64_tr_b16 a[162:163], v72 offset:24576
  v_cvt_pk_bf16_f32 v36, v40, v41
  v_mfma_f32_16x16x32_bf16 v[20:23], a[80:83], a[32:35], v[60:63]
  v_exp_f32 v42, v26
  v_mfma_f32_16x16x32_bf16 v[20:23], a[84:87], a[36:39], v[20:23]
  buffer_load_dwordx4 v80, s[8:11], s41 offen lds
  v_mfma_f32_16x16x32_bf16 v[20:23], a[88:91], a[40:43], v[20:23]
  v_exp_f32 v43, v27
  v_mfma_f32_16x16x32_bf16 v[20:23], a[92:95], a[44:47], v[20:23]
  ds_read_b64_tr_b16 a[164:165], v73 offset:16384
  v_cvt_pk_bf16_f32 v37, v42, v43
  v_mfma_f32_16x16x32_bf16 v[48:51], v[124:127], v[32:35], v[48:51]
  v_exp_f32 v44, v28
  v_mfma_f32_16x16x32_bf16 v[128:131], a[128:131], v[32:35], v[128:131]
  buffer_load_dwordx4 v81, s[8:11], s41 offen offset:1024 lds
  v_mfma_f32_16x16x32_bf16 v[132:135], a[132:135], v[32:35], v[132:135]
  s_add_u32 s41, s41, 8192
  v_exp_f32 v45, v29
  v_mfma_f32_16x16x32_bf16 v[136:139], a[136:139], v[32:35], v[136:139]
  ds_read_b64_tr_b16 a[166:167], v73 offset:24576
  v_cvt_pk_bf16_f32 v38, v44, v45
  v_mfma_f32_16x16x32_bf16 v[140:143], a[140:143], v[32:35], v[140:143]
  v_exp_f32 v46, v30
  v_mfma_f32_16x16x32_bf16 v[144:147], a[144:147], v[32:35], v[144:147]
  ds_read_b64_tr_b16 a[168:169], v74 offset:16384
  v_mfma_f32_16x16x32_bf16 v[148:151], a[148:151], v[32:35], v[148:151]
  v_exp_f32 v47, v31
  v_mfma_f32_16x16x32_bf16 v[152:155], a[152:155], v[32:35], v[152:155]
  ds_read_b64_tr_b16 a[170:171], v74 offset:24576
  v_cvt_pk_bf16_f32 v39, v46, v47
  v_mfma_f32_16x16x32_bf16 v[156:159], a[156:159], v[32:35], v[156:159]
  v_mfma_f32_16x16x32_bf16 v[24:27], a[64:67], a[48:51], v[64:67]
  s_add_u32 m0, s43, 2048
  v_exp_f32 v40, v16
  v_mfma_f32_16x16x32_bf16 v[24:27], a[68:71], a[52:55], v[24:27]
  buffer_load_dwordx4 v82, s[12:15], s42 offen lds
  v_mfma_f32_16x16x32_bf16 v[24:27], a[72:75], a[56:59], v[24:27]
  v_exp_f32 v41, v17
  v_mfma_f32_16x16x32_bf16 v[24:27], a[76:79], a[60:63], v[24:27]
  ds_read_b64_tr_b16 a[172:173], v75 offset:16384
  v_cvt_pk_bf16_f32 v32, v40, v41
  v_mfma_f32_16x16x32_bf16 v[28:31], a[80:83], a[48:51], v[64:67]
  v_exp_f32 v42, v18
  v_mfma_f32_16x16x32_bf16 v[28:31], a[84:87], a[52:55], v[28:31]
  buffer_load_dwordx4 v83, s[12:15], s42 offen offset:1024 lds
  v_mfma_f32_16x16x32_bf16 v[28:31], a[88:91], a[56:59], v[28:31]
  s_add_u32 s42, s42, 8192
  v_exp_f32 v43, v19
  v_mfma_f32_16x16x32_bf16 v[28:31], a[92:95], a[60:63], v[28:31]
  ds_read_b64_tr_b16 a[174:175], v75 offset:24576
  v_cvt_pk_bf16_f32 v33, v42, v43
  v_mfma_f32_16x16x32_bf16 v[48:51], v[8:11], v[36:39], v[48:51]
  v_exp_f32 v44, v20
  v_mfma_f32_16x16x32_bf16 v[160:163], a[128:131], v[36:39], v[160:163]
  ds_read_b64_tr_b16 a[176:177], v76 offset:16384
  v_mfma_f32_16x16x32_bf16 v[164:167], a[132:135], v[36:39], v[164:167]
  v_exp_f32 v45, v21
  v_mfma_f32_16x16x32_bf16 v[168:171], a[136:139], v[36:39], v[168:171]
  ds_read_b64_tr_b16 a[178:179], v76 offset:24576
  v_cvt_pk_bf16_f32 v34, v44, v45
  v_mfma_f32_16x16x32_bf16 v[172:175], a[140:143], v[36:39], v[172:175]
  v_exp_f32 v46, v22
  v_mfma_f32_16x16x32_bf16 v[176:179], a[144:147], v[36:39], v[176:179]
  ds_read_b64_tr_b16 a[180:181], v77 offset:16384
  v_mfma_f32_16x16x32_bf16 v[180:183], a[148:151], v[36:39], v[180:183]
  v_exp_f32 v47, v23
  v_mfma_f32_16x16x32_bf16 v[184:187], a[152:155], v[36:39], v[184:187]
  ds_read_b64_tr_b16 a[182:183], v77 offset:24576
  v_cvt_pk_bf16_f32 v35, v46, v47
  v_mfma_f32_16x16x32_bf16 v[188:191], a[156:159], v[36:39], v[188:191]
  v_mfma_f32_16x16x32_bf16 v[16:19], a[96:99], a[0:3], v[52:55]
  v_exp_f32 v40, v24
  v_mfma_f32_16x16x32_bf16 v[16:19], a[100:103], a[4:7], v[16:19]
  ds_read_b64_tr_b16 a[184:185], v78 offset:16384
  v_mfma_f32_16x16x32_bf16 v[16:19], a[104:107], a[8:11], v[16:19]
  v_exp_f32 v41, v25
  v_mfma_f32_16x16x32_bf16 v[16:19], a[108:111], a[12:15], v[16:19]
  ds_read_b64_tr_b16 a[186:187], v78 offset:24576
  v_cvt_pk_bf16_f32 v36, v40, v41
  v_mfma_f32_16x16x32_bf16 v[20:23], a[112:115], a[0:3], v[52:55]
  v_exp_f32 v42, v26
  v_mfma_f32_16x16x32_bf16 v[20:23], a[116:119], a[4:7], v[20:23]
  ds_read_b64_tr_b16 a[188:189], v79 offset:16384
  v_mfma_f32_16x16x32_bf16 v[20:23], a[120:123], a[8:11], v[20:23]
  v_exp_f32 v43, v27
  v_mfma_f32_16x16x32_bf16 v[20:23], a[124:127], a[12:15], v[20:23]
  ds_read_b64_tr_b16 a[190:191], v79 offset:24576
  v_cvt_pk_bf16_f32 v37, v42, v43
  v_mfma_f32_16x16x32_bf16 v[120:123], v[124:127], v[32:35], v[120:123]
  v_exp_f32 v44, v28
  v_mfma_f32_16x16x32_bf16 v[192:195], a[128:131], v[32:35], v[192:195]
  ds_read_b128 a[64:67], v68 offset:16384
  v_mfma_f32_16x16x32_bf16 v[196:199], a[132:135], v[32:35], v[196:199]
  v_exp_f32 v45, v29
  v_mfma_f32_16x16x32_bf16 v[200:203], a[136:139], v[32:35], v[200:203]
  ds_read_b128 a[68:71], v69 offset:16384
  v_cvt_pk_bf16_f32 v38, v44, v45
  v_mfma_f32_16x16x32_bf16 v[204:207], a[140:143], v[32:35], v[204:207]
  v_exp_f32 v46, v30
  v_mfma_f32_16x16x32_bf16 v[208:211], a[144:147], v[32:35], v[208:211]
  ds_read_b128 a[72:75], v70 offset:16384
  v_mfma_f32_16x16x32_bf16 v[212:215], a[148:151], v[32:35], v[212:215]
  v_exp_f32 v47, v31
  v_mfma_f32_16x16x32_bf16 v[216:219], a[152:155], v[32:35], v[216:219]
  ds_read_b128 a[76:79], v71 offset:16384
  v_cvt_pk_bf16_f32 v39, v46, v47
  v_mfma_f32_16x16x32_bf16 v[220:223], a[156:159], v[32:35], v[220:223]
  v_mfma_f32_16x16x32_bf16 v[24:27], a[96:99], a[16:19], v[56:59]
  v_exp_f32 v40, v16
  v_mfma_f32_16x16x32_bf16 v[24:27], a[100:103], a[20:23], v[24:27]
  ds_read_b128 a[80:83], v68 offset:24576
  v_mfma_f32_16x16x32_bf16 v[24:27], a[104:107], a[24:27], v[24:27]
  v_exp_f32 v41, v17
  v_mfma_f32_16x16x32_bf16 v[24:27], a[108:111], a[28:31], v[24:27]
  ds_read_b128 a[84:87], v69 offset:24576
  v_cvt_pk_bf16_f32 v32, v40, v41
  v_mfma_f32_16x16x32_bf16 v[28:31], a[112:115], a[16:19], v[56:59]
  v_exp_f32 v42, v18
  v_mfma_f32_16x16x32_bf16 v[28:31], a[116:119], a[20:23], v[28:31]
  ds_read_b128 a[88:91], v70 offset:24576
  v_mfma_f32_16x16x32_bf16 v[28:31], a[120:123], a[24:27], v[28:31]
  v_exp_f32 v43, v19
  v_mfma_f32_16x16x32_bf16 v[28:31], a[124:127], a[28:31], v[28:31]
  ds_read_b128 a[92:95], v71 offset:24576
  v_cvt_pk_bf16_f32 v33, v42, v43
  v_mfma_f32_16x16x32_bf16 v[120:123], v[8:11], v[36:39], v[120:123]
  v_exp_f32 v44, v20
  v_mfma_f32_16x16x32_bf16 v[224:227], a[128:131], v[36:39], v[224:227]
  v_mfma_f32_16x16x32_bf16 v[228:231], a[132:135], v[36:39], v[228:231]
  v_exp_f32 v45, v21
  v_mfma_f32_16x16x32_bf16 v[232:235], a[136:139], v[36:39], v[232:235]
  v_cvt_pk_bf16_f32 v34, v44, v45
  v_mfma_f32_16x16x32_bf16 v[236:239], a[140:143], v[36:39], v[236:239]
  v_exp_f32 v46, v22
  v_mfma_f32_16x16x32_bf16 v[240:243], a[144:147], v[36:39], v[240:243]
  v_mfma_f32_16x16x32_bf16 v[244:247], a[148:151], v[36:39], v[244:247]
  s_waitcnt vmcnt(8) lgkmcnt(0)
  v_exp_f32 v47, v23
  v_mfma_f32_16x16x32_bf16 v[248:251], a[152:155], v[36:39], v[248:251]
  v_cvt_pk_bf16_f32 v35, v46, v47
  v_mfma_f32_16x16x32_bf16 v[252:255], a[156:159], v[36:39], v[252:255]
  s_barrier
  v_mfma_f32_16x16x32_bf16 v[16:19], a[96:99], a[32:35], v[60:63]
  v_exp_f32 v40, v24
  v_mfma_f32_16x16x32_bf16 v[16:19], a[100:103], a[36:39], v[16:19]
  ds_read_b64_tr_b16 a[128:129], v72 offset:32768
  v_mfma_f32_16x16x32_bf16 v[16:19], a[104:107], a[40:43], v[16:19]
  s_add_u32 m0, s43, 16384
  v_exp_f32 v41, v25
  v_mfma_f32_16x16x32_bf16 v[16:19], a[108:111], a[44:47], v[16:19]
  ds_read_b64_tr_b16 a[130:131], v72 offset:40960
  v_cvt_pk_bf16_f32 v36, v40, v41
  v_mfma_f32_16x16x32_bf16 v[20:23], a[112:115], a[32:35], v[60:63]
  v_exp_f32 v42, v26
  v_mfma_f32_16x16x32_bf16 v[20:23], a[116:119], a[36:39], v[20:23]
  buffer_load_dwordx4 v80, s[8:11], s41 offen lds
  v_mfma_f32_16x16x32_bf16 v[20:23], a[120:123], a[40:43], v[20:23]
  v_exp_f32 v43, v27
  v_mfma_f32_16x16x32_bf16 v[20:23], a[124:127], a[44:47], v[20:23]
  ds_read_b64_tr_b16 a[132:133], v73 offset:32768
  v_cvt_pk_bf16_f32 v37, v42, v43
  v_mfma_f32_16x16x32_bf16 v[48:51], v[124:127], v[32:35], v[48:51]
  v_exp_f32 v44, v28
  v_mfma_f32_16x16x32_bf16 v[128:131], a[160:163], v[32:35], v[128:131]
  buffer_load_dwordx4 v81, s[8:11], s41 offen offset:1024 lds
  v_mfma_f32_16x16x32_bf16 v[132:135], a[164:167], v[32:35], v[132:135]
  s_add_u32 s41, s41, 8192
  v_exp_f32 v45, v29
  v_mfma_f32_16x16x32_bf16 v[136:139], a[168:171], v[32:35], v[136:139]
  ds_read_b64_tr_b16 a[134:135], v73 offset:40960
  v_cvt_pk_bf16_f32 v38, v44, v45
  v_mfma_f32_16x16x32_bf16 v[140:143], a[172:175], v[32:35], v[140:143]
  v_exp_f32 v46, v30
  v_mfma_f32_16x16x32_bf16 v[144:147], a[176:179], v[32:35], v[144:147]
  ds_read_b64_tr_b16 a[136:137], v74 offset:32768
  v_mfma_f32_16x16x32_bf16 v[148:151], a[180:183], v[32:35], v[148:151]
  v_exp_f32 v47, v31
  v_mfma_f32_16x16x32_bf16 v[152:155], a[184:187], v[32:35], v[152:155]
  ds_read_b64_tr_b16 a[138:139], v74 offset:40960
  v_cvt_pk_bf16_f32 v39, v46, v47
  v_mfma_f32_16x16x32_bf16 v[156:159], a[188:191], v[32:35], v[156:159]
  v_mfma_f32_16x16x32_bf16 v[24:27], a[96:99], a[48:51], v[64:67]
  s_add_u32 m0, s43, 18432
  v_exp_f32 v40, v16
  v_mfma_f32_16x16x32_bf16 v[24:27], a[100:103], a[52:55], v[24:27]
  buffer_load_dwordx4 v82, s[12:15], s42 offen lds
  v_mfma_f32_16x16x32_bf16 v[24:27], a[104:107], a[56:59], v[24:27]
  v_exp_f32 v41, v17
  v_mfma_f32_16x16x32_bf16 v[24:27], a[108:111], a[60:63], v[24:27]
  ds_read_b64_tr_b16 a[140:141], v75 offset:32768
  v_cvt_pk_bf16_f32 v32, v40, v41
  v_mfma_f32_16x16x32_bf16 v[28:31], a[112:115], a[48:51], v[64:67]
  v_exp_f32 v42, v18
  v_mfma_f32_16x16x32_bf16 v[28:31], a[116:119], a[52:55], v[28:31]
  buffer_load_dwordx4 v83, s[12:15], s42 offen offset:1024 lds
  v_mfma_f32_16x16x32_bf16 v[28:31], a[120:123], a[56:59], v[28:31]
  s_add_u32 s42, s42, 8192
  v_exp_f32 v43, v19
  v_mfma_f32_16x16x32_bf16 v[28:31], a[124:127], a[60:63], v[28:31]
  ds_read_b64_tr_b16 a[142:143], v75 offset:40960
  v_cvt_pk_bf16_f32 v33, v42, v43
  v_mfma_f32_16x16x32_bf16 v[48:51], v[8:11], v[36:39], v[48:51]
  v_exp_f32 v44, v20
  v_mfma_f32_16x16x32_bf16 v[160:163], a[160:163], v[36:39], v[160:163]
  ds_read_b64_tr_b16 a[144:145], v76 offset:32768
  v_mfma_f32_16x16x32_bf16 v[164:167], a[164:167], v[36:39], v[164:167]
  v_exp_f32 v45, v21
  v_mfma_f32_16x16x32_bf16 v[168:171], a[168:171], v[36:39], v[168:171]
  ds_read_b64_tr_b16 a[146:147], v76 offset:40960
  v_cvt_pk_bf16_f32 v34, v44, v45
  v_mfma_f32_16x16x32_bf16 v[172:175], a[172:175], v[36:39], v[172:175]
  v_exp_f32 v46, v22
  v_mfma_f32_16x16x32_bf16 v[176:179], a[176:179], v[36:39], v[176:179]
  ds_read_b64_tr_b16 a[148:149], v77 offset:32768
  v_mfma_f32_16x16x32_bf16 v[180:183], a[180:183], v[36:39], v[180:183]
  v_exp_f32 v47, v23
  v_mfma_f32_16x16x32_bf16 v[184:187], a[184:187], v[36:39], v[184:187]
  ds_read_b64_tr_b16 a[150:151], v77 offset:40960
  v_cvt_pk_bf16_f32 v35, v46, v47
  v_mfma_f32_16x16x32_bf16 v[188:191], a[188:191], v[36:39], v[188:191]
  v_mfma_f32_16x16x32_bf16 v[16:19], a[64:67], a[0:3], v[52:55]
  v_exp_f32 v40, v24
  v_mfma_f32_16x16x32_bf16 v[16:19], a[68:71], a[4:7], v[16:19]
  ds_read_b64_tr_b16 a[152:153], v78 offset:32768
  v_mfma_f32_16x16x32_bf16 v[16:19], a[72:75], a[8:11], v[16:19]
  v_exp_f32 v41, v25
  v_mfma_f32_16x16x32_bf16 v[16:19], a[76:79], a[12:15], v[16:19]
  ds_read_b64_tr_b16 a[154:155], v78 offset:40960
  v_cvt_pk_bf16_f32 v36, v40, v41
  v_mfma_f32_16x16x32_bf16 v[20:23], a[80:83], a[0:3], v[52:55]
  v_exp_f32 v42, v26
  v_mfma_f32_16x16x32_bf16 v[20:23], a[84:87], a[4:7], v[20:23]
  ds_read_b64_tr_b16 a[156:157], v79 offset:32768
  v_mfma_f32_16x16x32_bf16 v[20:23], a[88:91], a[8:11], v[20:23]
  v_exp_f32 v43, v27
  v_mfma_f32_16x16x32_bf16 v[20:23], a[92:95], a[12:15], v[20:23]
  ds_read_b64_tr_b16 a[158:159], v79 offset:40960
  v_cvt_pk_bf16_f32 v37, v42, v43
  v_mfma_f32_16x16x32_bf16 v[120:123], v[124:127], v[32:35], v[120:123]
  v_exp_f32 v44, v28
  v_mfma_f32_16x16x32_bf16 v[192:195], a[160:163], v[32:35], v[192:195]
  ds_read_b128 a[96:99], v68 offset:32768
  v_mfma_f32_16x16x32_bf16 v[196:199], a[164:167], v[32:35], v[196:199]
  v_exp_f32 v45, v29
  v_mfma_f32_16x16x32_bf16 v[200:203], a[168:171], v[32:35], v[200:203]
  ds_read_b128 a[100:103], v69 offset:32768
  v_cvt_pk_bf16_f32 v38, v44, v45
  v_mfma_f32_16x16x32_bf16 v[204:207], a[172:175], v[32:35], v[204:207]
  v_exp_f32 v46, v30
  v_mfma_f32_16x16x32_bf16 v[208:211], a[176:179], v[32:35], v[208:211]
  ds_read_b128 a[104:107], v70 offset:32768
  v_mfma_f32_16x16x32_bf16 v[212:215], a[180:183], v[32:35], v[212:215]
  v_exp_f32 v47, v31
  v_mfma_f32_16x16x32_bf16 v[216:219], a[184:187], v[32:35], v[216:219]
  ds_read_b128 a[108:111], v71 offset:32768
  v_cvt_pk_bf16_f32 v39, v46, v47
  v_mfma_f32_16x16x32_bf16 v[220:223], a[188:191], v[32:35], v[220:223]
  v_mfma_f32_16x16x32_bf16 v[24:27], a[64:67], a[16:19], v[56:59]
  v_exp_f32 v40, v16
  v_mfma_f32_16x16x32_bf16 v[24:27], a[68:71], a[20:23], v[24:27]
  ds_read_b128 a[112:115], v68 offset:40960
  v_mfma_f32_16x16x32_bf16 v[24:27], a[72:75], a[24:27], v[24:27]
  v_exp_f32 v41, v17
  v_mfma_f32_16x16x32_bf16 v[24:27], a[76:79], a[28:31], v[24:27]
  ds_read_b128 a[116:119], v69 offset:40960
  v_cvt_pk_bf16_f32 v32, v40, v41
  v_mfma_f32_16x16x32_bf16 v[28:31], a[80:83], a[16:19], v[56:59]
  v_exp_f32 v42, v18
  v_mfma_f32_16x16x32_bf16 v[28:31], a[84:87], a[20:23], v[28:31]
  ds_read_b128 a[120:123], v70 offset:40960
  v_mfma_f32_16x16x32_bf16 v[28:31], a[88:91], a[24:27], v[28:31]
  v_exp_f32 v43, v19
  v_mfma_f32_16x16x32_bf16 v[28:31], a[92:95], a[28:31], v[28:31]
  ds_read_b128 a[124:127], v71 offset:40960
  v_cvt_pk_bf16_f32 v33, v42, v43
  v_mfma_f32_16x16x32_bf16 v[120:123], v[8:11], v[36:39], v[120:123]
  v_exp_f32 v44, v20
  v_mfma_f32_16x16x32_bf16 v[224:227], a[160:163], v[36:39], v[224:227]
  v_mfma_f32_16x16x32_bf16 v[228:231], a[164:167], v[36:39], v[228:231]
  v_exp_f32 v45, v21
  v_mfma_f32_16x16x32_bf16 v[232:235], a[168:171], v[36:39], v[232:235]
  v_cvt_pk_bf16_f32 v34, v44, v45
  v_mfma_f32_16x16x32_bf16 v[236:239], a[172:175], v[36:39], v[236:239]
  v_exp_f32 v46, v22
  v_mfma_f32_16x16x32_bf16 v[240:243], a[176:179], v[36:39], v[240:243]
  v_mfma_f32_16x16x32_bf16 v[244:247], a[180:183], v[36:39], v[244:247]
  s_waitcnt vmcnt(8) lgkmcnt(0)
  v_exp_f32 v47, v23
  v_mfma_f32_16x16x32_bf16 v[248:251], a[184:187], v[36:39], v[248:251]
  v_cvt_pk_bf16_f32 v35, v46, v47
  v_mfma_f32_16x16x32_bf16 v[252:255], a[188:191], v[36:39], v[252:255]
  s_barrier
  v_mfma_f32_16x16x32_bf16 v[16:19], a[64:67], a[32:35], v[60:63]
  v_exp_f32 v40, v24
  v_mfma_f32_16x16x32_bf16 v[16:19], a[68:71], a[36:39], v[16:19]
  ds_read_b64_tr_b16 a[160:161], v72 offset:49152
  v_mfma_f32_16x16x32_bf16 v[16:19], a[72:75], a[40:43], v[16:19]
  s_add_u32 m0, s43, 32768
  v_exp_f32 v41, v25
  v_mfma_f32_16x16x32_bf16 v[16:19], a[76:79], a[44:47], v[16:19]
  ds_read_b64_tr_b16 a[162:163], v72 offset:57344
  v_cvt_pk_bf16_f32 v36, v40, v41
  v_mfma_f32_16x16x32_bf16 v[20:23], a[80:83], a[32:35], v[60:63]
  v_exp_f32 v42, v26
  v_mfma_f32_16x16x32_bf16 v[20:23], a[84:87], a[36:39], v[20:23]
  buffer_load_dwordx4 v80, s[8:11], s41 offen lds
  v_mfma_f32_16x16x32_bf16 v[20:23], a[88:91], a[40:43], v[20:23]
  v_exp_f32 v43, v27
  v_mfma_f32_16x16x32_bf16 v[20:23], a[92:95], a[44:47], v[20:23]
  ds_read_b64_tr_b16 a[164:165], v73 offset:49152
  v_cvt_pk_bf16_f32 v37, v42, v43
  v_mfma_f32_16x16x32_bf16 v[48:51], v[124:127], v[32:35], v[48:51]
  v_exp_f32 v44, v28
  v_mfma_f32_16x16x32_bf16 v[128:131], a[128:131], v[32:35], v[128:131]
  buffer_load_dwordx4 v81, s[8:11], s41 offen offset:1024 lds
  v_mfma_f32_16x16x32_bf16 v[132:135], a[132:135], v[32:35], v[132:135]
  s_add_u32 s41, s41, 8192
  v_exp_f32 v45, v29
  v_mfma_f32_16x16x32_bf16 v[136:139], a[136:139], v[32:35], v[136:139]
  ds_read_b64_tr_b16 a[166:167], v73 offset:57344
  v_cvt_pk_bf16_f32 v38, v44, v45
  v_mfma_f32_16x16x32_bf16 v[140:143], a[140:143], v[32:35], v[140:143]
  v_exp_f32 v46, v30
  v_mfma_f32_16x16x32_bf16 v[144:147], a[144:147], v[32:35], v[144:147]
  ds_read_b64_tr_b16 a[168:169], v74 offset:49152
  v_mfma_f32_16x16x32_bf16 v[148:151], a[148:151], v[32:35], v[148:151]
  v_exp_f32 v47, v31
  v_mfma_f32_16x16x32_bf16 v[152:155], a[152:155], v[32:35], v[152:155]
  ds_read_b64_tr_b16 a[170:171], v74 offset:57344
  v_cvt_pk_bf16_f32 v39, v46, v47
  v_mfma_f32_16x16x32_bf16 v[156:159], a[156:159], v[32:35], v[156:159]
  v_mfma_f32_16x16x32_bf16 v[24:27], a[64:67], a[48:51], v[64:67]
  s_add_u32 m0, s43, 34816
  v_exp_f32 v40, v16
  v_mfma_f32_16x16x32_bf16 v[24:27], a[68:71], a[52:55], v[24:27]
  buffer_load_dwordx4 v82, s[12:15], s42 offen lds
  v_mfma_f32_16x16x32_bf16 v[24:27], a[72:75], a[56:59], v[24:27]
  v_exp_f32 v41, v17
  v_mfma_f32_16x16x32_bf16 v[24:27], a[76:79], a[60:63], v[24:27]
  ds_read_b64_tr_b16 a[172:173], v75 offset:49152
  v_cvt_pk_bf16_f32 v32, v40, v41
  v_mfma_f32_16x16x32_bf16 v[28:31], a[80:83], a[48:51], v[64:67]
  v_exp_f32 v42, v18
  v_mfma_f32_16x16x32_bf16 v[28:31], a[84:87], a[52:55], v[28:31]
  buffer_load_dwordx4 v83, s[12:15], s42 offen offset:1024 lds
  v_mfma_f32_16x16x32_bf16 v[28:31], a[88:91], a[56:59], v[28:31]
  s_add_u32 s42, s42, 8192
  v_exp_f32 v43, v19
  v_mfma_f32_16x16x32_bf16 v[28:31], a[92:95], a[60:63], v[28:31]
  ds_read_b64_tr_b16 a[174:175], v75 offset:57344
  v_cvt_pk_bf16_f32 v33, v42, v43
  v_mfma_f32_16x16x32_bf16 v[48:51], v[8:11], v[36:39], v[48:51]
  v_exp_f32 v44, v20
  v_mfma_f32_16x16x32_bf16 v[160:163], a[128:131], v[36:39], v[160:163]
  ds_read_b64_tr_b16 a[176:177], v76 offset:49152
  v_mfma_f32_16x16x32_bf16 v[164:167], a[132:135], v[36:39], v[164:167]
  v_exp_f32 v45, v21
  v_mfma_f32_16x16x32_bf16 v[168:171], a[136:139], v[36:39], v[168:171]
  ds_read_b64_tr_b16 a[178:179], v76 offset:57344
  v_cvt_pk_bf16_f32 v34, v44, v45
  v_mfma_f32_16x16x32_bf16 v[172:175], a[140:143], v[36:39], v[172:175]
  v_exp_f32 v46, v22
  v_mfma_f32_16x16x32_bf16 v[176:179], a[144:147], v[36:39], v[176:179]
  ds_read_b64_tr_b16 a[180:181], v77 offset:49152
  v_mfma_f32_16x16x32_bf16 v[180:183], a[148:151], v[36:39], v[180:183]
  v_exp_f32 v47, v23
  v_mfma_f32_16x16x32_bf16 v[184:187], a[152:155], v[36:39], v[184:187]
  ds_read_b64_tr_b16 a[182:183], v77 offset:57344
  v_cvt_pk_bf16_f32 v35, v46, v47
  v_mfma_f32_16x16x32_bf16 v[188:191], a[156:159], v[36:39], v[188:191]
  v_mfma_f32_16x16x32_bf16 v[16:19], a[96:99], a[0:3], v[52:55]
  v_exp_f32 v40, v24
  v_mfma_f32_16x16x32_bf16 v[16:19], a[100:103], a[4:7], v[16:19]
  ds_read_b64_tr_b16 a[184:185], v78 offset:49152
  v_mfma_f32_16x16x32_bf16 v[16:19], a[104:107], a[8:11], v[16:19]
  v_exp_f32 v41, v25
  v_mfma_f32_16x16x32_bf16 v[16:19], a[108:111], a[12:15], v[16:19]
  ds_read_b64_tr_b16 a[186:187], v78 offset:57344
  v_cvt_pk_bf16_f32 v36, v40, v41
  v_mfma_f32_16x16x32_bf16 v[20:23], a[112:115], a[0:3], v[52:55]
  v_exp_f32 v42, v26
  v_mfma_f32_16x16x32_bf16 v[20:23], a[116:119], a[4:7], v[20:23]
  ds_read_b64_tr_b16 a[188:189], v79 offset:49152
  v_mfma_f32_16x16x32_bf16 v[20:23], a[120:123], a[8:11], v[20:23]
  v_exp_f32 v43, v27
  v_mfma_f32_16x16x32_bf16 v[20:23], a[124:127], a[12:15], v[20:23]
  ds_read_b64_tr_b16 a[190:191], v79 offset:57344
  v_cvt_pk_bf16_f32 v37, v42, v43
  v_mfma_f32_16x16x32_bf16 v[120:123], v[124:127], v[32:35], v[120:123]
  v_exp_f32 v44, v28
  v_mfma_f32_16x16x32_bf16 v[192:195], a[128:131], v[32:35], v[192:195]
  ds_read_b128 a[64:67], v68 offset:49152
  v_mfma_f32_16x16x32_bf16 v[196:199], a[132:135], v[32:35], v[196:199]
  v_exp_f32 v45, v29
  v_mfma_f32_16x16x32_bf16 v[200:203], a[136:139], v[32:35], v[200:203]
  ds_read_b128 a[68:71], v69 offset:49152
  v_cvt_pk_bf16_f32 v38, v44, v45
  v_mfma_f32_16x16x32_bf16 v[204:207], a[140:143], v[32:35], v[204:207]
  v_exp_f32 v46, v30
  v_mfma_f32_16x16x32_bf16 v[208:211], a[144:147], v[32:35], v[208:211]
  ds_read_b128 a[72:75], v70 offset:49152
  v_mfma_f32_16x16x32_bf16 v[212:215], a[148:151], v[32:35], v[212:215]
  v_exp_f32 v47, v31
  v_mfma_f32_16x16x32_bf16 v[216:219], a[152:155], v[32:35], v[216:219]
  ds_read_b128 a[76:79], v71 offset:49152
  v_cvt_pk_bf16_f32 v39, v46, v47
  v_mfma_f32_16x16x32_bf16 v[220:223], a[156:159], v[32:35], v[220:223]
  v_mfma_f32_16x16x32_bf16 v[24:27], a[96:99], a[16:19], v[56:59]
  v_exp_f32 v40, v16
  v_mfma_f32_16x16x32_bf16 v[24:27], a[100:103], a[20:23], v[24:27]
  ds_read_b128 a[80:83], v68 offset:57344
  v_mfma_f32_16x16x32_bf16 v[24:27], a[104:107], a[24:27], v[24:27]
  v_exp_f32 v41, v17
  v_mfma_f32_16x16x32_bf16 v[24:27], a[108:111], a[28:31], v[24:27]
  ds_read_b128 a[84:87], v69 offset:57344
  v_cvt_pk_bf16_f32 v32, v40, v41
  v_mfma_f32_16x16x32_bf16 v[28:31], a[112:115], a[16:19], v[56:59]
  v_exp_f32 v42, v18
  v_mfma_f32_16x16x32_bf16 v[28:31], a[116:119], a[20:23], v[28:31]
  ds_read_b128 a[88:91], v70 offset:57344
  v_mfma_f32_16x16x32_bf16 v[28:31], a[120:123], a[24:27], v[28:31]
  v_exp_f32 v43, v19
  v_mfma_f32_16x16x32_bf16 v[28:31], a[124:127], a[28:31], v[28:31]
  ds_read_b128 a[92:95], v71 offset:57344
  v_cvt_pk_bf16_f32 v33, v42, v43
  v_mfma_f32_16x16x32_bf16 v[120:123], v[8:11], v[36:39], v[120:123]
  v_exp_f32 v44, v20
  v_mfma_f32_16x16x32_bf16 v[224:227], a[128:131], v[36:39], v[224:227]
  buffer_load_dword v14, off, s[36:39], s66 sc1
  v_mfma_f32_16x16x32_bf16 v[228:231], a[132:135], v[36:39], v[228:231]
  v_exp_f32 v45, v21
  v_mfma_f32_16x16x32_bf16 v[232:235], a[136:139], v[36:39], v[232:235]
  v_cvt_pk_bf16_f32 v34, v44, v45
  v_mfma_f32_16x16x32_bf16 v[236:239], a[140:143], v[36:39], v[236:239]
  v_exp_f32 v46, v22
  v_mfma_f32_16x16x32_bf16 v[240:243], a[144:147], v[36:39], v[240:243]
  v_mfma_f32_16x16x32_bf16 v[244:247], a[148:151], v[36:39], v[244:247]
  s_waitcnt vmcnt(9) lgkmcnt(0)
  v_exp_f32 v47, v23
  v_mfma_f32_16x16x32_bf16 v[248:251], a[152:155], v[36:39], v[248:251]
  v_cvt_pk_bf16_f32 v35, v46, v47
  v_mfma_f32_16x16x32_bf16 v[252:255], a[156:159], v[36:39], v[252:255]
  s_barrier
  v_mfma_f32_16x16x32_bf16 v[16:19], a[96:99], a[32:35], v[60:63]
  v_exp_f32 v40, v24
  v_mfma_f32_16x16x32_bf16 v[16:19], a[100:103], a[36:39], v[16:19]
  ds_read_b64_tr_b16 a[128:129], v72 offset:0
  v_mfma_f32_16x16x32_bf16 v[16:19], a[104:107], a[40:43], v[16:19]
  s_add_u32 m0, s43, 49152
  v_exp_f32 v41, v25
  v_mfma_f32_16x16x32_bf16 v[16:19], a[108:111], a[44:47], v[16:19]
  ds_read_b64_tr_b16 a[130:131], v72 offset:8192
  v_cvt_pk_bf16_f32 v36, v40, v41
  v_mfma_f32_16x16x32_bf16 v[20:23], a[112:115], a[32:35], v[60:63]
  v_exp_f32 v42, v26
  v_mfma_f32_16x16x32_bf16 v[20:23], a[116:119], a[36:39], v[20:23]
  buffer_load_dwordx4 v80, s[8:11], s41 offen lds
  v_mfma_f32_16x16x32_bf16 v[20:23], a[120:123], a[40:43], v[20:23]
  v_exp_f32 v43, v27
  v_mfma_f32_16x16x32_bf16 v[20:23], a[124:127], a[44:47], v[20:23]
  ds_read_b64_tr_b16 a[132:133], v73 offset:0
  v_cvt_pk_bf16_f32 v37, v42, v43
  v_mfma_f32_16x16x32_bf16 v[48:51], v[124:127], v[32:35], v[48:51]
  v_exp_f32 v44, v28
  v_mfma_f32_16x16x32_bf16 v[128:131], a[160:163], v[32:35], v[128:131]
  buffer_load_dwordx4 v81, s[8:11], s41 offen offset:1024 lds
  v_mfma_f32_16x16x32_bf16 v[132:135], a[164:167], v[32:35], v[132:135]
  s_add_u32 s41, s41, 8192
  v_exp_f32 v45, v29
  v_mfma_f32_16x16x32_bf16 v[136:139], a[168:171], v[32:35], v[136:139]
  ds_read_b64_tr_b16 a[134:135], v73 offset:8192
  v_cvt_pk_bf16_f32 v38, v44, v45
  v_mfma_f32_16x16x32_bf16 v[140:143], a[172:175], v[32:35], v[140:143]
  v_exp_f32 v46, v30
  v_mfma_f32_16x16x32_bf16 v[144:147], a[176:179], v[32:35], v[144:147]
  ds_read_b64_tr_b16 a[136:137], v74 offset:0
  v_mfma_f32_16x16x32_bf16 v[148:151], a[180:183], v[32:35], v[148:151]
  v_exp_f32 v47, v31
  v_mfma_f32_16x16x32_bf16 v[152:155], a[184:187], v[32:35], v[152:155]
  ds_read_b64_tr_b16 a[138:139], v74 offset:8192
  v_cvt_pk_bf16_f32 v39, v46, v47
  v_mfma_f32_16x16x32_bf16 v[156:159], a[188:191], v[32:35], v[156:159]
  v_mfma_f32_16x16x32_bf16 v[24:27], a[96:99], a[48:51], v[64:67]
  s_add_u32 m0, s43, 51200
  v_exp_f32 v40, v16
  v_mfma_f32_16x16x32_bf16 v[24:27], a[100:103], a[52:55], v[24:27]
  buffer_load_dwordx4 v82, s[12:15], s42 offen lds
  v_mfma_f32_16x16x32_bf16 v[24:27], a[104:107], a[56:59], v[24:27]
  v_exp_f32 v41, v17
  v_mfma_f32_16x16x32_bf16 v[24:27], a[108:111], a[60:63], v[24:27]
  ds_read_b64_tr_b16 a[140:141], v75 offset:0
  v_cvt_pk_bf16_f32 v32, v40, v41
  v_mfma_f32_16x16x32_bf16 v[28:31], a[112:115], a[48:51], v[64:67]
  v_exp_f32 v42, v18
  v_mfma_f32_16x16x32_bf16 v[28:31], a[116:119], a[52:55], v[28:31]
  buffer_load_dwordx4 v83, s[12:15], s42 offen offset:1024 lds
  v_mfma_f32_16x16x32_bf16 v[28:31], a[120:123], a[56:59], v[28:31]
  s_add_u32 s42, s42, 8192
  v_exp_f32 v43, v19
  v_mfma_f32_16x16x32_bf16 v[28:31], a[124:127], a[60:63], v[28:31]
  ds_read_b64_tr_b16 a[142:143], v75 offset:8192
  v_cvt_pk_bf16_f32 v33, v42, v43
  v_mfma_f32_16x16x32_bf16 v[48:51], v[8:11], v[36:39], v[48:51]
  v_exp_f32 v44, v20
  v_mfma_f32_16x16x32_bf16 v[160:163], a[160:163], v[36:39], v[160:163]
  ds_read_b64_tr_b16 a[144:145], v76 offset:0
  v_mfma_f32_16x16x32_bf16 v[164:167], a[164:167], v[36:39], v[164:167]
  v_exp_f32 v45, v21
  v_mfma_f32_16x16x32_bf16 v[168:171], a[168:171], v[36:39], v[168:171]
  ds_read_b64_tr_b16 a[146:147], v76 offset:8192
  v_cvt_pk_bf16_f32 v34, v44, v45
  v_mfma_f32_16x16x32_bf16 v[172:175], a[172:175], v[36:39], v[172:175]
  v_exp_f32 v46, v22
  v_mfma_f32_16x16x32_bf16 v[176:179], a[176:179], v[36:39], v[176:179]
  ds_read_b64_tr_b16 a[148:149], v77 offset:0
  v_mfma_f32_16x16x32_bf16 v[180:183], a[180:183], v[36:39], v[180:183]
  v_exp_f32 v47, v23
  v_mfma_f32_16x16x32_bf16 v[184:187], a[184:187], v[36:39], v[184:187]
  ds_read_b64_tr_b16 a[150:151], v77 offset:8192
  v_cvt_pk_bf16_f32 v35, v46, v47
  v_mfma_f32_16x16x32_bf16 v[188:191], a[188:191], v[36:39], v[188:191]
  v_mfma_f32_16x16x32_bf16 v[16:19], a[64:67], a[0:3], v[52:55]
  v_exp_f32 v40, v24
  v_mfma_f32_16x16x32_bf16 v[16:19], a[68:71], a[4:7], v[16:19]
  ds_read_b64_tr_b16 a[152:153], v78 offset:0
  v_mfma_f32_16x16x32_bf16 v[16:19], a[72:75], a[8:11], v[16:19]
  v_exp_f32 v41, v25
  v_mfma_f32_16x16x32_bf16 v[16:19], a[76:79], a[12:15], v[16:19]
  ds_read_b64_tr_b16 a[154:155], v78 offset:8192
  v_cvt_pk_bf16_f32 v36, v40, v41
  v_mfma_f32_16x16x32_bf16 v[20:23], a[80:83], a[0:3], v[52:55]
  v_exp_f32 v42, v26
  v_mfma_f32_16x16x32_bf16 v[20:23], a[84:87], a[4:7], v[20:23]
  ds_read_b64_tr_b16 a[156:157], v79 offset:0
  v_mfma_f32_16x16x32_bf16 v[20:23], a[88:91], a[8:11], v[20:23]
  v_exp_f32 v43, v27
  v_mfma_f32_16x16x32_bf16 v[20:23], a[92:95], a[12:15], v[20:23]
  ds_read_b64_tr_b16 a[158:159], v79 offset:8192
  v_cvt_pk_bf16_f32 v37, v42, v43
  v_mfma_f32_16x16x32_bf16 v[120:123], v[124:127], v[32:35], v[120:123]
  v_exp_f32 v44, v28
  v_mfma_f32_16x16x32_bf16 v[192:195], a[160:163], v[32:35], v[192:195]
  ds_read_b128 a[96:99], v68 offset:0
  v_mfma_f32_16x16x32_bf16 v[196:199], a[164:167], v[32:35], v[196:199]
  v_exp_f32 v45, v29
  v_mfma_f32_16x16x32_bf16 v[200:203], a[168:171], v[32:35], v[200:203]
  ds_read_b128 a[100:103], v69 offset:0
  v_cvt_pk_bf16_f32 v38, v44, v45
  v_mfma_f32_16x16x32_bf16 v[204:207], a[172:175], v[32:35], v[204:207]
  v_exp_f32 v46, v30
  v_mfma_f32_16x16x32_bf16 v[208:211], a[176:179], v[32:35], v[208:211]
  ds_read_b128 a[104:107], v70 offset:0
  v_mfma_f32_16x16x32_bf16 v[212:215], a[180:183], v[32:35], v[212:215]
  v_exp_f32 v47, v31
  v_mfma_f32_16x16x32_bf16 v[216:219], a[184:187], v[32:35], v[216:219]
  ds_read_b128 a[108:111], v71 offset:0
  v_cvt_pk_bf16_f32 v39, v46, v47
  v_mfma_f32_16x16x32_bf16 v[220:223], a[188:191], v[32:35], v[220:223]
  v_mfma_f32_16x16x32_bf16 v[24:27], a[64:67], a[16:19], v[56:59]
  v_exp_f32 v40, v16
  v_mfma_f32_16x16x32_bf16 v[24:27], a[68:71], a[20:23], v[24:27]
  ds_read_b128 a[112:115], v68 offset:8192
  v_mfma_f32_16x16x32_bf16 v[24:27], a[72:75], a[24:27], v[24:27]
  v_exp_f32 v41, v17
  v_mfma_f32_16x16x32_bf16 v[24:27], a[76:79], a[28:31], v[24:27]
  ds_read_b128 a[116:119], v69 offset:8192
  v_cvt_pk_bf16_f32 v32, v40, v41
  v_mfma_f32_16x16x32_bf16 v[28:31], a[80:83], a[16:19], v[56:59]
  v_exp_f32 v42, v18
  v_mfma_f32_16x16x32_bf16 v[28:31], a[84:87], a[20:23], v[28:31]
  ds_read_b128 a[120:123], v70 offset:8192
  v_mfma_f32_16x16x32_bf16 v[28:31], a[88:91], a[24:27], v[28:31]
  v_exp_f32 v43, v19
  v_mfma_f32_16x16x32_bf16 v[28:31], a[92:95], a[28:31], v[28:31]
  ds_read_b128 a[124:127], v71 offset:8192
  v_cvt_pk_bf16_f32 v33, v42, v43
  v_mfma_f32_16x16x32_bf16 v[120:123], v[8:11], v[36:39], v[120:123]
  v_exp_f32 v44, v20
  v_mfma_f32_16x16x32_bf16 v[224:227], a[160:163], v[36:39], v[224:227]
  v_mfma_f32_16x16x32_bf16 v[228:231], a[164:167], v[36:39], v[228:231]
  v_exp_f32 v45, v21
  v_mfma_f32_16x16x32_bf16 v[232:235], a[168:171], v[36:39], v[232:235]
  v_cvt_pk_bf16_f32 v34, v44, v45
  v_mfma_f32_16x16x32_bf16 v[236:239], a[172:175], v[36:39], v[236:239]
  v_exp_f32 v46, v22
  v_mfma_f32_16x16x32_bf16 v[240:243], a[176:179], v[36:39], v[240:243]
  v_mfma_f32_16x16x32_bf16 v[244:247], a[180:183], v[36:39], v[244:247]
  s_waitcnt vmcnt(9) lgkmcnt(0)
  v_exp_f32 v47, v23
  v_mfma_f32_16x16x32_bf16 v[248:251], a[184:187], v[36:39], v[248:251]
  v_cvt_pk_bf16_f32 v35, v46, v47
  v_mfma_f32_16x16x32_bf16 v[252:255], a[188:191], v[36:39], v[252:255]
  s_barrier
  v_mfma_f32_16x16x32_bf16 v[16:19], a[64:67], a[32:35], v[60:63]
  v_exp_f32 v40, v24
  v_mfma_f32_16x16x32_bf16 v[16:19], a[68:71], a[36:39], v[16:19]
  ds_read_b64_tr_b16 a[160:161], v72 offset:16384
  v_mfma_f32_16x16x32_bf16 v[16:19], a[72:75], a[40:43], v[16:19]
  s_add_u32 m0, s43, 0
  v_exp_f32 v41, v25
  v_mfma_f32_16x16x32_bf16 v[16:19], a[76:79], a[44:47], v[16:19]
  ds_read_b64_tr_b16 a[162:163], v72 offset:24576
  v_cvt_pk_bf16_f32 v36, v40, v41
  v_mfma_f32_16x16x32_bf16 v[20:23], a[80:83], a[32:35], v[60:63]
  v_exp_f32 v42, v26
  v_mfma_f32_16x16x32_bf16 v[20:23], a[84:87], a[36:39], v[20:23]
  buffer_load_dwordx4 v80, s[8:11], s41 offen lds
  v_mfma_f32_16x16x32_bf16 v[20:23], a[88:91], a[40:43], v[20:23]
  v_exp_f32 v43, v27
  v_mfma_f32_16x16x32_bf16 v[20:23], a[92:95], a[44:47], v[20:23]
  ds_read_b64_tr_b16 a[164:165], v73 offset:16384
  v_cvt_pk_bf16_f32 v37, v42, v43
  v_mfma_f32_16x16x32_bf16 v[48:51], v[124:127], v[32:35], v[48:51]
  v_exp_f32 v44, v28
  v_mfma_f32_16x16x32_bf16 v[128:131], a[128:131], v[32:35], v[128:131]
  buffer_load_dwordx4 v81, s[8:11], s41 offen offset:1024 lds
  v_mfma_f32_16x16x32_bf16 v[132:135], a[132:135], v[32:35], v[132:135]
  s_add_u32 s41, s41, 8192
  v_exp_f32 v45, v29
  v_mfma_f32_16x16x32_bf16 v[136:139], a[136:139], v[32:35], v[136:139]
  ds_read_b64_tr_b16 a[166:167], v73 offset:24576
  v_cvt_pk_bf16_f32 v38, v44, v45
  v_mfma_f32_16x16x32_bf16 v[140:143], a[140:143], v[32:35], v[140:143]
  v_exp_f32 v46, v30
  v_mfma_f32_16x16x32_bf16 v[144:147], a[144:147], v[32:35], v[144:147]
  ds_read_b64_tr_b16 a[168:169], v74 offset:16384
  v_mfma_f32_16x16x32_bf16 v[148:151], a[148:151], v[32:35], v[148:151]
  v_exp_f32 v47, v31
  v_mfma_f32_16x16x32_bf16 v[152:155], a[152:155], v[32:35], v[152:155]
  ds_read_b64_tr_b16 a[170:171], v74 offset:24576
  v_cvt_pk_bf16_f32 v39, v46, v47
  v_mfma_f32_16x16x32_bf16 v[156:159], a[156:159], v[32:35], v[156:159]
  v_mfma_f32_16x16x32_bf16 v[24:27], a[64:67], a[48:51], v[64:67]
  s_add_u32 m0, s43, 2048
  v_exp_f32 v40, v16
  v_mfma_f32_16x16x32_bf16 v[24:27], a[68:71], a[52:55], v[24:27]
  buffer_load_dwordx4 v82, s[12:15], s42 offen lds
  v_mfma_f32_16x16x32_bf16 v[24:27], a[72:75], a[56:59], v[24:27]
  v_exp_f32 v41, v17
  v_mfma_f32_16x16x32_bf16 v[24:27], a[76:79], a[60:63], v[24:27]
  ds_read_b64_tr_b16 a[172:173], v75 offset:16384
  v_cvt_pk_bf16_f32 v32, v40, v41
  v_mfma_f32_16x16x32_bf16 v[28:31], a[80:83], a[48:51], v[64:67]
  v_exp_f32 v42, v18
  v_mfma_f32_16x16x32_bf16 v[28:31], a[84:87], a[52:55], v[28:31]
  buffer_load_dwordx4 v83, s[12:15], s42 offen offset:1024 lds
  v_mfma_f32_16x16x32_bf16 v[28:31], a[88:91], a[56:59], v[28:31]
  s_add_u32 s42, s42, 8192
  v_exp_f32 v43, v19
  v_mfma_f32_16x16x32_bf16 v[28:31], a[92:95], a[60:63], v[28:31]
  ds_read_b64_tr_b16 a[174:175], v75 offset:24576
  v_cvt_pk_bf16_f32 v33, v42, v43
  v_mfma_f32_16x16x32_bf16 v[48:51], v[8:11], v[36:39], v[48:51]
  v_exp_f32 v44, v20
  v_mfma_f32_16x16x32_bf16 v[160:163], a[128:131], v[36:39], v[160:163]
  ds_read_b64_tr_b16 a[176:177], v76 offset:16384
  v_mfma_f32_16x16x32_bf16 v[164:167], a[132:135], v[36:39], v[164:167]
  v_exp_f32 v45, v21
  v_mfma_f32_16x16x32_bf16 v[168:171], a[136:139], v[36:39], v[168:171]
  ds_read_b64_tr_b16 a[178:179], v76 offset:24576
  v_cvt_pk_bf16_f32 v34, v44, v45
  v_mfma_f32_16x16x32_bf16 v[172:175], a[140:143], v[36:39], v[172:175]
  v_exp_f32 v46, v22
  v_mfma_f32_16x16x32_bf16 v[176:179], a[144:147], v[36:39], v[176:179]
  ds_read_b64_tr_b16 a[180:181], v77 offset:16384
  v_mfma_f32_16x16x32_bf16 v[180:183], a[148:151], v[36:39], v[180:183]
  v_exp_f32 v47, v23
  v_mfma_f32_16x16x32_bf16 v[184:187], a[152:155], v[36:39], v[184:187]
  ds_read_b64_tr_b16 a[182:183], v77 offset:24576
  v_cvt_pk_bf16_f32 v35, v46, v47
  v_mfma_f32_16x16x32_bf16 v[188:191], a[156:159], v[36:39], v[188:191]
  v_mfma_f32_16x16x32_bf16 v[16:19], a[96:99], a[0:3], v[52:55]
  v_exp_f32 v40, v24
  v_mfma_f32_16x16x32_bf16 v[16:19], a[100:103], a[4:7], v[16:19]
  ds_read_b64_tr_b16 a[184:185], v78 offset:16384
  v_mfma_f32_16x16x32_bf16 v[16:19], a[104:107], a[8:11], v[16:19]
  v_exp_f32 v41, v25
  v_mfma_f32_16x16x32_bf16 v[16:19], a[108:111], a[12:15], v[16:19]
  ds_read_b64_tr_b16 a[186:187], v78 offset:24576
  v_cvt_pk_bf16_f32 v36, v40, v41
  v_mfma_f32_16x16x32_bf16 v[20:23], a[112:115], a[0:3], v[52:55]
  v_exp_f32 v42, v26
  v_mfma_f32_16x16x32_bf16 v[20:23], a[116:119], a[4:7], v[20:23]
  ds_read_b64_tr_b16 a[188:189], v79 offset:16384
  v_mfma_f32_16x16x32_bf16 v[20:23], a[120:123], a[8:11], v[20:23]
  v_exp_f32 v43, v27
  v_mfma_f32_16x16x32_bf16 v[20:23], a[124:127], a[12:15], v[20:23]
  ds_read_b64_tr_b16 a[190:191], v79 offset:24576
  v_cvt_pk_bf16_f32 v37, v42, v43
  v_mfma_f32_16x16x32_bf16 v[120:123], v[124:127], v[32:35], v[120:123]
  v_exp_f32 v44, v28
  v_mfma_f32_16x16x32_bf16 v[192:195], a[128:131], v[32:35], v[192:195]
  ds_read_b128 a[64:67], v68 offset:16384
  v_mfma_f32_16x16x32_bf16 v[196:199], a[132:135], v[32:35], v[196:199]
  v_exp_f32 v45, v29
  v_mfma_f32_16x16x32_bf16 v[200:203], a[136:139], v[32:35], v[200:203]
  ds_read_b128 a[68:71], v69 offset:16384
  v_cvt_pk_bf16_f32 v38, v44, v45
  v_mfma_f32_16x16x32_bf16 v[204:207], a[140:143], v[32:35], v[204:207]
  v_exp_f32 v46, v30
  v_mfma_f32_16x16x32_bf16 v[208:211], a[144:147], v[32:35], v[208:211]
  ds_read_b128 a[72:75], v70 offset:16384
  v_mfma_f32_16x16x32_bf16 v[212:215], a[148:151], v[32:35], v[212:215]
  v_exp_f32 v47, v31
  v_mfma_f32_16x16x32_bf16 v[216:219], a[152:155], v[32:35], v[216:219]
  ds_read_b128 a[76:79], v71 offset:16384
  v_cvt_pk_bf16_f32 v39, v46, v47
  v_mfma_f32_16x16x32_bf16 v[220:223], a[156:159], v[32:35], v[220:223]
  v_mfma_f32_16x16x32_bf16 v[24:27], a[96:99], a[16:19], v[56:59]
  v_exp_f32 v40, v16
  v_mfma_f32_16x16x32_bf16 v[24:27], a[100:103], a[20:23], v[24:27]
  ds_read_b128 a[80:83], v68 offset:24576
  v_mfma_f32_16x16x32_bf16 v[24:27], a[104:107], a[24:27], v[24:27]
  v_exp_f32 v41, v17
  v_mfma_f32_16x16x32_bf16 v[24:27], a[108:111], a[28:31], v[24:27]
  ds_read_b128 a[84:87], v69 offset:24576
  v_cvt_pk_bf16_f32 v32, v40, v41
  v_mfma_f32_16x16x32_bf16 v[28:31], a[112:115], a[16:19], v[56:59]
  v_exp_f32 v42, v18
  v_mfma_f32_16x16x32_bf16 v[28:31], a[116:119], a[20:23], v[28:31]
  ds_read_b128 a[88:91], v70 offset:24576
  v_mfma_f32_16x16x32_bf16 v[28:31], a[120:123], a[24:27], v[28:31]
  v_exp_f32 v43, v19
  v_mfma_f32_16x16x32_bf16 v[28:31], a[124:127], a[28:31], v[28:31]
  ds_read_b128 a[92:95], v71 offset:24576
  v_cvt_pk_bf16_f32 v33, v42, v43
  v_mfma_f32_16x16x32_bf16 v[120:123], v[8:11], v[36:39], v[120:123]
  v_exp_f32 v44, v20
  v_mfma_f32_16x16x32_bf16 v[224:227], a[128:131], v[36:39], v[224:227]
  v_mfma_f32_16x16x32_bf16 v[228:231], a[132:135], v[36:39], v[228:231]
  v_exp_f32 v45, v21
  v_mfma_f32_16x16x32_bf16 v[232:235], a[136:139], v[36:39], v[232:235]
  v_cvt_pk_bf16_f32 v34, v44, v45
  v_mfma_f32_16x16x32_bf16 v[236:239], a[140:143], v[36:39], v[236:239]
  v_exp_f32 v46, v22
  v_mfma_f32_16x16x32_bf16 v[240:243], a[144:147], v[36:39], v[240:243]
  v_mfma_f32_16x16x32_bf16 v[244:247], a[148:151], v[36:39], v[244:247]
  s_waitcnt vmcnt(8) lgkmcnt(0)
  v_exp_f32 v47, v23
  v_mfma_f32_16x16x32_bf16 v[248:251], a[152:155], v[36:39], v[248:251]
  v_cvt_pk_bf16_f32 v35, v46, v47
  v_mfma_f32_16x16x32_bf16 v[252:255], a[156:159], v[36:39], v[252:255]
  s_barrier
  v_mfma_f32_16x16x32_bf16 v[16:19], a[96:99], a[32:35], v[60:63]
  v_exp_f32 v40, v24
  v_mfma_f32_16x16x32_bf16 v[16:19], a[100:103], a[36:39], v[16:19]
  ds_read_b64_tr_b16 a[128:129], v72 offset:32768
  v_mfma_f32_16x16x32_bf16 v[16:19], a[104:107], a[40:43], v[16:19]
  s_add_u32 m0, s43, 16384
  v_exp_f32 v41, v25
  v_mfma_f32_16x16x32_bf16 v[16:19], a[108:111], a[44:47], v[16:19]
  ds_read_b64_tr_b16 a[130:131], v72 offset:40960
  v_cvt_pk_bf16_f32 v36, v40, v41
  v_mfma_f32_16x16x32_bf16 v[20:23], a[112:115], a[32:35], v[60:63]
  v_exp_f32 v42, v26
  v_mfma_f32_16x16x32_bf16 v[20:23], a[116:119], a[36:39], v[20:23]
  buffer_load_dwordx4 v80, s[8:11], s41 offen lds
  v_mfma_f32_16x16x32_bf16 v[20:23], a[120:123], a[40:43], v[20:23]
  v_exp_f32 v43, v27
  v_mfma_f32_16x16x32_bf16 v[20:23], a[124:127], a[44:47], v[20:23]
  ds_read_b64_tr_b16 a[132:133], v73 offset:32768
  v_cvt_pk_bf16_f32 v37, v42, v43
  v_mfma_f32_16x16x32_bf16 v[48:51], v[124:127], v[32:35], v[48:51]
  v_exp_f32 v44, v28
  v_mfma_f32_16x16x32_bf16 v[128:131], a[160:163], v[32:35], v[128:131]
  buffer_load_dwordx4 v81, s[8:11], s41 offen offset:1024 lds
  v_mfma_f32_16x16x32_bf16 v[132:135], a[164:167], v[32:35], v[132:135]
  s_add_u32 s41, s41, 8192
  v_exp_f32 v45, v29
  v_mfma_f32_16x16x32_bf16 v[136:139], a[168:171], v[32:35], v[136:139]
  ds_read_b64_tr_b16 a[134:135], v73 offset:40960
  v_cvt_pk_bf16_f32 v38, v44, v45
  v_mfma_f32_16x16x32_bf16 v[140:143], a[172:175], v[32:35], v[140:143]
  v_exp_f32 v46, v30
  v_mfma_f32_16x16x32_bf16 v[144:147], a[176:179], v[32:35], v[144:147]
  ds_read_b64_tr_b16 a[136:137], v74 offset:32768
  v_mfma_f32_16x16x32_bf16 v[148:151], a[180:183], v[32:35], v[148:151]
  v_exp_f32 v47, v31
  v_mfma_f32_16x16x32_bf16 v[152:155], a[184:187], v[32:35], v[152:155]
  ds_read_b64_tr_b16 a[138:139], v74 offset:40960
  v_cvt_pk_bf16_f32 v39, v46, v47
  v_mfma_f32_16x16x32_bf16 v[156:159], a[188:191], v[32:35], v[156:159]
  v_mfma_f32_16x16x32_bf16 v[24:27], a[96:99], a[48:51], v[64:67]
  s_add_u32 m0, s43, 18432
  v_exp_f32 v40, v16
  v_mfma_f32_16x16x32_bf16 v[24:27], a[100:103], a[52:55], v[24:27]
  buffer_load_dwordx4 v82, s[12:15], s42 offen lds
  v_mfma_f32_16x16x32_bf16 v[24:27], a[104:107], a[56:59], v[24:27]
  v_exp_f32 v41, v17
  v_mfma_f32_16x16x32_bf16 v[24:27], a[108:111], a[60:63], v[24:27]
  ds_read_b64_tr_b16 a[140:141], v75 offset:32768
  v_cvt_pk_bf16_f32 v32, v40, v41
  v_mfma_f32_16x16x32_bf16 v[28:31], a[112:115], a[48:51], v[64:67]
  v_exp_f32 v42, v18
  v_mfma_f32_16x16x32_bf16 v[28:31], a[116:119], a[52:55], v[28:31]
  buffer_load_dwordx4 v83, s[12:15], s42 offen offset:1024 lds
  v_mfma_f32_16x16x32_bf16 v[28:31], a[120:123], a[56:59], v[28:31]
  s_add_u32 s42, s42, 8192
  v_exp_f32 v43, v19
  v_mfma_f32_16x16x32_bf16 v[28:31], a[124:127], a[60:63], v[28:31]
  ds_read_b64_tr_b16 a[142:143], v75 offset:40960
  v_cvt_pk_bf16_f32 v33, v42, v43
  v_mfma_f32_16x16x32_bf16 v[48:51], v[8:11], v[36:39], v[48:51]
  v_exp_f32 v44, v20
  v_mfma_f32_16x16x32_bf16 v[160:163], a[160:163], v[36:39], v[160:163]
  ds_read_b64_tr_b16 a[144:145], v76 offset:32768
  v_mfma_f32_16x16x32_bf16 v[164:167], a[164:167], v[36:39], v[164:167]
  v_exp_f32 v45, v21
  v_mfma_f32_16x16x32_bf16 v[168:171], a[168:171], v[36:39], v[168:171]
  ds_read_b64_tr_b16 a[146:147], v76 offset:40960
  v_cvt_pk_bf16_f32 v34, v44, v45
  v_mfma_f32_16x16x32_bf16 v[172:175], a[172:175], v[36:39], v[172:175]
  v_exp_f32 v46, v22
  v_mfma_f32_16x16x32_bf16 v[176:179], a[176:179], v[36:39], v[176:179]
  ds_read_b64_tr_b16 a[148:149], v77 offset:32768
  v_mfma_f32_16x16x32_bf16 v[180:183], a[180:183], v[36:39], v[180:183]
  v_exp_f32 v47, v23
  v_mfma_f32_16x16x32_bf16 v[184:187], a[184:187], v[36:39], v[184:187]
  ds_read_b64_tr_b16 a[150:151], v77 offset:40960
  v_cvt_pk_bf16_f32 v35, v46, v47
  v_mfma_f32_16x16x32_bf16 v[188:191], a[188:191], v[36:39], v[188:191]
  v_mfma_f32_16x16x32_bf16 v[16:19], a[64:67], a[0:3], v[52:55]
  v_exp_f32 v40, v24
  v_mfma_f32_16x16x32_bf16 v[16:19], a[68:71], a[4:7], v[16:19]
  ds_read_b64_tr_b16 a[152:153], v78 offset:32768
  v_mfma_f32_16x16x32_bf16 v[16:19], a[72:75], a[8:11], v[16:19]
  v_exp_f32 v41, v25
  v_mfma_f32_16x16x32_bf16 v[16:19], a[76:79], a[12:15], v[16:19]
  ds_read_b64_tr_b16 a[154:155], v78 offset:40960
  v_cvt_pk_bf16_f32 v36, v40, v41
  v_mfma_f32_16x16x32_bf16 v[20:23], a[80:83], a[0:3], v[52:55]
  v_exp_f32 v42, v26
  v_mfma_f32_16x16x32_bf16 v[20:23], a[84:87], a[4:7], v[20:23]
  ds_read_b64_tr_b16 a[156:157], v79 offset:32768
  v_mfma_f32_16x16x32_bf16 v[20:23], a[88:91], a[8:11], v[20:23]
  v_exp_f32 v43, v27
  v_mfma_f32_16x16x32_bf16 v[20:23], a[92:95], a[12:15], v[20:23]
  ds_read_b64_tr_b16 a[158:159], v79 offset:40960
  v_cvt_pk_bf16_f32 v37, v42, v43
  v_mfma_f32_16x16x32_bf16 v[120:123], v[124:127], v[32:35], v[120:123]
  v_exp_f32 v44, v28
  v_mfma_f32_16x16x32_bf16 v[192:195], a[160:163], v[32:35], v[192:195]
  ds_read_b128 a[96:99], v68 offset:32768
  v_mfma_f32_16x16x32_bf16 v[196:199], a[164:167], v[32:35], v[196:199]
  v_exp_f32 v45, v29
  v_mfma_f32_16x16x32_bf16 v[200:203], a[168:171], v[32:35], v[200:203]
  ds_read_b128 a[100:103], v69 offset:32768
  v_cvt_pk_bf16_f32 v38, v44, v45
  v_mfma_f32_16x16x32_bf16 v[204:207], a[172:175], v[32:35], v[204:207]
  v_exp_f32 v46, v30
  v_mfma_f32_16x16x32_bf16 v[208:211], a[176:179], v[32:35], v[208:211]
  ds_read_b128 a[104:107], v70 offset:32768
  v_mfma_f32_16x16x32_bf16 v[212:215], a[180:183], v[32:35], v[212:215]
  v_exp_f32 v47, v31
  v_mfma_f32_16x16x32_bf16 v[216:219], a[184:187], v[32:35], v[216:219]
  ds_read_b128 a[108:111], v71 offset:32768
  v_cvt_pk_bf16_f32 v39, v46, v47
  v_mfma_f32_16x16x32_bf16 v[220:223], a[188:191], v[32:35], v[220:223]
  v_readfirstlane_b32 s56, v14
  s_nop 3
  s_lshr_b32 s57, s56, 28
  s_cmp_eq_u32 s57, 4
  s_cbranch_scc0 L_slowpoll
L_polled:
  s_mov_b32 s76, 0
  s_mov_b32 s77, 0
  s_bfe_u32 s68, s56, 0x70000
  s_min_u32 s57, s68, 15
  s_lshl_b32 s57, s57, 2
  s_bfm_b64 s[58:59], s57, 0
  s_and_b32 s58, s58, 0x11111111
  s_and_b32 s59, s59, 0x11111111
  s_or_b64 s[76:77], s[76:77], s[58:59]
  s_bfe_u32 s69, s56, 0x70007
  s_min_u32 s57, s69, 15
  s_lshl_b32 s57, s57, 2
  s_bfm_b64 s[58:59], s57, 0
  s_and_b32 s58, s58, 0x22222222
  s_and_b32 s59, s59, 0x22222222
  s_or_b64 s[76:77], s[76:77], s[58:59]
  s_bfe_u32 s70, s56, 0x7000e
  s_min_u32 s57, s70, 15
  s_lshl_b32 s57, s57, 2
  s_bfm_b64 s[58:59], s57, 0
  s_and_b32 s58, s58, 0x44444444
  s_and_b32 s59, s59, 0x44444444
  s_or_b64 s[76:77], s[76:77], s[58:59]
  s_bfe_u32 s71, s56, 0x70015
  s_min_u32 s57, s71, 15
  s_lshl_b32 s57, s57, 2
  s_bfm_b64 s[58:59], s57, 0
  s_and_b32 s58, s58, 0x88888888
  s_and_b32 s59, s59, 0x88888888
  s_or_b64 s[76:77], s[76:77], s[58:59]
  s_bcnt1_i32_b64 s78, s[76:77]
  s_min_u32 s78, s78, 11
  s_add_u32 s85, s78, 1
  s_cmp_eq_u32 s78, 0
  s_cselect_b32 s85, 0, s85
  s_mov_b32 s79, -1
  s_mov_b32 s81, s94
  v_mfma_f32_16x16x32_bf16 v[24:27], a[64:67], a[16:19], v[56:59]
  s_ff1_i32_b64 s56, s[76:77]
  v_exp_f32 v40, v16
  v_mfma_f32_16x16x32_bf16 v[24:27], a[68:71], a[20:23], v[24:27]
  ds_read_b128 a[112:115], v68 offset:40960
  v_mfma_f32_16x16x32_bf16 v[24:27], a[72:75], a[24:27], v[24:27]
  s_cmp_eq_u32 s78, 0
  s_cselect_b32 s56, -1, s56
  v_exp_f32 v41, v17
  v_mfma_f32_16x16x32_bf16 v[24:27], a[76:79], a[28:31], v[24:27]
  ds_read_b128 a[116:119], v69 offset:40960
  v_cvt_pk_bf16_f32 v32, v40, v41
  v_mfma_f32_16x16x32_bf16 v[28:31], a[80:83], a[16:19], v[56:59]
  s_mov_b32 s80, s79
  s_mov_b32 s79, s56
  v_exp_f32 v42, v18
  v_mfma_f32_16x16x32_bf16 v[28:31], a[84:87], a[20:23], v[28:31]
  ds_read_b128 a[120:123], v70 offset:40960
  v_mfma_f32_16x16x32_bf16 v[28:31], a[88:91], a[24:27], v[28:31]
  s_mov_b32 s82, s81
  s_bitset0_b64 s[76:77], s56
  v_exp_f32 v43, v19
  v_mfma_f32_16x16x32_bf16 v[28:31], a[92:95], a[28:31], v[28:31]
  ds_read_b128 a[124:127], v71 offset:40960
  v_cvt_pk_bf16_f32 v33, v42, v43
  v_mfma_f32_16x16x32_bf16 v[120:123], v[8:11], v[36:39], v[120:123]
  s_sub_i32 s78, s78, 1
  s_max_i32 s78, s78, 0
  v_exp_f32 v44, v20
  v_mfma_f32_16x16x32_bf16 v[224:227], a[160:163], v[36:39], v[224:227]
  v_mfma_f32_16x16x32_bf16 v[228:231], a[164:167], v[36:39], v[228:231]
  s_and_b32 s57, s56, 3
  v_exp_f32 v45, v21
  v_mfma_f32_16x16x32_bf16 v[232:235], a[168:171], v[36:39], v[232:235]
  v_cvt_pk_bf16_f32 v34, v44, v45
  v_mfma_f32_16x16x32_bf16 v[236:239], a[172:175], v[36:39], v[236:239]
  s_mul_i32 s57, s57, 3072
  v_exp_f32 v46, v22
  v_mfma_f32_16x16x32_bf16 v[240:243], a[176:179], v[36:39], v[240:243]
  v_mfma_f32_16x16x32_bf16 v[244:247], a[180:183], v[36:39], v[244:247]
  s_waitcnt vmcnt(8) lgkmcnt(0)
  v_exp_f32 v47, v23
  v_mfma_f32_16x16x32_bf16 v[248:251], a[184:187], v[36:39], v[248:251]
  v_cvt_pk_bf16_f32 v35, v46, v47
  v_mfma_f32_16x16x32_bf16 v[252:255], a[188:191], v[36:39], v[252:255]
  s_barrier
  v_mfma_f32_16x16x32_bf16 v[16:19], a[64:67], a[32:35], v[60:63]
  v_exp_f32 v40, v24
  v_mfma_f32_16x16x32_bf16 v[16:19], a[68:71], a[36:39], v[16:19]
  ds_read_b64_tr_b16 a[160:161], v72 offset:49152
  v_mfma_f32_16x16x32_bf16 v[16:19], a[72:75], a[40:43], v[16:19]
  s_add_u32 m0, s43, 32768
  v_exp_f32 v41, v25
  v_mfma_f32_16x16x32_bf16 v[16:19], a[76:79], a[44:47], v[16:19]
  ds_read_b64_tr_b16 a[162:163], v72 offset:57344
  v_cvt_pk_bf16_f32 v36, v40, v41
  v_mfma_f32_16x16x32_bf16 v[20:23], a[80:83], a[32:35], v[60:63]
  s_lshr_b32 s58, s56, 2
  v_exp_f32 v42, v26
  v_mfma_f32_16x16x32_bf16 v[20:23], a[84:87], a[36:39], v[20:23]
  buffer_load_dwordx4 v80, s[8:11], s41 offen lds
  v_mfma_f32_16x16x32_bf16 v[20:23], a[88:91], a[40:43], v[20:23]
  s_mul_i32 s58, s58, 786432
  v_exp_f32 v43, v27
  v_mfma_f32_16x16x32_bf16 v[20:23], a[92:95], a[44:47], v[20:23]
  ds_read_b64_tr_b16 a[164:165], v73 offset:49152
  v_cvt_pk_bf16_f32 v37, v42, v43
  v_mfma_f32_16x16x32_bf16 v[48:51], v[124:127], v[32:35], v[48:51]
  v_exp_f32 v44, v28
  v_mfma_f32_16x16x32_bf16 v[128:131], a[128:131], v[32:35], v[128:131]
  buffer_load_dwordx4 v81, s[8:11], s41 offen offset:1024 lds
  v_mfma_f32_16x16x32_bf16 v[132:135], a[132:135], v[32:35], v[132:135]
  s_add_u32 s41, s41, 8192
  s_add_u32 s57, s57, s58
  v_exp_f32 v45, v29
  v_mfma_f32_16x16x32_bf16 v[136:139], a[136:139], v[32:35], v[136:139]
  ds_read_b64_tr_b16 a[166:167], v73 offset:57344
  v_cvt_pk_bf16_f32 v38, v44, v45
  v_mfma_f32_16x16x32_bf16 v[140:143], a[140:143], v[32:35], v[140:143]
  s_add_u32 s57, s57, s93
  v_exp_f32 v46, v30
  v_mfma_f32_16x16x32_bf16 v[144:147], a[144:147], v[32:35], v[144:147]
  ds_read_b64_tr_b16 a[168:169], v74 offset:49152
  v_mfma_f32_16x16x32_bf16 v[148:151], a[148:151], v[32:35], v[148:151]
  s_cmp_lt_i32 s56, 0
  s_cselect_b32 s81, s94, s57
  v_exp_f32 v47, v31
  v_mfma_f32_16x16x32_bf16 v[152:155], a[152:155], v[32:35], v[152:155]
  ds_read_b64_tr_b16 a[170:171], v74 offset:57344
  v_cvt_pk_bf16_f32 v39, v46, v47
  v_mfma_f32_16x16x32_bf16 v[156:159], a[156:159], v[32:35], v[156:159]
  v_mfma_f32_16x16x32_bf16 v[24:27], a[64:67], a[48:51], v[64:67]
  s_add_u32 m0, s43, 34816
  v_exp_f32 v40, v16
  v_mfma_f32_16x16x32_bf16 v[24:27], a[68:71], a[52:55], v[24:27]
  buffer_load_dwordx4 v82, s[12:15], s42 offen lds
  v_mfma_f32_16x16x32_bf16 v[24:27], a[72:75], a[56:59], v[24:27]
  v_exp_f32 v41, v17
  v_mfma_f32_16x16x32_bf16 v[24:27], a[76:79], a[60:63], v[24:27]
  ds_read_b64_tr_b16 a[172:173], v75 offset:49152
  v_cvt_pk_bf16_f32 v32, v40, v41
  v_mfma_f32_16x16x32_bf16 v[28:31], a[80:83], a[48:51], v[64:67]
  v_exp_f32 v42, v18
  v_mfma_f32_16x16x32_bf16 v[28:31], a[84:87], a[52:55], v[28:31]
  buffer_load_dwordx4 v83, s[12:15], s42 offen offset:1024 lds
  v_mfma_f32_16x16x32_bf16 v[28:31], a[88:91], a[56:59], v[28:31]
  s_add_u32 s42, s42, 8192
  v_exp_f32 v43, v19
  v_mfma_f32_16x16x32_bf16 v[28:31], a[92:95], a[60:63], v[28:31]
  ds_read_b64_tr_b16 a[174:175], v75 offset:57344
  v_cvt_pk_bf16_f32 v33, v42, v43
  v_mfma_f32_16x16x32_bf16 v[48:51], v[8:11], v[36:39], v[48:51]
  buffer_load_dwordx4 v[96:99], v15, s[32:35], s81 offen offset:0 sc1
  v_exp_f32 v44, v20
  v_mfma_f32_16x16x32_bf16 v[160:163], a[128:131], v[36:39], v[160:163]
  ds_read_b64_tr_b16 a[176:177], v76 offset:49152
  v_mfma_f32_16x16x32_bf16 v[164:167], a[132:135], v[36:39], v[164:167]
  buffer_load_dwordx4 v[100:103], v15, s[32:35], s81 offen offset:1024 sc1
  v_exp_f32 v45, v21
  v_mfma_f32_16x16x32_bf16 v[168:171], a[136:139], v[36:39], v[168:171]
  ds_read_b64_tr_b16 a[178:179], v76 offset:57344
  v_cvt_pk_bf16_f32 v34, v44, v45
  v_mfma_f32_16x16x32_bf16 v[172:175], a[140:143], v[36:39], v[172:175]
  buffer_load_dwordx4 v[104:107], v15, s[32:35], s82 offen offset:2048 sc1
  v_exp_f32 v46, v22
  v_mfma_f32_16x16x32_bf16 v[176:179], a[144:147], v[36:39], v[176:179]
  ds_read_b64_tr_b16 a[180:181], v77 offset:49152
  v_mfma_f32_16x16x32_bf16 v[180:183], a[148:151], v[36:39], v[180:183]
  v_exp_f32 v47, v23
  v_mfma_f32_16x16x32_bf16 v[184:187], a[152:155], v[36:39], v[184:187]
  ds_read_b64_tr_b16 a[182:183], v77 offset:57344
  v_cvt_pk_bf16_f32 v35, v46, v47
  v_mfma_f32_16x16x32_bf16 v[188:191], a[156:159], v[36:39], v[188:191]
  v_mfma_f32_16x16x32_bf16 v[16:19], a[96:99], a[0:3], v[52:55]
  v_exp_f32 v40, v24
  v_mfma_f32_16x16x32_bf16 v[16:19], a[100:103], a[4:7], v[16:19]
  ds_read_b64_tr_b16 a[184:185], v78 offset:49152
  v_mfma_f32_16x16x32_bf16 v[16:19], a[104:107], a[8:11], v[16:19]
  v_exp_f32 v41, v25
  v_mfma_f32_16x16x32_bf16 v[16:19], a[108:111], a[12:15], v[16:19]
  ds_read_b64_tr_b16 a[186:187], v78 offset:57344
  v_cvt_pk_bf16_f32 v36, v40, v41
  v_mfma_f32_16x16x32_bf16 v[20:23], a[112:115], a[0:3], v[52:55]
  v_exp_f32 v42, v26
  v_mfma_f32_16x16x32_bf16 v[20:23], a[116:119], a[4:7], v[20:23]
  ds_read_b64_tr_b16 a[188:189], v79 offset:49152
  v_mfma_f32_16x16x32_bf16 v[20:23], a[120:123], a[8:11], v[20:23]
  v_exp_f32 v43, v27
  v_mfma_f32_16x16x32_bf16 v[20:23], a[124:127], a[12:15], v[20:23]
  ds_read_b64_tr_b16 a[190:191], v79 offset:57344
  v_cvt_pk_bf16_f32 v37, v42, v43
  v_mfma_f32_16x16x32_bf16 v[120:123], v[124:127], v[32:35], v[120:123]
  v_exp_f32 v44, v28
  v_mfma_f32_16x16x32_bf16 v[192:195], a[128:131], v[32:35], v[192:195]
  ds_read_b128 a[64:67], v68 offset:49152
  v_mfma_f32_16x16x32_bf16 v[196:199], a[132:135], v[32:35], v[196:199]
  v_exp_f32 v45, v29
  v_mfma_f32_16x16x32_bf16 v[200:203], a[136:139], v[32:35], v[200:203]
  ds_read_b128 a[68:71], v69 offset:49152
  v_cvt_pk_bf16_f32 v38, v44, v45
  v_mfma_f32_16x16x32_bf16 v[204:207], a[140:143], v[32:35], v[204:207]
  v_exp_f32 v46, v30
  v_mfma_f32_16x16x32_bf16 v[208:211], a[144:147], v[32:35], v[208:211]
  ds_read_b128 a[72:75], v70 offset:49152
  v_mfma_f32_16x16x32_bf16 v[212:215], a[148:151], v[32:35], v[212:215]
  v_exp_f32 v47, v31
  v_mfma_f32_16x16x32_bf16 v[216:219], a[152:155], v[32:35], v[216:219]
  ds_read_b128 a[76:79], v71 offset:49152
  v_cvt_pk_bf16_f32 v39, v46, v47
  v_mfma_f32_16x16x32_bf16 v[220:223], a[156:159], v[32:35], v[220:223]
  v_mfma_f32_16x16x32_bf16 v[24:27], a[96:99], a[16:19], v[56:59]
  v_exp_f32 v40, v16
  v_mfma_f32_16x16x32_bf16 v[24:27], a[100:103], a[20:23], v[24:27]
  ds_read_b128 a[80:83], v68 offset:57344
  v_mfma_f32_16x16x32_bf16 v[24:27], a[104:107], a[24:27], v[24:27]
  v_exp_f32 v41, v17
  v_mfma_f32_16x16x32_bf16 v[24:27], a[108:111], a[28:31], v[24:27]
  ds_read_b128 a[84:87], v69 offset:57344
  v_cvt_pk_bf16_f32 v32, v40, v41
  v_mfma_f32_16x16x32_bf16 v[28:31], a[112:115], a[16:19], v[56:59]
  v_exp_f32 v42, v18
  v_mfma_f32_16x16x32_bf16 v[28:31], a[116:119], a[20:23], v[28:31]
  ds_read_b128 a[88:91], v70 offset:57344
  v_mfma_f32_16x16x32_bf16 v[28:31], a[120:123], a[24:27], v[28:31]
  v_exp_f32 v43, v19
  v_mfma_f32_16x16x32_bf16 v[28:31], a[124:127], a[28:31], v[28:31]
  ds_read_b128 a[92:95], v71 offset:57344
  v_cvt_pk_bf16_f32 v33, v42, v43
  v_mfma_f32_16x16x32_bf16 v[120:123], v[8:11], v[36:39], v[120:123]
  v_exp_f32 v44, v20
  v_mfma_f32_16x16x32_bf16 v[224:227], a[128:131], v[36:39], v[224:227]
  v_mfma_f32_16x16x32_bf16 v[228:231], a[132:135], v[36:39], v[228:231]
  v_exp_f32 v45, v21
  v_mfma_f32_16x16x32_bf16 v[232:235], a[136:139], v[36:39], v[232:235]
  v_cvt_pk_bf16_f32 v34, v44, v45
  v_mfma_f32_16x16x32_bf16 v[236:239], a[140:143], v[36:39], v[236:239]
  v_exp_f32 v46, v22
  v_mfma_f32_16x16x32_bf16 v[240:243], a[144:147], v[36:39], v[240:243]
  v_mfma_f32_16x16x32_bf16 v[244:247], a[148:151], v[36:39], v[244:247]
  s_waitcnt vmcnt(11) lgkmcnt(0)
  v_exp_f32 v47, v23
  v_mfma_f32_16x16x32_bf16 v[248:251], a[152:155], v[36:39], v[248:251]
  v_cvt_pk_bf16_f32 v35, v46, v47
  v_mfma_f32_16x16x32_bf16 v[252:255], a[156:159], v[36:39], v[252:255]
  s_barrier
  v_mfma_f32_16x16x32_bf16 v[16:19], a[96:99], a[32:35], v[60:63]
  v_exp_f32 v40, v24
  v_mfma_f32_16x16x32_bf16 v[16:19], a[100:103], a[36:39], v[16:19]
  ds_read_b64_tr_b16 a[128:129], v72 offset:0
  v_mfma_f32_16x16x32_bf16 v[16:19], a[104:107], a[40:43], v[16:19]
  s_add_u32 m0, s43, 49152
  v_exp_f32 v41, v25
  v_mfma_f32_16x16x32_bf16 v[16:19], a[108:111], a[44:47], v[16:19]
  ds_read_b64_tr_b16 a[130:131], v72 offset:8192
  v_cvt_pk_bf16_f32 v36, v40, v41
  v_mfma_f32_16x16x32_bf16 v[20:23], a[112:115], a[32:35], v[60:63]
  v_exp_f32 v42, v26
  v_mfma_f32_16x16x32_bf16 v[20:23], a[116:119], a[36:39], v[20:23]
  buffer_load_dwordx4 v80, s[8:11], s41 offen lds
  v_mfma_f32_16x16x32_bf16 v[20:23], a[120:123], a[40:43], v[20:23]
  v_exp_f32 v43, v27
  v_mfma_f32_16x16x32_bf16 v[20:23], a[124:127], a[44:47], v[20:23]
  ds_read_b64_tr_b16 a[132:133], v73 offset:0
  v_cvt_pk_bf16_f32 v37, v42, v43
  v_mfma_f32_16x16x32_bf16 v[48:51], v[124:127], v[32:35], v[48:51]
  v_exp_f32 v44, v28
  v_mfma_f32_16x16x32_bf16 v[128:131], a[160:163], v[32:35], v[128:131]
  buffer_load_dwordx4 v81, s[8:11], s41 offen offset:1024 lds
  v_mfma_f32_16x16x32_bf16 v[132:135], a[164:167], v[32:35], v[132:135]
  s_add_u32 s41, s41, 8192
  v_exp_f32 v45, v29
  v_mfma_f32_16x16x32_bf16 v[136:139], a[168:171], v[32:35], v[136:139]
  ds_read_b64_tr_b16 a[134:135], v73 offset:8192
  v_cvt_pk_bf16_f32 v38, v44, v45
  v_mfma_f32_16x16x32_bf16 v[140:143], a[172:175], v[32:35], v[140:143]
  v_exp_f32 v46, v30
  v_mfma_f32_16x16x32_bf16 v[144:147], a[176:179], v[32:35], v[144:147]
  ds_read_b64_tr_b16 a[136:137], v74 offset:0
  v_mfma_f32_16x16x32_bf16 v[148:151], a[180:183], v[32:35], v[148:151]
  v_exp_f32 v47, v31
  v_mfma_f32_16x16x32_bf16 v[152:155], a[184:187], v[32:35], v[152:155]
  ds_read_b64_tr_b16 a[138:139], v74 offset:8192
  v_cvt_pk_bf16_f32 v39, v46, v47
  v_mfma_f32_16x16x32_bf16 v[156:159], a[188:191], v[32:35], v[156:159]
  v_mfma_f32_16x16x32_bf16 v[24:27], a[96:99], a[48:51], v[64:67]
  s_add_u32 m0, s43, 51200
  v_exp_f32 v40, v16
  v_mfma_f32_16x16x32_bf16 v[24:27], a[100:103], a[52:55], v[24:27]
  buffer_load_dwordx4 v82, s[12:15], s42 offen lds
  v_mfma_f32_16x16x32_bf16 v[24:27], a[104:107], a[56:59], v[24:27]
  v_exp_f32 v41, v17
  v_mfma_f32_16x16x32_bf16 v[24:27], a[108:111], a[60:63], v[24:27]
  ds_read_b64_tr_b16 a[140:141], v75 offset:0
  v_cvt_pk_bf16_f32 v32, v40, v41
  v_mfma_f32_16x16x32_bf16 v[28:31], a[112:115], a[48:51], v[64:67]
  v_exp_f32 v42, v18
  v_mfma_f32_16x16x32_bf16 v[28:31], a[116:119], a[52:55], v[28:31]
  buffer_load_dwordx4 v83, s[12:15], s42 offen offset:1024 lds
  v_mfma_f32_16x16x32_bf16 v[28:31], a[120:123], a[56:59], v[28:31]
  s_add_u32 s42, s42, 8192
  v_exp_f32 v43, v19
  v_mfma_f32_16x16x32_bf16 v[28:31], a[124:127], a[60:63], v[28:31]
  ds_read_b64_tr_b16 a[142:143], v75 offset:8192
  v_cvt_pk_bf16_f32 v33, v42, v43
  v_mfma_f32_16x16x32_bf16 v[48:51], v[8:11], v[36:39], v[48:51]
  v_exp_f32 v44, v20
  v_mfma_f32_16x16x32_bf16 v[160:163], a[160:163], v[36:39], v[160:163]
  ds_read_b64_tr_b16 a[144:145], v76 offset:0
  v_mfma_f32_16x16x32_bf16 v[164:167], a[164:167], v[36:39], v[164:167]
  v_exp_f32 v45, v21
  v_mfma_f32_16x16x32_bf16 v[168:171], a[168:171], v[36:39], v[168:171]
  ds_read_b64_tr_b16 a[146:147], v76 offset:8192
  v_cvt_pk_bf16_f32 v34, v44, v45
  v_mfma_f32_16x16x32_bf16 v[172:175], a[172:175], v[36:39], v[172:175]
  v_exp_f32 v46, v22
  v_mfma_f32_16x16x32_bf16 v[176:179], a[176:179], v[36:39], v[176:179]
  ds_read_b64_tr_b16 a[148:149], v77 offset:0
  v_mfma_f32_16x16x32_bf16 v[180:183], a[180:183], v[36:39], v[180:183]
  v_exp_f32 v47, v23
  v_mfma_f32_16x16x32_bf16 v[184:187], a[184:187], v[36:39], v[184:187]
  ds_read_b64_tr_b16 a[150:151], v77 offset:8192
  v_cvt_pk_bf16_f32 v35, v46, v47
  v_mfma_f32_16x16x32_bf16 v[188:191], a[188:191], v[36:39], v[188:191]
  v_mfma_f32_16x16x32_bf16 v[16:19], a[64:67], a[0:3], v[52:55]
  v_exp_f32 v40, v24
  v_mfma_f32_16x16x32_bf16 v[16:19], a[68:71], a[4:7], v[16:19]
  ds_read_b64_tr_b16 a[152:153], v78 offset:0
  v_mfma_f32_16x16x32_bf16 v[16:19], a[72:75], a[8:11], v[16:19]
  v_exp_f32 v41, v25
  v_mfma_f32_16x16x32_bf16 v[16:19], a[76:79], a[12:15], v[16:19]
  ds_read_b64_tr_b16 a[154:155], v78 offset:8192
  v_cvt_pk_bf16_f32 v36, v40, v41
  v_mfma_f32_16x16x32_bf16 v[20:23], a[80:83], a[0:3], v[52:55]
  v_exp_f32 v42, v26
  v_mfma_f32_16x16x32_bf16 v[20:23], a[84:87], a[4:7], v[20:23]
  ds_read_b64_tr_b16 a[156:157], v79 offset:0
  v_mfma_f32_16x16x32_bf16 v[20:23], a[88:91], a[8:11], v[20:23]
  v_exp_f32 v43, v27
  v_mfma_f32_16x16x32_bf16 v[20:23], a[92:95], a[12:15], v[20:23]
  ds_read_b64_tr_b16 a[158:159], v79 offset:8192
  v_cvt_pk_bf16_f32 v37, v42, v43
  v_mfma_f32_16x16x32_bf16 v[120:123], v[124:127], v[32:35], v[120:123]
  v_exp_f32 v44, v28
  v_mfma_f32_16x16x32_bf16 v[192:195], a[160:163], v[32:35], v[192:195]
  ds_read_b128 a[96:99], v68 offset:0
  v_mfma_f32_16x16x32_bf16 v[196:199], a[164:167], v[32:35], v[196:199]
  s_sub_u32 s44, 12, s85
  v_exp_f32 v45, v29
  v_mfma_f32_16x16x32_bf16 v[200:203], a[168:171], v[32:35], v[200:203]
  ds_read_b128 a[100:103], v69 offset:0
  v_cvt_pk_bf16_f32 v38, v44, v45
  v_mfma_f32_16x16x32_bf16 v[204:207], a[172:175], v[32:35], v[204:207]
  s_cmp_eq_u32 s85, 0
  v_exp_f32 v46, v30
  v_mfma_f32_16x16x32_bf16 v[208:211], a[176:179], v[32:35], v[208:211]
  ds_read_b128 a[104:107], v70 offset:0
  v_mfma_f32_16x16x32_bf16 v[212:215], a[180:183], v[32:35], v[212:215]
  v_exp_f32 v47, v31
  v_mfma_f32_16x16x32_bf16 v[216:219], a[184:187], v[32:35], v[216:219]
  ds_read_b128 a[108:111], v71 offset:0
  v_cvt_pk_bf16_f32 v39, v46, v47
  v_mfma_f32_16x16x32_bf16 v[220:223], a[188:191], v[32:35], v[220:223]
  s_cbranch_scc1 L_B_entry
.p2align 3
L_A0n:
  v_mfma_f32_16x16x32_bf16 v[24:27], a[64:67], a[16:19], v[56:59]
  v_exp_f32 v40, v16
  v_mfma_f32_16x16x32_bf16 v[24:27], a[68:71], a[20:23], v[24:27]
  ds_read_b128 a[112:115], v68 offset:8192
  v_mfma_f32_16x16x32_bf16 v[24:27], a[72:75], a[24:27], v[24:27]
  v_exp_f32 v41, v17
  v_mfma_f32_16x16x32_bf16 v[24:27], a[76:79], a[28:31], v[24:27]
  ds_read_b128 a[116:119], v69 offset:8192
  v_cvt_pk_bf16_f32 v32, v40, v41
  v_mfma_f32_16x16x32_bf16 v[28:31], a[80:83], a[16:19], v[56:59]
  v_exp_f32 v42, v18
  v_mfma_f32_16x16x32_bf16 v[28:31], a[84:87], a[20:23], v[28:31]
  ds_read_b128 a[120:123], v70 offset:8192
  v_mfma_f32_16x16x32_bf16 v[28:31], a[88:91], a[24:27], v[28:31]
  s_waitcnt vmcnt(4)
  v_exp_f32 v43, v19
  v_mfma_f32_16x16x32_bf16 v[28:31], a[92:95], a[28:31], v[28:31]
  ds_read_b128 a[124:127], v71 offset:8192
  v_cvt_pk_bf16_f32 v33, v42, v43
  v_mfma_f32_16x16x32_bf16 v[120:123], v[8:11], v[36:39], v[120:123]
  s_mov_b32 m0, s64
  v_exp_f32 v44, v20
  v_mfma_f32_16x16x32_bf16 v[224:227], a[160:163], v[36:39], v[224:227]
  buffer_load_dwordx4 v96, s[20:23], 0 offen offset:0 lds
  v_mfma_f32_16x16x32_bf16 v[228:231], a[164:167], v[36:39], v[228:231]
  v_exp_f32 v45, v21
  v_mfma_f32_16x16x32_bf16 v[232:235], a[168:171], v[36:39], v[232:235]
  buffer_load_dwordx4 v97, s[20:23], 0 offen offset:1024 lds
  v_cvt_pk_bf16_f32 v34, v44, v45
  v_mfma_f32_16x16x32_bf16 v[236:239], a[172:175], v[36:39], v[236:239]
  v_exp_f32 v46, v22
  v_mfma_f32_16x16x32_bf16 v[240:243], a[176:179], v[36:39], v[240:243]
  buffer_load_dwordx4 v98, s[20:23], 0 offen offset:2048 lds
  v_mfma_f32_16x16x32_bf16 v[244:247], a[180:183], v[36:39], v[244:247]
  s_waitcnt vmcnt(14) lgkmcnt(0)
  v_exp_f32 v47, v23
  v_mfma_f32_16x16x32_bf16 v[248:251], a[184:187], v[36:39], v[248:251]
  buffer_load_dwordx4 v99, s[20:23], 0 offen offset:3072 lds
  v_cvt_pk_bf16_f32 v35, v46, v47
  v_mfma_f32_16x16x32_bf16 v[252:255], a[188:191], v[36:39], v[252:255]
  s_barrier
  v_mfma_f32_16x16x32_bf16 v[16:19], a[64:67], a[32:35], v[60:63]
  v_exp_f32 v40, v24
  v_mfma_f32_16x16x32_bf16 v[16:19], a[68:71], a[36:39], v[16:19]
  ds_read_b64_tr_b16 a[160:161], v72 offset:16384
  v_mfma_f32_16x16x32_bf16 v[16:19], a[72:75], a[40:43], v[16:19]
  s_add_u32 m0, s43, 0
  v_exp_f32 v41, v25
  v_mfma_f32_16x16x32_bf16 v[16:19], a[76:79], a[44:47], v[16:19]
  ds_read_b64_tr_b16 a[162:163], v72 offset:24576
  v_cvt_pk_bf16_f32 v36, v40, v41
  v_mfma_f32_16x16x32_bf16 v[20:23], a[80:83], a[32:35], v[60:63]
  v_exp_f32 v42, v26
  v_mfma_f32_16x16x32_bf16 v[20:23], a[84:87], a[36:39], v[20:23]
  buffer_load_dwordx4 v80, s[8:11], s41 offen lds
  v_mfma_f32_16x16x32_bf16 v[20:23], a[88:91], a[40:43], v[20:23]
  v_exp_f32 v43, v27
  v_mfma_f32_16x16x32_bf16 v[20:23], a[92:95], a[44:47], v[20:23]
  ds_read_b64_tr_b16 a[164:165], v73 offset:16384
  v_cvt_pk_bf16_f32 v37, v42, v43
  v_mfma_f32_16x16x32_bf16 v[48:51], v[124:127], v[32:35], v[48:51]
  v_exp_f32 v44, v28
  v_mfma_f32_16x16x32_bf16 v[128:131], a[128:131], v[32:35], v[128:131]
  buffer_load_dwordx4 v81, s[8:11], s41 offen offset:1024 lds
  v_mfma_f32_16x16x32_bf16 v[132:135], a[132:135], v[32:35], v[132:135]
  s_add_u32 s41, s41, 8192
  v_exp_f32 v45, v29
  v_mfma_f32_16x16x32_bf16 v[136:139], a[136:139], v[32:35], v[136:139]
  ds_read_b64_tr_b16 a[166:167], v73 offset:24576
  v_cvt_pk_bf16_f32 v38, v44, v45
  v_mfma_f32_16x16x32_bf16 v[140:143], a[140:143], v[32:35], v[140:143]
  v_exp_f32 v46, v30
  v_mfma_f32_16x16x32_bf16 v[144:147], a[144:147], v[32:35], v[144:147]
  ds_read_b64_tr_b16 a[168:169], v74 offset:16384
  v_mfma_f32_16x16x32_bf16 v[148:151], a[148:151], v[32:35], v[148:151]
  v_exp_f32 v47, v31
  v_mfma_f32_16x16x32_bf16 v[152:155], a[152:155], v[32:35], v[152:155]
  ds_read_b64_tr_b16 a[170:171], v74 offset:24576
  v_cvt_pk_bf16_f32 v39, v46, v47
  v_mfma_f32_16x16x32_bf16 v[156:159], a[156:159], v[32:35], v[156:159]
  v_mfma_f32_16x16x32_bf16 v[24:27], a[64:67], a[48:51], v[64:67]
  s_add_u32 m0, s43, 2048
  v_exp_f32 v40, v16
  v_mfma_f32_16x16x32_bf16 v[24:27], a[68:71], a[52:55], v[24:27]
  buffer_load_dwordx4 v82, s[12:15], s42 offen lds
  v_mfma_f32_16x16x32_bf16 v[24:27], a[72:75], a[56:59], v[24:27]
  v_exp_f32 v41, v17
  v_mfma_f32_16x16x32_bf16 v[24:27], a[76:79], a[60:63], v[24:27]
  ds_read_b64_tr_b16 a[172:173], v75 offset:16384
  v_cvt_pk_bf16_f32 v32, v40, v41
  v_mfma_f32_16x16x32_bf16 v[28:31], a[80:83], a[48:51], v[64:67]
  v_exp_f32 v42, v18
  v_mfma_f32_16x16x32_bf16 v[28:31], a[84:87], a[52:55], v[28:31]
  buffer_load_dwordx4 v83, s[12:15], s42 offen offset:1024 lds
  v_mfma_f32_16x16x32_bf16 v[28:31], a[88:91], a[56:59], v[28:31]
  s_add_u32 s42, s42, 8192
  v_exp_f32 v43, v19
  v_mfma_f32_16x16x32_bf16 v[28:31], a[92:95], a[60:63], v[28:31]
  ds_read_b64_tr_b16 a[174:175], v75 offset:24576
  v_cvt_pk_bf16_f32 v33, v42, v43
  v_mfma_f32_16x16x32_bf16 v[48:51], v[8:11], v[36:39], v[48:51]
  v_exp_f32 v44, v20
  v_mfma_f32_16x16x32_bf16 v[160:163], a[128:131], v[36:39], v[160:163]
  ds_read_b64_tr_b16 a[176:177], v76 offset:16384
  v_mfma_f32_16x16x32_bf16 v[164:167], a[132:135], v[36:39], v[164:167]
  v_exp_f32 v45, v21
  v_mfma_f32_16x16x32_bf16 v[168:171], a[136:139], v[36:39], v[168:171]
  ds_read_b64_tr_b16 a[178:179], v76 offset:24576
  v_cvt_pk_bf16_f32 v34, v44, v45
  v_mfma_f32_16x16x32_bf16 v[172:175], a[140:143], v[36:39], v[172:175]
  v_exp_f32 v46, v22
  v_mfma_f32_16x16x32_bf16 v[176:179], a[144:147], v[36:39], v[176:179]
  ds_read_b64_tr_b16 a[180:181], v77 offset:16384
  v_mfma_f32_16x16x32_bf16 v[180:183], a[148:151], v[36:39], v[180:183]
  v_exp_f32 v47, v23
  v_mfma_f32_16x16x32_bf16 v[184:187], a[152:155], v[36:39], v[184:187]
  ds_read_b64_tr_b16 a[182:183], v77 offset:24576
  v_cvt_pk_bf16_f32 v35, v46, v47
  v_mfma_f32_16x16x32_bf16 v[188:191], a[156:159], v[36:39], v[188:191]
  v_mfma_f32_16x16x32_bf16 v[16:19], a[96:99], a[0:3], v[52:55]
  v_exp_f32 v40, v24
  v_mfma_f32_16x16x32_bf16 v[16:19], a[100:103], a[4:7], v[16:19]
  ds_read_b64_tr_b16 a[184:185], v78 offset:16384
  v_mfma_f32_16x16x32_bf16 v[16:19], a[104:107], a[8:11], v[16:19]
  v_exp_f32 v41, v25
  v_mfma_f32_16x16x32_bf16 v[16:19], a[108:111], a[12:15], v[16:19]
  ds_read_b64_tr_b16 a[186:187], v78 offset:24576
  v_cvt_pk_bf16_f32 v36, v40, v41
  v_mfma_f32_16x16x32_bf16 v[20:23], a[112:115], a[0:3], v[52:55]
  v_exp_f32 v42, v26
  v_mfma_f32_16x16x32_bf16 v[20:23], a[116:119], a[4:7], v[20:23]
  ds_read_b64_tr_b16 a[188:189], v79 offset:16384
  v_mfma_f32_16x16x32_bf16 v[20:23], a[120:123], a[8:11], v[20:23]
  v_exp_f32 v43, v27
  v_mfma_f32_16x16x32_bf16 v[20:23], a[124:127], a[12:15], v[20:23]
  ds_read_b64_tr_b16 a[190:191], v79 offset:24576
  v_cvt_pk_bf16_f32 v37, v42, v43
  v_mfma_f32_16x16x32_bf16 v[120:123], v[124:127], v[32:35], v[120:123]
  v_exp_f32 v44, v28
  v_mfma_f32_16x16x32_bf16 v[192:195], a[128:131], v[32:35], v[192:195]
  ds_read_b128 a[64:67], v68 offset:16384
  v_mfma_f32_16x16x32_bf16 v[196:199], a[132:135], v[32:35], v[196:199]
  v_exp_f32 v45, v29
  v_mfma_f32_16x16x32_bf16 v[200:203], a[136:139], v[32:35], v[200:203]
  ds_read_b128 a[68:71], v69 offset:16384
  v_cvt_pk_bf16_f32 v38, v44, v45
  v_mfma_f32_16x16x32_bf16 v[204:207], a[140:143], v[32:35], v[204:207]
  v_exp_f32 v46, v30
  v_mfma_f32_16x16x32_bf16 v[208:211], a[144:147], v[32:35], v[208:211]
  ds_read_b128 a[72:75], v70 offset:16384
  v_mfma_f32_16x16x32_bf16 v[212:215], a[148:151], v[32:35], v[212:215]
  s_add_u32 m0, s64, 4096
  v_exp_f32 v47, v31
  v_mfma_f32_16x16x32_bf16 v[216:219], a[152:155], v[32:35], v[216:219]
  ds_read_b128 a[76:79], v71 offset:16384
  v_cvt_pk_bf16_f32 v39, v46, v47
  v_mfma_f32_16x16x32_bf16 v[220:223], a[156:159], v[32:35], v[220:223]
  buffer_load_dwordx4 v100, s[20:23], 0 offen offset:0 lds
.p2align 3
L_A1:
  v_mfma_f32_16x16x32_bf16 v[24:27], a[96:99], a[16:19], v[56:59]
  s_ff1_i32_b64 s56, s[76:77]
  v_exp_f32 v40, v16
  v_mfma_f32_16x16x32_bf16 v[24:27], a[100:103], a[20:23], v[24:27]
  ds_read_b128 a[80:83], v68 offset:24576
  buffer_load_dwordx4 v101, s[20:23], 0 offen offset:1024 lds
  v_mfma_f32_16x16x32_bf16 v[24:27], a[104:107], a[24:27], v[24:27]
  s_cmp_eq_u32 s78, 0
  s_cselect_b32 s56, -1, s56
  v_exp_f32 v41, v17
  v_mfma_f32_16x16x32_bf16 v[24:27], a[108:111], a[28:31], v[24:27]
  ds_read_b128 a[84:87], v69 offset:24576
  v_cvt_pk_bf16_f32 v32, v40, v41
  v_mfma_f32_16x16x32_bf16 v[28:31], a[112:115], a[16:19], v[56:59]
  s_mov_b32 s80, s79
  s_mov_b32 s79, s56
  v_exp_f32 v42, v18
  v_mfma_f32_16x16x32_bf16 v[28:31], a[116:119], a[20:23], v[28:31]
  ds_read_b128 a[88:91], v70 offset:24576
  buffer_load_dwordx4 v102, s[20:23], 0 offen offset:2048 lds
  v_mfma_f32_16x16x32_bf16 v[28:31], a[120:123], a[24:27], v[28:31]
  s_mov_b32 s82, s81
  s_bitset0_b64 s[76:77], s56
  v_exp_f32 v43, v19
  v_mfma_f32_16x16x32_bf16 v[28:31], a[124:127], a[28:31], v[28:31]
  ds_read_b128 a[92:95], v71 offset:24576
  v_cvt_pk_bf16_f32 v33, v42, v43
  v_mfma_f32_16x16x32_bf16 v[120:123], v[8:11], v[36:39], v[120:123]
  s_sub_i32 s78, s78, 1
  s_max_i32 s78, s78, 0
  v_exp_f32 v44, v20
  v_mfma_f32_16x16x32_bf16 v[224:227], a[128:131], v[36:39], v[224:227]
  buffer_load_dwordx4 v103, s[20:23], 0 offen offset:3072 lds
  v_mfma_f32_16x16x32_bf16 v[228:231], a[132:135], v[36:39], v[228:231]
  s_add_u32 m0, s64, 8192
  v_exp_f32 v45, v21
  v_mfma_f32_16x16x32_bf16 v[232:235], a[136:139], v[36:39], v[232:235]
  buffer_load_dwordx4 v96, s[24:27], 0 offen offset:0 lds
  v_cvt_pk_bf16_f32 v34, v44, v45
  v_mfma_f32_16x16x32_bf16 v[236:239], a[140:143], v[36:39], v[236:239]
  s_and_b32 s57, s56, 3
  v_exp_f32 v46, v22
  v_mfma_f32_16x16x32_bf16 v[240:243], a[144:147], v[36:39], v[240:243]
  buffer_load_dwordx4 v97, s[24:27], 0 offen offset:1024 lds
  v_mfma_f32_16x16x32_bf16 v[244:247], a[148:151], v[36:39], v[244:247]
  s_waitcnt vmcnt(18) lgkmcnt(0)
  v_exp_f32 v47, v23
  v_mfma_f32_16x16x32_bf16 v[248:251], a[152:155], v[36:39], v[248:251]
  buffer_load_dwordx4 v98, s[24:27], 0 offen offset:2048 lds
  v_cvt_pk_bf16_f32 v35, v46, v47
  v_mfma_f32_16x16x32_bf16 v[252:255], a[156:159], v[36:39], v[252:255]
  s_barrier
  v_mfma_f32_16x16x32_bf16 v[16:19], a[96:99], a[32:35], v[60:63]
  v_exp_f32 v40, v24
  v_mfma_f32_16x16x32_bf16 v[16:19], a[100:103], a[36:39], v[16:19]
  ds_read_b64_tr_b16 a[128:129], v72 offset:32768
  buffer_load_dwordx4 v99, s[24:27], 0 offen offset:3072 lds
  v_mfma_f32_16x16x32_bf16 v[16:19], a[104:107], a[40:43], v[16:19]
  s_add_u32 m0, s43, 16384
  v_exp_f32 v41, v25
  v_mfma_f32_16x16x32_bf16 v[16:19], a[108:111], a[44:47], v[16:19]
  ds_read_b64_tr_b16 a[130:131], v72 offset:40960
  v_cvt_pk_bf16_f32 v36, v40, v41
  v_mfma_f32_16x16x32_bf16 v[20:23], a[112:115], a[32:35], v[60:63]
  s_mul_i32 s57, s57, 3072
  v_exp_f32 v42, v26
  v_mfma_f32_16x16x32_bf16 v[20:23], a[116:119], a[36:39], v[20:23]
  buffer_load_dwordx4 v80, s[8:11], s41 offen lds
  v_mfma_f32_16x16x32_bf16 v[20:23], a[120:123], a[40:43], v[20:23]
  s_lshr_b32 s58, s56, 2
  v_exp_f32 v43, v27
  v_mfma_f32_16x16x32_bf16 v[20:23], a[124:127], a[44:47], v[20:23]
  ds_read_b64_tr_b16 a[132:133], v73 offset:32768
  v_cvt_pk_bf16_f32 v37, v42, v43
  v_mfma_f32_16x16x32_bf16 v[48:51], v[124:127], v[32:35], v[48:51]
  s_mul_i32 s58, s58, 786432
  v_exp_f32 v44, v28
  v_mfma_f32_16x16x32_bf16 v[128:131], a[160:163], v[32:35], v[128:131]
  buffer_load_dwordx4 v81, s[8:11], s41 offen offset:1024 lds
  v_mfma_f32_16x16x32_bf16 v[132:135], a[164:167], v[32:35], v[132:135]
  s_add_u32 s41, s41, 8192
  v_exp_f32 v45, v29
  v_mfma_f32_16x16x32_bf16 v[136:139], a[168:171], v[32:35], v[136:139]
  ds_read_b64_tr_b16 a[134:135], v73 offset:40960
  v_cvt_pk_bf16_f32 v38, v44, v45
  v_mfma_f32_16x16x32_bf16 v[140:143], a[172:175], v[32:35], v[140:143]
  s_add_u32 s57, s57, s58
  v_exp_f32 v46, v30
  v_mfma_f32_16x16x32_bf16 v[144:147], a[176:179], v[32:35], v[144:147]
  ds_read_b64_tr_b16 a[136:137], v74 offset:32768
  v_mfma_f32_16x16x32_bf16 v[148:151], a[180:183], v[32:35], v[148:151]
  s_add_u32 s57, s57, s93
  v_exp_f32 v47, v31
  v_mfma_f32_16x16x32_bf16 v[152:155], a[184:187], v[32:35], v[152:155]
  ds_read_b64_tr_b16 a[138:139], v74 offset:40960
  v_cvt_pk_bf16_f32 v39, v46, v47
  v_mfma_f32_16x16x32_bf16 v[156:159], a[188:191], v[32:35], v[156:159]
  v_mfma_f32_16x16x32_bf16 v[24:27], a[96:99], a[48:51], v[64:67]
  s_add_u32 m0, s43, 18432
  v_exp_f32 v40, v16
  v_mfma_f32_16x16x32_bf16 v[24:27], a[100:103], a[52:55], v[24:27]
  buffer_load_dwordx4 v82, s[12:15], s42 offen lds
  v_mfma_f32_16x16x32_bf16 v[24:27], a[104:107], a[56:59], v[24:27]
  s_cmp_lt_i32 s56, 0
  s_cselect_b32 s81, s94, s57
  v_exp_f32 v41, v17
  v_mfma_f32_16x16x32_bf16 v[24:27], a[108:111], a[60:63], v[24:27]
  ds_read_b64_tr_b16 a[140:141], v75 offset:32768
  v_cvt_pk_bf16_f32 v32, v40, v41
  v_mfma_f32_16x16x32_bf16 v[28:31], a[112:115], a[48:51], v[64:67]
  v_exp_f32 v42, v18
  v_mfma_f32_16x16x32_bf16 v[28:31], a[116:119], a[52:55], v[28:31]
  buffer_load_dwordx4 v83, s[12:15], s42 offen offset:1024 lds
  v_mfma_f32_16x16x32_bf16 v[28:31], a[120:123], a[56:59], v[28:31]
  s_add_u32 m0, s64, 12288
  v_exp_f32 v43, v19
  v_mfma_f32_16x16x32_bf16 v[28:31], a[124:127], a[60:63], v[28:31]
  ds_read_b64_tr_b16 a[142:143], v75 offset:40960
  buffer_load_dwordx4 v100, s[24:27], 0 offen offset:0 lds
  v_cvt_pk_bf16_f32 v33, v42, v43
  v_mfma_f32_16x16x32_bf16 v[48:51], v[8:11], v[36:39], v[48:51]
  s_add_u32 s42, s42, 8192
  v_exp_f32 v44, v20
  v_mfma_f32_16x16x32_bf16 v[160:163], a[160:163], v[36:39], v[160:163]
  ds_read_b64_tr_b16 a[144:145], v76 offset:32768
  buffer_load_dwordx4 v101, s[24:27], 0 offen offset:1024 lds
  v_mfma_f32_16x16x32_bf16 v[164:167], a[164:167], v[36:39], v[164:167]
  v_exp_f32 v45, v21
  v_mfma_f32_16x16x32_bf16 v[168:171], a[168:171], v[36:39], v[168:171]
  ds_read_b64_tr_b16 a[146:147], v76 offset:40960
  v_cvt_pk_bf16_f32 v34, v44, v45
  v_mfma_f32_16x16x32_bf16 v[172:175], a[172:175], v[36:39], v[172:175]
  v_exp_f32 v46, v22
  v_mfma_f32_16x16x32_bf16 v[176:179], a[176:179], v[36:39], v[176:179]
  ds_read_b64_tr_b16 a[148:149], v77 offset:32768
  buffer_load_dwordx4 v102, s[24:27], 0 offen offset:2048 lds
  v_mfma_f32_16x16x32_bf16 v[180:183], a[180:183], v[36:39], v[180:183]
  v_exp_f32 v47, v23
  v_mfma_f32_16x16x32_bf16 v[184:187], a[184:187], v[36:39], v[184:187]
  ds_read_b64_tr_b16 a[150:151], v77 offset:40960
  v_cvt_pk_bf16_f32 v35, v46, v47
  v_mfma_f32_16x16x32_bf16 v[188:191], a[188:191], v[36:39], v[188:191]
  buffer_load_dwordx4 v103, s[24:27], 0 offen offset:3072 lds
  v_mfma_f32_16x16x32_bf16 v[16:19], a[64:67], a[0:3], v[52:55]
  v_exp_f32 v40, v24
  v_mfma_f32_16x16x32_bf16 v[16:19], a[68:71], a[4:7], v[16:19]
  ds_read_b64_tr_b16 a[152:153], v78 offset:32768
  v_mfma_f32_16x16x32_bf16 v[16:19], a[72:75], a[8:11], v[16:19]
  v_exp_f32 v41, v25
  v_mfma_f32_16x16x32_bf16 v[16:19], a[76:79], a[12:15], v[16:19]
  ds_read_b64_tr_b16 a[154:155], v78 offset:40960
  v_cvt_pk_bf16_f32 v36, v40, v41
  v_mfma_f32_16x16x32_bf16 v[20:23], a[80:83], a[0:3], v[52:55]
  v_exp_f32 v42, v26
  v_mfma_f32_16x16x32_bf16 v[20:23], a[84:87], a[4:7], v[20:23]
  ds_read_b64_tr_b16 a[156:157], v79 offset:32768
  buffer_load_dwordx4 v[96:99], v15, s[32:35], s81 offen offset:0 sc1
  v_mfma_f32_16x16x32_bf16 v[20:23], a[88:91], a[8:11], v[20:23]
  v_exp_f32 v43, v27
  v_mfma_f32_16x16x32_bf16 v[20:23], a[92:95], a[12:15], v[20:23]
  ds_read_b64_tr_b16 a[158:159], v79 offset:40960
  v_cvt_pk_bf16_f32 v37, v42, v43
  v_mfma_f32_16x16x32_bf16 v[120:123], v[124:127], v[32:35], v[120:123]
  v_exp_f32 v44, v28
  v_mfma_f32_16x16x32_bf16 v[192:195], a[160:163], v[32:35], v[192:195]
  ds_read_b128 a[96:99], v68 offset:32768
  buffer_load_dwordx4 v[100:103], v15, s[32:35], s81 offen offset:1024 sc1
  v_mfma_f32_16x16x32_bf16 v[196:199], a[164:167], v[32:35], v[196:199]
  v_exp_f32 v45, v29
  v_mfma_f32_16x16x32_bf16 v[200:203], a[168:171], v[32:35], v[200:203]
  ds_read_b128 a[100:103], v69 offset:32768
  v_cvt_pk_bf16_f32 v38, v44, v45
  v_mfma_f32_16x16x32_bf16 v[204:207], a[172:175], v[32:35], v[204:207]
  v_exp_f32 v46, v30
  v_mfma_f32_16x16x32_bf16 v[208:211], a[176:179], v[32:35], v[208:211]
  ds_read_b128 a[104:107], v70 offset:32768
  v_mfma_f32_16x16x32_bf16 v[212:215], a[180:183], v[32:35], v[212:215]
  v_exp_f32 v47, v31
  v_mfma_f32_16x16x32_bf16 v[216:219], a[184:187], v[32:35], v[216:219]
  ds_read_b128 a[108:111], v71 offset:32768
  v_cvt_pk_bf16_f32 v39, v46, v47
  v_mfma_f32_16x16x32_bf16 v[220:223], a[188:191], v[32:35], v[220:223]
  buffer_load_dwordx4 v[104:107], v15, s[32:35], s82 offen offset:2048 sc1
  v_mfma_f32_16x16x32_bf16 v[24:27], a[64:67], a[16:19], v[56:59]
  v_exp_f32 v40, v16
  v_mfma_f32_16x16x32_bf16 v[24:27], a[68:71], a[20:23], v[24:27]
  ds_read_b128 a[112:115], v68 offset:40960
  v_mfma_f32_16x16x32_bf16 v[24:27], a[72:75], a[24:27], v[24:27]
  v_exp_f32 v41, v17
  v_mfma_f32_16x16x32_bf16 v[24:27], a[76:79], a[28:31], v[24:27]
  ds_read_b128 a[116:119], v69 offset:40960
  v_cvt_pk_bf16_f32 v32, v40, v41
  v_mfma_f32_16x16x32_bf16 v[28:31], a[80:83], a[16:19], v[56:59]
  v_exp_f32 v42, v18
  v_mfma_f32_16x16x32_bf16 v[28:31], a[84:87], a[20:23], v[28:31]
  ds_read_b128 a[120:123], v70 offset:40960
  v_mfma_f32_16x16x32_bf16 v[28:31], a[88:91], a[24:27], v[28:31]
  v_exp_f32 v43, v19
  v_mfma_f32_16x16x32_bf16 v[28:31], a[92:95], a[28:31], v[28:31]
  ds_read_b128 a[124:127], v71 offset:40960
  v_cvt_pk_bf16_f32 v33, v42, v43
  v_mfma_f32_16x16x32_bf16 v[120:123], v[8:11], v[36:39], v[120:123]
  v_exp_f32 v44, v20
  v_mfma_f32_16x16x32_bf16 v[224:227], a[160:163], v[36:39], v[224:227]
  v_mfma_f32_16x16x32_bf16 v[228:231], a[164:167], v[36:39], v[228:231]
  v_exp_f32 v45, v21
  v_mfma_f32_16x16x32_bf16 v[232:235], a[168:171], v[36:39], v[232:235]
  v_cvt_pk_bf16_f32 v34, v44, v45
  v_mfma_f32_16x16x32_bf16 v[236:239], a[172:175], v[36:39], v[236:239]
  v_exp_f32 v46, v22
  v_mfma_f32_16x16x32_bf16 v[240:243], a[176:179], v[36:39], v[240:243]
  v_mfma_f32_16x16x32_bf16 v[244:247], a[180:183], v[36:39], v[244:247]
  s_waitcnt vmcnt(27) lgkmcnt(0)
  v_exp_f32 v47, v23
  v_mfma_f32_16x16x32_bf16 v[248:251], a[184:187], v[36:39], v[248:251]
  v_cvt_pk_bf16_f32 v35, v46, v47
  v_mfma_f32_16x16x32_bf16 v[252:255], a[188:191], v[36:39], v[252:255]
  s_barrier
  v_mfma_f32_16x16x32_bf16 v[16:19], a[64:67], a[32:35], v[60:63]
  v_exp_f32 v40, v24
  v_mfma_f32_16x16x32_bf16 v[16:19], a[68:71], a[36:39], v[16:19]
  ds_read_b64_tr_b16 a[160:161], v72 offset:49152
  v_mfma_f32_16x16x32_bf16 v[16:19], a[72:75], a[40:43], v[16:19]
  s_add_u32 m0, s43, 32768
  v_exp_f32 v41, v25
  v_mfma_f32_16x16x32_bf16 v[16:19], a[76:79], a[44:47], v[16:19]
  ds_read_b64_tr_b16 a[162:163], v72 offset:57344
  v_cvt_pk_bf16_f32 v36, v40, v41
  v_mfma_f32_16x16x32_bf16 v[20:23], a[80:83], a[32:35], v[60:63]
  v_exp_f32 v42, v26
  v_mfma_f32_16x16x32_bf16 v[20:23], a[84:87], a[36:39], v[20:23]
  buffer_load_dwordx4 v80, s[8:11], s41 offen lds
  v_mfma_f32_16x16x32_bf16 v[20:23], a[88:91], a[40:43], v[20:23]
  v_exp_f32 v43, v27
  v_mfma_f32_16x16x32_bf16 v[20:23], a[92:95], a[44:47], v[20:23]
  ds_read_b64_tr_b16 a[164:165], v73 offset:49152
  v_cvt_pk_bf16_f32 v37, v42, v43
  v_mfma_f32_16x16x32_bf16 v[48:51], v[124:127], v[32:35], v[48:51]
  v_exp_f32 v44, v28
  v_mfma_f32_16x16x32_bf16 v[128:131], a[128:131], v[32:35], v[128:131]
  buffer_load_dwordx4 v81, s[8:11], s41 offen offset:1024 lds
  v_mfma_f32_16x16x32_bf16 v[132:135], a[132:135], v[32:35], v[132:135]
  s_add_u32 s41, s41, 8192
  v_exp_f32 v45, v29
  v_mfma_f32_16x16x32_bf16 v[136:139], a[136:139], v[32:35], v[136:139]
  ds_read_b64_tr_b16 a[166:167], v73 offset:57344
  v_cvt_pk_bf16_f32 v38, v44, v45
  v_mfma_f32_16x16x32_bf16 v[140:143], a[140:143], v[32:35], v[140:143]
  v_exp_f32 v46, v30
  v_mfma_f32_16x16x32_bf16 v[144:147], a[144:147], v[32:35], v[144:147]
  ds_read_b64_tr_b16 a[168:169], v74 offset:49152
  v_mfma_f32_16x16x32_bf16 v[148:151], a[148:151], v[32:35], v[148:151]
  v_exp_f32 v47, v31
  v_mfma_f32_16x16x32_bf16 v[152:155], a[152:155], v[32:35], v[152:155]
  ds_read_b64_tr_b16 a[170:171], v74 offset:57344
  v_cvt_pk_bf16_f32 v39, v46, v47
  v_mfma_f32_16x16x32_bf16 v[156:159], a[156:159], v[32:35], v[156:159]
  v_mfma_f32_16x16x32_bf16 v[24:27], a[64:67], a[48:51], v[64:67]
  s_add_u32 m0, s43, 34816
  v_exp_f32 v40, v16
  v_mfma_f32_16x16x32_bf16 v[24:27], a[68:71], a[52:55], v[24:27]
  buffer_load_dwordx4 v82, s[12:15], s42 offen lds
  v_mfma_f32_16x16x32_bf16 v[24:27], a[72:75], a[56:59], v[24:27]
  v_exp_f32 v41, v17
  v_mfma_f32_16x16x32_bf16 v[24:27], a[76:79], a[60:63], v[24:27]
  ds_read_b64_tr_b16 a[172:173], v75 offset:49152
  v_cvt_pk_bf16_f32 v32, v40, v41
  v_mfma_f32_16x16x32_bf16 v[28:31], a[80:83], a[48:51], v[64:67]
  v_exp_f32 v42, v18
  v_mfma_f32_16x16x32_bf16 v[28:31], a[84:87], a[52:55], v[28:31]
  buffer_load_dwordx4 v83, s[12:15], s42 offen offset:1024 lds
  v_mfma_f32_16x16x32_bf16 v[28:31], a[88:91], a[56:59], v[28:31]
  s_add_u32 s42, s42, 8192
  v_exp_f32 v43, v19
  v_mfma_f32_16x16x32_bf16 v[28:31], a[92:95], a[60:63], v[28:31]
  ds_read_b64_tr_b16 a[174:175], v75 offset:57344
  v_cvt_pk_bf16_f32 v33, v42, v43
  v_mfma_f32_16x16x32_bf16 v[48:51], v[8:11], v[36:39], v[48:51]
  v_exp_f32 v44, v20
  v_mfma_f32_16x16x32_bf16 v[160:163], a[128:131], v[36:39], v[160:163]
  ds_read_b64_tr_b16 a[176:177], v76 offset:49152
  v_mfma_f32_16x16x32_bf16 v[164:167], a[132:135], v[36:39], v[164:167]
  v_exp_f32 v45, v21
  v_mfma_f32_16x16x32_bf16 v[168:171], a[136:139], v[36:39], v[168:171]
  ds_read_b64_tr_b16 a[178:179], v76 offset:57344
  v_cvt_pk_bf16_f32 v34, v44, v45
  v_mfma_f32_16x16x32_bf16 v[172:175], a[140:143], v[36:39], v[172:175]
  v_exp_f32 v46, v22
  v_mfma_f32_16x16x32_bf16 v[176:179], a[144:147], v[36:39], v[176:179]
  ds_read_b64_tr_b16 a[180:181], v77 offset:49152
  v_mfma_f32_16x16x32_bf16 v[180:183], a[148:151], v[36:39], v[180:183]
  v_exp_f32 v47, v23
  v_mfma_f32_16x16x32_bf16 v[184:187], a[152:155], v[36:39], v[184:187]
  ds_read_b64_tr_b16 a[182:183], v77 offset:57344
  v_cvt_pk_bf16_f32 v35, v46, v47
  v_mfma_f32_16x16x32_bf16 v[188:191], a[156:159], v[36:39], v[188:191]
  v_mfma_f32_16x16x32_bf16 v[16:19], a[96:99], a[0:3], v[52:55]
  v_exp_f32 v40, v24
  v_mfma_f32_16x16x32_bf16 v[16:19], a[100:103], a[4:7], v[16:19]
  ds_read_b64_tr_b16 a[184:185], v78 offset:49152
  v_mfma_f32_16x16x32_bf16 v[16:19], a[104:107], a[8:11], v[16:19]
  v_exp_f32 v41, v25
  v_mfma_f32_16x16x32_bf16 v[16:19], a[108:111], a[12:15], v[16:19]
  ds_read_b64_tr_b16 a[186:187], v78 offset:57344
  v_cvt_pk_bf16_f32 v36, v40, v41
  v_mfma_f32_16x16x32_bf16 v[20:23], a[112:115], a[0:3], v[52:55]
  v_exp_f32 v42, v26
  v_mfma_f32_16x16x32_bf16 v[20:23], a[116:119], a[4:7], v[20:23]
  ds_read_b64_tr_b16 a[188:189], v79 offset:49152
  v_mfma_f32_16x16x32_bf16 v[20:23], a[120:123], a[8:11], v[20:23]
  v_exp_f32 v43, v27
  v_mfma_f32_16x16x32_bf16 v[20:23], a[124:127], a[12:15], v[20:23]
  ds_read_b64_tr_b16 a[190:191], v79 offset:57344
  v_cvt_pk_bf16_f32 v37, v42, v43
  v_mfma_f32_16x16x32_bf16 v[120:123], v[124:127], v[32:35], v[120:123]
  v_exp_f32 v44, v28
  v_mfma_f32_16x16x32_bf16 v[192:195], a[128:131], v[32:35], v[192:195]
  ds_read_b128 a[64:67], v68 offset:49152
  v_mfma_f32_16x16x32_bf16 v[196:199], a[132:135], v[32:35], v[196:199]
  v_exp_f32 v45, v29
  v_mfma_f32_16x16x32_bf16 v[200:203], a[136:139], v[32:35], v[200:203]
  ds_read_b128 a[68:71], v69 offset:49152
  v_cvt_pk_bf16_f32 v38, v44, v45
  v_mfma_f32_16x16x32_bf16 v[204:207], a[140:143], v[32:35], v[204:207]
  v_exp_f32 v46, v30
  v_mfma_f32_16x16x32_bf16 v[208:211], a[144:147], v[32:35], v[208:211]
  ds_read_b128 a[72:75], v70 offset:49152
  v_mfma_f32_16x16x32_bf16 v[212:215], a[148:151], v[32:35], v[212:215]
  v_exp_f32 v47, v31
  v_mfma_f32_16x16x32_bf16 v[216:219], a[152:155], v[32:35], v[216:219]
  ds_read_b128 a[76:79], v71 offset:49152
  v_cvt_pk_bf16_f32 v39, v46, v47
  v_mfma_f32_16x16x32_bf16 v[220:223], a[156:159], v[32:35], v[220:223]
  v_mfma_f32_16x16x32_bf16 v[24:27], a[96:99], a[16:19], v[56:59]
  v_exp_f32 v40, v16
  v_mfma_f32_16x16x32_bf16 v[24:27], a[100:103], a[20:23], v[24:27]
  ds_read_b128 a[80:83], v68 offset:57344
  v_mfma_f32_16x16x32_bf16 v[24:27], a[104:107], a[24:27], v[24:27]
  v_exp_f32 v41, v17
  v_mfma_f32_16x16x32_bf16 v[24:27], a[108:111], a[28:31], v[24:27]
  ds_read_b128 a[84:87], v69 offset:57344
  v_cvt_pk_bf16_f32 v32, v40, v41
  v_mfma_f32_16x16x32_bf16 v[28:31], a[112:115], a[16:19], v[56:59]
  v_exp_f32 v42, v18
  v_mfma_f32_16x16x32_bf16 v[28:31], a[116:119], a[20:23], v[28:31]
  ds_read_b128 a[88:91], v70 offset:57344
  v_mfma_f32_16x16x32_bf16 v[28:31], a[120:123], a[24:27], v[28:31]
  v_exp_f32 v43, v19
  v_mfma_f32_16x16x32_bf16 v[28:31], a[124:127], a[28:31], v[28:31]
  ds_read_b128 a[92:95], v71 offset:57344
  v_cvt_pk_bf16_f32 v33, v42, v43
  v_mfma_f32_16x16x32_bf16 v[120:123], v[8:11], v[36:39], v[120:123]
  v_exp_f32 v44, v20
  v_mfma_f32_16x16x32_bf16 v[224:227], a[128:131], v[36:39], v[224:227]
  v_mfma_f32_16x16x32_bf16 v[228:231], a[132:135], v[36:39], v[228:231]
  v_exp_f32 v45, v21
  v_mfma_f32_16x16x32_bf16 v[232:235], a[136:139], v[36:39], v[232:235]
  v_cvt_pk_bf16_f32 v34, v44, v45
  v_mfma_f32_16x16x32_bf16 v[236:239], a[140:143], v[36:39], v[236:239]
  v_exp_f32 v46, v22
  v_mfma_f32_16x16x32_bf16 v[240:243], a[144:147], v[36:39], v[240:243]
  v_mfma_f32_16x16x32_bf16 v[244:247], a[148:151], v[36:39], v[244:247]
  s_waitcnt vmcnt(23) lgkmcnt(0)
  v_exp_f32 v47, v23
  v_mfma_f32_16x16x32_bf16 v[248:251], a[152:155], v[36:39], v[248:251]
  v_cvt_pk_bf16_f32 v35, v46, v47
  v_mfma_f32_16x16x32_bf16 v[252:255], a[156:159], v[36:39], v[252:255]
  s_barrier
  v_mfma_f32_16x16x32_bf16 v[16:19], a[96:99], a[32:35], v[60:63]
  v_exp_f32 v40, v24
  v_mfma_f32_16x16x32_bf16 v[16:19], a[100:103], a[36:39], v[16:19]
  ds_read_b64_tr_b16 a[128:129], v72 offset:0
  v_mfma_f32_16x16x32_bf16 v[16:19], a[104:107], a[40:43], v[16:19]
  s_add_u32 m0, s43, 49152
  v_exp_f32 v41, v25
  v_mfma_f32_16x16x32_bf16 v[16:19], a[108:111], a[44:47], v[16:19]
  ds_read_b64_tr_b16 a[130:131], v72 offset:8192
  v_cvt_pk_bf16_f32 v36, v40, v41
  v_mfma_f32_16x16x32_bf16 v[20:23], a[112:115], a[32:35], v[60:63]
  v_exp_f32 v42, v26
  v_mfma_f32_16x16x32_bf16 v[20:23], a[116:119], a[36:39], v[20:23]
  buffer_load_dwordx4 v80, s[8:11], s41 offen lds
  v_mfma_f32_16x16x32_bf16 v[20:23], a[120:123], a[40:43], v[20:23]
  v_exp_f32 v43, v27
  v_mfma_f32_16x16x32_bf16 v[20:23], a[124:127], a[44:47], v[20:23]
  ds_read_b64_tr_b16 a[132:133], v73 offset:0
  v_cvt_pk_bf16_f32 v37, v42, v43
  v_mfma_f32_16x16x32_bf16 v[48:51], v[124:127], v[32:35], v[48:51]
  v_exp_f32 v44, v28
  v_mfma_f32_16x16x32_bf16 v[128:131], a[160:163], v[32:35], v[128:131]
  buffer_load_dwordx4 v81, s[8:11], s41 offen offset:1024 lds
  v_mfma_f32_16x16x32_bf16 v[132:135], a[164:167], v[32:35], v[132:135]
  s_add_u32 s41, s41, 8192
  v_exp_f32 v45, v29
  v_mfma_f32_16x16x32_bf16 v[136:139], a[168:171], v[32:35], v[136:139]
  ds_read_b64_tr_b16 a[134:135], v73 offset:8192
  v_cvt_pk_bf16_f32 v38, v44, v45
  v_mfma_f32_16x16x32_bf16 v[140:143], a[172:175], v[32:35], v[140:143]
  v_exp_f32 v46, v30
  v_mfma_f32_16x16x32_bf16 v[144:147], a[176:179], v[32:35], v[144:147]
  ds_read_b64_tr_b16 a[136:137], v74 offset:0
  v_mfma_f32_16x16x32_bf16 v[148:151], a[180:183], v[32:35], v[148:151]
  v_exp_f32 v47, v31
  v_mfma_f32_16x16x32_bf16 v[152:155], a[184:187], v[32:35], v[152:155]
  ds_read_b64_tr_b16 a[138:139], v74 offset:8192
  v_cvt_pk_bf16_f32 v39, v46, v47
  v_mfma_f32_16x16x32_bf16 v[156:159], a[188:191], v[32:35], v[156:159]
  v_mfma_f32_16x16x32_bf16 v[24:27], a[96:99], a[48:51], v[64:67]
  s_add_u32 m0, s43, 51200
  v_exp_f32 v40, v16
  v_mfma_f32_16x16x32_bf16 v[24:27], a[100:103], a[52:55], v[24:27]
  buffer_load_dwordx4 v82, s[12:15], s42 offen lds
  v_mfma_f32_16x16x32_bf16 v[24:27], a[104:107], a[56:59], v[24:27]
  v_exp_f32 v41, v17
  v_mfma_f32_16x16x32_bf16 v[24:27], a[108:111], a[60:63], v[24:27]
  ds_read_b64_tr_b16 a[140:141], v75 offset:0
  v_cvt_pk_bf16_f32 v32, v40, v41
  v_mfma_f32_16x16x32_bf16 v[28:31], a[112:115], a[48:51], v[64:67]
  v_exp_f32 v42, v18
  v_mfma_f32_16x16x32_bf16 v[28:31], a[116:119], a[52:55], v[28:31]
  buffer_load_dwordx4 v83, s[12:15], s42 offen offset:1024 lds
  v_mfma_f32_16x16x32_bf16 v[28:31], a[120:123], a[56:59], v[28:31]
  s_add_u32 s42, s42, 8192
  v_exp_f32 v43, v19
  v_mfma_f32_16x16x32_bf16 v[28:31], a[124:127], a[60:63], v[28:31]
  ds_read_b64_tr_b16 a[142:143], v75 offset:8192
  v_cvt_pk_bf16_f32 v33, v42, v43
  v_mfma_f32_16x16x32_bf16 v[48:51], v[8:11], v[36:39], v[48:51]
  v_exp_f32 v44, v20
  v_mfma_f32_16x16x32_bf16 v[160:163], a[160:163], v[36:39], v[160:163]
  ds_read_b64_tr_b16 a[144:145], v76 offset:0
  v_mfma_f32_16x16x32_bf16 v[164:167], a[164:167], v[36:39], v[164:167]
  v_exp_f32 v45, v21
  v_mfma_f32_16x16x32_bf16 v[168:171], a[168:171], v[36:39], v[168:171]
  ds_read_b64_tr_b16 a[146:147], v76 offset:8192
  v_cvt_pk_bf16_f32 v34, v44, v45
  v_mfma_f32_16x16x32_bf16 v[172:175], a[172:175], v[36:39], v[172:175]
  v_exp_f32 v46, v22
  v_mfma_f32_16x16x32_bf16 v[176:179], a[176:179], v[36:39], v[176:179]
  ds_read_b64_tr_b16 a[148:149], v77 offset:0
  v_mfma_f32_16x16x32_bf16 v[180:183], a[180:183], v[36:39], v[180:183]
  v_exp_f32 v47, v23
  v_mfma_f32_16x16x32_bf16 v[184:187], a[184:187], v[36:39], v[184:187]
  ds_read_b64_tr_b16 a[150:151], v77 offset:8192
  v_cvt_pk_bf16_f32 v35, v46, v47
  v_mfma_f32_16x16x32_bf16 v[188:191], a[188:191], v[36:39], v[188:191]
  v_mfma_f32_16x16x32_bf16 v[16:19], a[64:67], a[0:3], v[52:55]
  v_exp_f32 v40, v24
  v_mfma_f32_16x16x32_bf16 v[16:19], a[68:71], a[4:7], v[16:19]
  ds_read_b64_tr_b16 a[152:153], v78 offset:0
  v_mfma_f32_16x16x32_bf16 v[16:19], a[72:75], a[8:11], v[16:19]
  s_and_b32 s86, s80, 2
  v_exp_f32 v41, v25
  v_mfma_f32_16x16x32_bf16 v[16:19], a[76:79], a[12:15], v[16:19]
  ds_read_b64_tr_b16 a[154:155], v78 offset:8192
  v_cvt_pk_bf16_f32 v36, v40, v41
  v_mfma_f32_16x16x32_bf16 v[20:23], a[80:83], a[0:3], v[52:55]
  s_cmp_lg_u32 s86, 0
  s_cselect_b64 vcc, -1, 0
  v_exp_f32 v42, v26
  v_mfma_f32_16x16x32_bf16 v[20:23], a[84:87], a[4:7], v[20:23]
  ds_read_b64_tr_b16 a[156:157], v79 offset:0
  v_mfma_f32_16x16x32_bf16 v[20:23], a[88:91], a[8:11], v[20:23]
  s_sub_u32 s85, s85, 1
  v_exp_f32 v43, v27
  v_mfma_f32_16x16x32_bf16 v[20:23], a[92:95], a[12:15], v[20:23]
  ds_read_b64_tr_b16 a[158:159], v79 offset:8192
  v_cvt_pk_bf16_f32 v37, v42, v43
  v_mfma_f32_16x16x32_bf16 v[120:123], v[124:127], v[32:35], v[120:123]
  v_exp_f32 v44, v28
  v_mfma_f32_16x16x32_bf16 v[192:195], a[160:163], v[32:35], v[192:195]
  ds_read_b128 a[96:99], v68 offset:0
  v_mfma_f32_16x16x32_bf16 v[196:199], a[164:167], v[32:35], v[196:199]
  v_exp_f32 v45, v29
  v_mfma_f32_16x16x32_bf16 v[200:203], a[168:171], v[32:35], v[200:203]
  ds_read_b128 a[100:103], v69 offset:0
  v_cvt_pk_bf16_f32 v38, v44, v45
  v_mfma_f32_16x16x32_bf16 v[204:207], a[172:175], v[32:35], v[204:207]
  v_exp_f32 v46, v30
  v_mfma_f32_16x16x32_bf16 v[208:211], a[176:179], v[32:35], v[208:211]
  ds_read_b128 a[104:107], v70 offset:0
  v_mfma_f32_16x16x32_bf16 v[212:215], a[180:183], v[32:35], v[212:215]
  s_cmp_eq_u32 s85, 0
  v_exp_f32 v47, v31
  v_mfma_f32_16x16x32_bf16 v[216:219], a[184:187], v[32:35], v[216:219]
  ds_read_b128 a[108:111], v71 offset:0
  v_cvt_pk_bf16_f32 v39, v46, v47
  v_mfma_f32_16x16x32_bf16 v[220:223], a[188:191], v[32:35], v[220:223]
  s_cbranch_scc1 L_B_entry
  s_bitcmp1_b32 s80, 0
  s_cbranch_vccnz L_T0_hi
  s_cbranch_scc1 L_T0_1
L_T0_0:
  v_mfma_f32_16x16x32_bf16 v[24:27], a[64:67], a[16:19], v[56:59]
  s_waitcnt vmcnt(23)
  v_exp_f32 v40, v16
  v_mfma_f32_16x16x32_bf16 v[24:27], a[68:71], a[20:23], v[24:27]
  ds_read_b128 a[112:115], v68 offset:8192
  ds_read_b128 a[192:195], v84 offset:0
  v_mfma_f32_16x16x32_bf16 v[24:27], a[72:75], a[24:27], v[24:27]
  v_exp_f32 v41, v17
  v_mfma_f32_16x16x32_bf16 v[24:27], a[76:79], a[28:31], v[24:27]
  ds_read_b128 a[116:119], v69 offset:8192
  v_cvt_pk_bf16_f32 v32, v40, v41
  v_mfma_f32_16x16x32_bf16 v[28:31], a[80:83], a[16:19], v[56:59]
  v_exp_f32 v42, v18
  v_mfma_f32_16x16x32_bf16 v[28:31], a[84:87], a[20:23], v[28:31]
  ds_read_b128 a[120:123], v70 offset:8192
  ds_read_b128 a[196:199], v85 offset:0
  v_mfma_f32_16x16x32_bf16 v[28:31], a[88:91], a[24:27], v[28:31]
  v_exp_f32 v43, v19
  v_mfma_f32_16x16x32_bf16 v[28:31], a[92:95], a[28:31], v[28:31]
  ds_read_b128 a[124:127], v71 offset:8192
  v_cvt_pk_bf16_f32 v33, v42, v43
  v_mfma_f32_16x16x32_bf16 v[120:123], v[8:11], v[36:39], v[120:123]
  v_exp_f32 v44, v20
  v_mfma_f32_16x16x32_bf16 v[224:227], a[160:163], v[36:39], v[224:227]
  ds_read_b128 a[200:203], v86 offset:0
  ds_read_b128 a[204:207], v87 offset:0
  v_mfma_f32_16x16x32_bf16 v[228:231], a[164:167], v[36:39], v[228:231]
  v_exp_f32 v45, v21
  v_mfma_f32_16x16x32_bf16 v[232:235], a[168:171], v[36:39], v[232:235]
  ds_read_b128 a[208:211], v84 offset:4096
  v_cvt_pk_bf16_f32 v34, v44, v45
  v_mfma_f32_16x16x32_bf16 v[236:239], a[172:175], v[36:39], v[236:239]
  v_exp_f32 v46, v22
  v_mfma_f32_16x16x32_bf16 v[240:243], a[176:179], v[36:39], v[240:243]
  ds_read_b128 a[212:215], v85 offset:4096
  ds_read_b128 a[216:219], v86 offset:4096
  v_mfma_f32_16x16x32_bf16 v[244:247], a[180:183], v[36:39], v[244:247]
  s_waitcnt vmcnt(15) lgkmcnt(5)
  v_exp_f32 v47, v23
  v_mfma_f32_16x16x32_bf16 v[248:251], a[184:187], v[36:39], v[248:251]
  ds_read_b128 a[220:223], v87 offset:4096
  v_cvt_pk_bf16_f32 v35, v46, v47
  v_mfma_f32_16x16x32_bf16 v[252:255], a[188:191], v[36:39], v[252:255]
  s_barrier
  v_mfma_f32_16x16x32_bf16 v[16:19], a[64:67], a[32:35], v[60:63]
  v_exp_f32 v40, v24
  v_mfma_f32_16x16x32_bf16 v[16:19], a[68:71], a[36:39], v[16:19]
  ds_read_b64_tr_b16 a[160:161], v72 offset:16384
  v_mfma_f32_16x16x32_bf16 v[16:19], a[72:75], a[40:43], v[16:19]
  s_add_u32 m0, s43, 0
  v_exp_f32 v41, v25
  v_mfma_f32_16x16x32_bf16 v[16:19], a[76:79], a[44:47], v[16:19]
  ds_read_b64_tr_b16 a[162:163], v72 offset:24576
  v_cvt_pk_bf16_f32 v36, v40, v41
  v_mfma_f32_16x16x32_bf16 v[20:23], a[80:83], a[32:35], v[60:63]
  v_exp_f32 v42, v26
  v_mfma_f32_16x16x32_bf16 v[20:23], a[84:87], a[36:39], v[20:23]
  buffer_load_dwordx4 v80, s[8:11], s41 offen lds
  v_mfma_f32_16x16x32_bf16 v[20:23], a[88:91], a[40:43], v[20:23]
  v_exp_f32 v43, v27
  v_mfma_f32_16x16x32_bf16 v[20:23], a[92:95], a[44:47], v[20:23]
  ds_read_b64_tr_b16 a[164:165], v73 offset:16384
  v_cvt_pk_bf16_f32 v37, v42, v43
  v_mfma_f32_16x16x32_bf16 v[48:51], v[124:127], v[32:35], v[48:51]
  v_exp_f32 v44, v28
  v_mfma_f32_16x16x32_bf16 v[128:131], a[128:131], v[32:35], v[128:131]
  buffer_load_dwordx4 v81, s[8:11], s41 offen offset:1024 lds
  v_mfma_f32_16x16x32_bf16 v[132:135], a[132:135], v[32:35], v[132:135]
  s_add_u32 s41, s41, 8192
  v_exp_f32 v45, v29
  v_mfma_f32_16x16x32_bf16 v[136:139], a[136:139], v[32:35], v[136:139]
  ds_read_b64_tr_b16 a[166:167], v73 offset:24576
  v_cvt_pk_bf16_f32 v38, v44, v45
  v_mfma_f32_16x16x32_bf16 v[140:143], a[140:143], v[32:35], v[140:143]
  s_waitcnt vmcnt(13)
  v_exp_f32 v46, v30
  v_mfma_f32_16x16x32_bf16 v[144:147], a[144:147], v[32:35], v[144:147]
  ds_read_b64_tr_b16 a[168:169], v74 offset:16384
  ds_read_b64_tr_b16 a[224:225], v88 offset:0
  v_mfma_f32_16x16x32_bf16 v[148:151], a[148:151], v[32:35], v[148:151]
  s_waitcnt lgkmcnt(6)
  v_exp_f32 v47, v31
  v_mfma_f32_16x16x32_bf16 v[152:155], a[152:155], v[32:35], v[152:155]
  ds_read_b64_tr_b16 a[170:171], v74 offset:24576
  v_cvt_pk_bf16_f32 v39, v46, v47
  v_mfma_f32_16x16x32_bf16 v[156:159], a[156:159], v[32:35], v[156:159]
  ds_read_b64_tr_b16 a[226:227], v88 offset:4096
  ds_read_b64_tr_b16 a[228:229], v89 offset:0
  v_mfma_f32_16x16x32_bf16 v[108:111], a[192:195], a[0:3], v[52:55]
  s_add_u32 m0, s43, 2048
  v_exp_f32 v40, v16
  v_mfma_f32_16x16x32_bf16 v[108:111], a[196:199], a[4:7], v[108:111]
  buffer_load_dwordx4 v82, s[12:15], s42 offen lds
  v_mfma_f32_16x16x32_bf16 v[108:111], a[200:203], a[8:11], v[108:111]
  v_exp_f32 v41, v17
  v_mfma_f32_16x16x32_bf16 v[108:111], a[204:207], a[12:15], v[108:111]
  ds_read_b64_tr_b16 a[172:173], v75 offset:16384
  v_cvt_pk_bf16_f32 v32, v40, v41
  v_mfma_f32_16x16x32_bf16 v[112:115], a[208:211], a[0:3], v[52:55]
  v_exp_f32 v42, v18
  v_mfma_f32_16x16x32_bf16 v[112:115], a[212:215], a[4:7], v[112:115]
  buffer_load_dwordx4 v83, s[12:15], s42 offen offset:1024 lds
  v_mfma_f32_16x16x32_bf16 v[112:115], a[216:219], a[8:11], v[112:115]
  s_add_u32 s42, s42, 8192
  v_exp_f32 v43, v19
  v_mfma_f32_16x16x32_bf16 v[112:115], a[220:223], a[12:15], v[112:115]
  ds_read_b64_tr_b16 a[174:175], v75 offset:24576
  v_cvt_pk_bf16_f32 v33, v42, v43
  v_mfma_f32_16x16x32_bf16 v[48:51], v[8:11], v[36:39], v[48:51]
  v_exp_f32 v44, v20
  v_mfma_f32_16x16x32_bf16 v[160:163], a[128:131], v[36:39], v[160:163]
  ds_read_b64_tr_b16 a[176:177], v76 offset:16384
  ds_read_b64_tr_b16 a[230:231], v89 offset:4096
  v_mfma_f32_16x16x32_bf16 v[164:167], a[132:135], v[36:39], v[164:167]
  s_waitcnt vmcnt(12)
  v_exp_f32 v45, v21
  v_mfma_f32_16x16x32_bf16 v[168:171], a[136:139], v[36:39], v[168:171]
  ds_read_b64_tr_b16 a[178:179], v76 offset:24576
  v_cvt_pk_bf16_f32 v34, v44, v45
  v_mfma_f32_16x16x32_bf16 v[172:175], a[140:143], v[36:39], v[172:175]
  s_mov_b32 m0, s64
  v_exp_f32 v46, v22
  v_mfma_f32_16x16x32_bf16 v[176:179], a[144:147], v[36:39], v[176:179]
  ds_read_b64_tr_b16 a[180:181], v77 offset:16384
  ds_read_b64_tr_b16 a[232:233], v90 offset:0
  v_mfma_f32_16x16x32_bf16 v[180:183], a[148:151], v[36:39], v[180:183]
  v_exp_f32 v47, v23
  v_mfma_f32_16x16x32_bf16 v[184:187], a[152:155], v[36:39], v[184:187]
  ds_read_b64_tr_b16 a[182:183], v77 offset:24576
  v_cvt_pk_bf16_f32 v35, v46, v47
  v_mfma_f32_16x16x32_bf16 v[188:191], a[156:159], v[36:39], v[188:191]
  buffer_load_dwordx4 v96, s[20:23], 0 offen offset:0 lds
  v_mfma_f32_16x16x32_bf16 v[24:27], a[64:67], a[48:51], v[64:67]
  v_exp_f32 v40, v108
  v_mfma_f32_16x16x32_bf16 v[24:27], a[68:71], a[52:55], v[24:27]
  ds_read_b64_tr_b16 a[234:235], v90 offset:4096
  ds_read_b64_tr_b16 a[236:237], v91 offset:0
  v_mfma_f32_16x16x32_bf16 v[24:27], a[72:75], a[56:59], v[24:27]
  v_exp_f32 v41, v109
  v_mfma_f32_16x16x32_bf16 v[24:27], a[76:79], a[60:63], v[24:27]
  ds_read_b64_tr_b16 a[238:239], v91 offset:4096
  v_cvt_pk_bf16_f32 v116, v40, v41
  v_mfma_f32_16x16x32_bf16 v[28:31], a[80:83], a[48:51], v[64:67]
  v_exp_f32 v42, v110
  v_mfma_f32_16x16x32_bf16 v[28:31], a[84:87], a[52:55], v[28:31]
  ds_read_b64_tr_b16 a[240:241], v92 offset:0
  v_and_b32 v116, v116, v104
  v_mfma_f32_16x16x32_bf16 v[28:31], a[88:91], a[56:59], v[28:31]
  v_exp_f32 v43, v111
  v_mfma_f32_16x16x32_bf16 v[28:31], a[92:95], a[60:63], v[28:31]
  ds_read_b64_tr_b16 a[242:243], v92 offset:4096
  v_cvt_pk_bf16_f32 v117, v42, v43
  v_mfma_f32_16x16x32_bf16 v[120:123], v[124:127], v[32:35], v[120:123]
  v_exp_f32 v44, v112
  v_mfma_f32_16x16x32_bf16 v[192:195], a[128:131], v[32:35], v[192:195]
  ds_read_b64_tr_b16 a[244:245], v93 offset:0
  v_and_b32 v117, v117, v105
  v_mfma_f32_16x16x32_bf16 v[196:199], a[132:135], v[32:35], v[196:199]
  v_exp_f32 v45, v113
  v_mfma_f32_16x16x32_bf16 v[200:203], a[136:139], v[32:35], v[200:203]
  ds_read_b64_tr_b16 a[246:247], v93 offset:4096
  v_cvt_pk_bf16_f32 v118, v44, v45
  v_mfma_f32_16x16x32_bf16 v[204:207], a[140:143], v[32:35], v[204:207]
  v_exp_f32 v46, v114
  v_mfma_f32_16x16x32_bf16 v[208:211], a[144:147], v[32:35], v[208:211]
  ds_read_b64_tr_b16 a[248:249], v94 offset:0
  v_and_b32 v118, v118, v106
  v_mfma_f32_16x16x32_bf16 v[212:215], a[148:151], v[32:35], v[212:215]
  v_exp_f32 v47, v115
  v_mfma_f32_16x16x32_bf16 v[216:219], a[152:155], v[32:35], v[216:219]
  ds_read_b64_tr_b16 a[250:251], v94 offset:4096
  v_cvt_pk_bf16_f32 v119, v46, v47
  v_mfma_f32_16x16x32_bf16 v[220:223], a[156:159], v[32:35], v[220:223]
  ds_read_b64_tr_b16 a[252:253], v95 offset:0
  ds_read_b64_tr_b16 a[254:255], v95 offset:4096
  v_mfma_f32_16x16x32_bf16 v[16:19], a[96:99], a[0:3], v[52:55]
  v_exp_f32 v40, v24
  v_mfma_f32_16x16x32_bf16 v[16:19], a[100:103], a[4:7], v[16:19]
  ds_read_b64_tr_b16 a[184:185], v78 offset:16384
  v_and_b32 v119, v119, v107
  v_mfma_f32_16x16x32_bf16 v[16:19], a[104:107], a[8:11], v[16:19]
  v_exp_f32 v41, v25
  v_mfma_f32_16x16x32_bf16 v[16:19], a[108:111], a[12:15], v[16:19]
  ds_read_b64_tr_b16 a[186:187], v78 offset:24576
  v_cvt_pk_bf16_f32 v36, v40, v41
  v_mfma_f32_16x16x32_bf16 v[20:23], a[112:115], a[0:3], v[52:55]
  v_exp_f32 v42, v26
  v_mfma_f32_16x16x32_bf16 v[20:23], a[116:119], a[4:7], v[20:23]
  ds_read_b64_tr_b16 a[188:189], v79 offset:16384
  buffer_load_dwordx4 v97, s[20:23], 0 offen offset:1024 lds
  v_mfma_f32_16x16x32_bf16 v[20:23], a[120:123], a[8:11], v[20:23]
  s_waitcnt lgkmcnt(3)
  v_exp_f32 v43, v27
  v_mfma_f32_16x16x32_bf16 v[20:23], a[124:127], a[12:15], v[20:23]
  ds_read_b64_tr_b16 a[190:191], v79 offset:24576
  v_cvt_pk_bf16_f32 v37, v42, v43
  v_mfma_f32_16x16x32_bf16 v[48:51], v[124:127], v[116:119], v[48:51]
  v_exp_f32 v44, v28
  v_mfma_f32_16x16x32_bf16 v[128:131], a[224:227], v[116:119], v[128:131]
  ds_read_b128 a[64:67], v68 offset:16384
  buffer_load_dwordx4 v98, s[20:23], 0 offen offset:2048 lds
  v_mfma_f32_16x16x32_bf16 v[132:135], a[228:231], v[116:119], v[132:135]
  v_exp_f32 v45, v29
  v_mfma_f32_16x16x32_bf16 v[136:139], a[232:235], v[116:119], v[136:139]
  ds_read_b128 a[68:71], v69 offset:16384
  v_cvt_pk_bf16_f32 v38, v44, v45
  v_mfma_f32_16x16x32_bf16 v[140:143], a[236:239], v[116:119], v[140:143]
  v_exp_f32 v46, v30
  v_mfma_f32_16x16x32_bf16 v[144:147], a[240:243], v[116:119], v[144:147]
  ds_read_b128 a[72:75], v70 offset:16384
  buffer_load_dwordx4 v99, s[20:23], 0 offen offset:3072 lds
  v_mfma_f32_16x16x32_bf16 v[148:151], a[244:247], v[116:119], v[148:151]
  s_add_u32 m0, s64, 4096
  v_exp_f32 v47, v31
  v_mfma_f32_16x16x32_bf16 v[152:155], a[248:251], v[116:119], v[152:155]
  ds_read_b128 a[76:79], v71 offset:16384
  v_cvt_pk_bf16_f32 v39, v46, v47
  v_mfma_f32_16x16x32_bf16 v[156:159], a[252:255], v[116:119], v[156:159]
  buffer_load_dwordx4 v100, s[20:23], 0 offen offset:0 lds
  s_branch L_A1
.p2align 3
L_T0_1:
  v_mfma_f32_16x16x32_bf16 v[24:27], a[64:67], a[16:19], v[56:59]
  s_waitcnt vmcnt(23)
  v_exp_f32 v40, v16
  v_mfma_f32_16x16x32_bf16 v[24:27], a[68:71], a[20:23], v[24:27]
  ds_read_b128 a[112:115], v68 offset:8192
  ds_read_b128 a[192:195], v84 offset:0
  v_mfma_f32_16x16x32_bf16 v[24:27], a[72:75], a[24:27], v[24:27]
  v_exp_f32 v41, v17
  v_mfma_f32_16x16x32_bf16 v[24:27], a[76:79], a[28:31], v[24:27]
  ds_read_b128 a[116:119], v69 offset:8192
  v_cvt_pk_bf16_f32 v32, v40, v41
  v_mfma_f32_16x16x32_bf16 v[28:31], a[80:83], a[16:19], v[56:59]
  v_exp_f32 v42, v18
  v_mfma_f32_16x16x32_bf16 v[28:31], a[84:87], a[20:23], v[28:31]
  ds_read_b128 a[120:123], v70 offset:8192
  ds_read_b128 a[196:199], v85 offset:0
  v_mfma_f32_16x16x32_bf16 v[28:31], a[88:91], a[24:27], v[28:31]
  v_exp_f32 v43, v19
  v_mfma_f32_16x16x32_bf16 v[28:31], a[92:95], a[28:31], v[28:31]
  ds_read_b128 a[124:127], v71 offset:8192
  v_cvt_pk_bf16_f32 v33, v42, v43
  v_mfma_f32_16x16x32_bf16 v[120:123], v[8:11], v[36:39], v[120:123]
  v_exp_f32 v44, v20
  v_mfma_f32_16x16x32_bf16 v[224:227], a[160:163], v[36:39], v[224:227]
  ds_read_b128 a[200:203], v86 offset:0
  ds_read_b128 a[204:207], v87 offset:0
  v_mfma_f32_16x16x32_bf16 v[228:231], a[164:167], v[36:39], v[228:231]
  v_exp_f32 v45, v21
  v_mfma_f32_16x16x32_bf16 v[232:235], a[168:171], v[36:39], v[232:235]
  ds_read_b128 a[208:211], v84 offset:4096
  v_cvt_pk_bf16_f32 v34, v44, v45
  v_mfma_f32_16x16x32_bf16 v[236:239], a[172:175], v[36:39], v[236:239]
  v_exp_f32 v46, v22
  v_mfma_f32_16x16x32_bf16 v[240:243], a[176:179], v[36:39], v[240:243]
  ds_read_b128 a[212:215], v85 offset:4096
  ds_read_b128 a[216:219], v86 offset:4096
  v_mfma_f32_16x16x32_bf16 v[244:247], a[180:183], v[36:39], v[244:247]
  s_waitcnt vmcnt(15) lgkmcnt(5)
  v_exp_f32 v47, v23
  v_mfma_f32_16x16x32_bf16 v[248:251], a[184:187], v[36:39], v[248:251]
  ds_read_b128 a[220:223], v87 offset:4096
  v_cvt_pk_bf16_f32 v35, v46, v47
  v_mfma_f32_16x16x32_bf16 v[252:255], a[188:191], v[36:39], v[252:255]
  s_barrier
  v_mfma_f32_16x16x32_bf16 v[16:19], a[64:67], a[32:35], v[60:63]
  v_exp_f32 v40, v24
  v_mfma_f32_16x16x32_bf16 v[16:19], a[68:71], a[36:39], v[16:19]
  ds_read_b64_tr_b16 a[160:161], v72 offset:16384
  v_mfma_f32_16x16x32_bf16 v[16:19], a[72:75], a[40:43], v[16:19]
  s_add_u32 m0, s43, 0
  v_exp_f32 v41, v25
  v_mfma_f32_16x16x32_bf16 v[16:19], a[76:79], a[44:47], v[16:19]
  ds_read_b64_tr_b16 a[162:163], v72 offset:24576
  v_cvt_pk_bf16_f32 v36, v40, v41
  v_mfma_f32_16x16x32_bf16 v[20:23], a[80:83], a[32:35], v[60:63]
  v_exp_f32 v42, v26
  v_mfma_f32_16x16x32_bf16 v[20:23], a[84:87], a[36:39], v[20:23]
  buffer_load_dwordx4 v80, s[8:11], s41 offen lds
  v_mfma_f32_16x16x32_bf16 v[20:23], a[88:91], a[40:43], v[20:23]
  v_exp_f32 v43, v27
  v_mfma_f32_16x16x32_bf16 v[20:23], a[92:95], a[44:47], v[20:23]
  ds_read_b64_tr_b16 a[164:165], v73 offset:16384
  v_cvt_pk_bf16_f32 v37, v42, v43
  v_mfma_f32_16x16x32_bf16 v[48:51], v[124:127], v[32:35], v[48:51]
  v_exp_f32 v44, v28
  v_mfma_f32_16x16x32_bf16 v[128:131], a[128:131], v[32:35], v[128:131]
  buffer_load_dwordx4 v81, s[8:11], s41 offen offset:1024 lds
  v_mfma_f32_16x16x32_bf16 v[132:135], a[132:135], v[32:35], v[132:135]
  s_add_u32 s41, s41, 8192
  v_exp_f32 v45, v29
  v_mfma_f32_16x16x32_bf16 v[136:139], a[136:139], v[32:35], v[136:139]
  ds_read_b64_tr_b16 a[166:167], v73 offset:24576
  v_cvt_pk_bf16_f32 v38, v44, v45
  v_mfma_f32_16x16x32_bf16 v[140:143], a[140:143], v[32:35], v[140:143]
  s_waitcnt vmcnt(13)
  v_exp_f32 v46, v30
  v_mfma_f32_16x16x32_bf16 v[144:147], a[144:147], v[32:35], v[144:147]
  ds_read_b64_tr_b16 a[168:169], v74 offset:16384
  ds_read_b64_tr_b16 a[224:225], v88 offset:0
  v_mfma_f32_16x16x32_bf16 v[148:151], a[148:151], v[32:35], v[148:151]
  s_waitcnt lgkmcnt(6)
  v_exp_f32 v47, v31
  v_mfma_f32_16x16x32_bf16 v[152:155], a[152:155], v[32:35], v[152:155]
  ds_read_b64_tr_b16 a[170:171], v74 offset:24576
  v_cvt_pk_bf16_f32 v39, v46, v47
  v_mfma_f32_16x16x32_bf16 v[156:159], a[156:159], v[32:35], v[156:159]
  ds_read_b64_tr_b16 a[226:227], v88 offset:4096
  ds_read_b64_tr_b16 a[228:229], v89 offset:0
  v_mfma_f32_16x16x32_bf16 v[108:111], a[192:195], a[16:19], v[56:59]
  s_add_u32 m0, s43, 2048
  v_exp_f32 v40, v16
  v_mfma_f32_16x16x32_bf16 v[108:111], a[196:199], a[20:23], v[108:111]
  buffer_load_dwordx4 v82, s[12:15], s42 offen lds
  v_mfma_f32_16x16x32_bf16 v[108:111], a[200:203], a[24:27], v[108:111]
  v_exp_f32 v41, v17
  v_mfma_f32_16x16x32_bf16 v[108:111], a[204:207], a[28:31], v[108:111]
  ds_read_b64_tr_b16 a[172:173], v75 offset:16384
  v_cvt_pk_bf16_f32 v32, v40, v41
  v_mfma_f32_16x16x32_bf16 v[112:115], a[208:211], a[16:19], v[56:59]
  v_exp_f32 v42, v18
  v_mfma_f32_16x16x32_bf16 v[112:115], a[212:215], a[20:23], v[112:115]
  buffer_load_dwordx4 v83, s[12:15], s42 offen offset:1024 lds
  v_mfma_f32_16x16x32_bf16 v[112:115], a[216:219], a[24:27], v[112:115]
  s_add_u32 s42, s42, 8192
  v_exp_f32 v43, v19
  v_mfma_f32_16x16x32_bf16 v[112:115], a[220:223], a[28:31], v[112:115]
  ds_read_b64_tr_b16 a[174:175], v75 offset:24576
  v_cvt_pk_bf16_f32 v33, v42, v43
  v_mfma_f32_16x16x32_bf16 v[48:51], v[8:11], v[36:39], v[48:51]
  v_exp_f32 v44, v20
  v_mfma_f32_16x16x32_bf16 v[160:163], a[128:131], v[36:39], v[160:163]
  ds_read_b64_tr_b16 a[176:177], v76 offset:16384
  ds_read_b64_tr_b16 a[230:231], v89 offset:4096
  v_mfma_f32_16x16x32_bf16 v[164:167], a[132:135], v[36:39], v[164:167]
  s_waitcnt vmcnt(12)
  v_exp_f32 v45, v21
  v_mfma_f32_16x16x32_bf16 v[168:171], a[136:139], v[36:39], v[168:171]
  ds_read_b64_tr_b16 a[178:179], v76 offset:24576
  v_cvt_pk_bf16_f32 v34, v44, v45
  v_mfma_f32_16x16x32_bf16 v[172:175], a[140:143], v[36:39], v[172:175]
  s_mov_b32 m0, s64
  v_exp_f32 v46, v22
  v_mfma_f32_16x16x32_bf16 v[176:179], a[144:147], v[36:39], v[176:179]
  ds_read_b64_tr_b16 a[180:181], v77 offset:16384
  ds_read_b64_tr_b16 a[232:233], v90 offset:0
  v_mfma_f32_16x16x32_bf16 v[180:183], a[148:151], v[36:39], v[180:183]
  v_exp_f32 v47, v23
  v_mfma_f32_16x16x32_bf16 v[184:187], a[152:155], v[36:39], v[184:187]
  ds_read_b64_tr_b16 a[182:183], v77 offset:24576
  v_cvt_pk_bf16_f32 v35, v46, v47
  v_mfma_f32_16x16x32_bf16 v[188:191], a[156:159], v[36:39], v[188:191]
  buffer_load_dwordx4 v96, s[20:23], 0 offen offset:0 lds
  v_mfma_f32_16x16x32_bf16 v[24:27], a[64:67], a[48:51], v[64:67]
  v_exp_f32 v40, v108
  v_mfma_f32_16x16x32_bf16 v[24:27], a[68:71], a[52:55], v[24:27]
  ds_read_b64_tr_b16 a[234:235], v90 offset:4096
  ds_read_b64_tr_b16 a[236:237], v91 offset:0
  v_mfma_f32_16x16x32_bf16 v[24:27], a[72:75], a[56:59], v[24:27]
  v_exp_f32 v41, v109
  v_mfma_f32_16x16x32_bf16 v[24:27], a[76:79], a[60:63], v[24:27]
  ds_read_b64_tr_b16 a[238:239], v91 offset:4096
  v_cvt_pk_bf16_f32 v116, v40, v41
  v_mfma_f32_16x16x32_bf16 v[28:31], a[80:83], a[48:51], v[64:67]
  v_exp_f32 v42, v110
  v_mfma_f32_16x16x32_bf16 v[28:31], a[84:87], a[52:55], v[28:31]
  ds_read_b64_tr_b16 a[240:241], v92 offset:0
  v_and_b32 v116, v116, v104
  v_mfma_f32_16x16x32_bf16 v[28:31], a[88:91], a[56:59], v[28:31]
  v_exp_f32 v43, v111
  v_mfma_f32_16x16x32_bf16 v[28:31], a[92:95], a[60:63], v[28:31]
  ds_read_b64_tr_b16 a[242:243], v92 offset:4096
  v_cvt_pk_bf16_f32 v117, v42, v43
  v_mfma_f32_16x16x32_bf16 v[120:123], v[124:127], v[32:35], v[120:123]
  v_exp_f32 v44, v112
  v_mfma_f32_16x16x32_bf16 v[192:195], a[128:131], v[32:35], v[192:195]
  ds_read_b64_tr_b16 a[244:245], v93 offset:0
  v_and_b32 v117, v117, v105
  v_mfma_f32_16x16x32_bf16 v[196:199], a[132:135], v[32:35], v[196:199]
  v_exp_f32 v45, v113
  v_mfma_f32_16x16x32_bf16 v[200:203], a[136:139], v[32:35], v[200:203]
  ds_read_b64_tr_b16 a[246:247], v93 offset:4096
  v_cvt_pk_bf16_f32 v118, v44, v45
  v_mfma_f32_16x16x32_bf16 v[204:207], a[140:143], v[32:35], v[204:207]
  v_exp_f32 v46, v114
  v_mfma_f32_16x16x32_bf16 v[208:211], a[144:147], v[32:35], v[208:211]
  ds_read_b64_tr_b16 a[248:249], v94 offset:0
  v_and_b32 v118, v118, v106
  v_mfma_f32_16x16x32_bf16 v[212:215], a[148:151], v[32:35], v[212:215]
  v_exp_f32 v47, v115
  v_mfma_f32_16x16x32_bf16 v[216:219], a[152:155], v[32:35], v[216:219]
  ds_read_b64_tr_b16 a[250:251], v94 offset:4096
  v_cvt_pk_bf16_f32 v119, v46, v47
  v_mfma_f32_16x16x32_bf16 v[220:223], a[156:159], v[32:35], v[220:223]
  ds_read_b64_tr_b16 a[252:253], v95 offset:0
  ds_read_b64_tr_b16 a[254:255], v95 offset:4096
  v_mfma_f32_16x16x32_bf16 v[16:19], a[96:99], a[0:3], v[52:55]
  v_exp_f32 v40, v24
  v_mfma_f32_16x16x32_bf16 v[16:19], a[100:103], a[4:7], v[16:19]
  ds_read_b64_tr_b16 a[184:185], v78 offset:16384
  v_and_b32 v119, v119, v107
  v_mfma_f32_16x16x32_bf16 v[16:19], a[104:107], a[8:11], v[16:19]
  v_exp_f32 v41, v25
  v_mfma_f32_16x16x32_bf16 v[16:19], a[108:111], a[12:15], v[16:19]
  ds_read_b64_tr_b16 a[186:187], v78 offset:24576
  v_cvt_pk_bf16_f32 v36, v40, v41
  v_mfma_f32_16x16x32_bf16 v[20:23], a[112:115], a[0:3], v[52:55]
  v_exp_f32 v42, v26
  v_mfma_f32_16x16x32_bf16 v[20:23], a[116:119], a[4:7], v[20:23]
  ds_read_b64_tr_b16 a[188:189], v79 offset:16384
  buffer_load_dwordx4 v97, s[20:23], 0 offen offset:1024 lds
  v_mfma_f32_16x16x32_bf16 v[20:23], a[120:123], a[8:11], v[20:23]
  s_waitcnt lgkmcnt(3)
  v_exp_f32 v43, v27
  v_mfma_f32_16x16x32_bf16 v[20:23], a[124:127], a[12:15], v[20:23]
  ds_read_b64_tr_b16 a[190:191], v79 offset:24576
  v_cvt_pk_bf16_f32 v37, v42, v43
  v_mfma_f32_16x16x32_bf16 v[48:51], v[8:11], v[116:119], v[48:51]
  v_exp_f32 v44, v28
  v_mfma_f32_16x16x32_bf16 v[160:163], a[224:227], v[116:119], v[160:163]
  ds_read_b128 a[64:67], v68 offset:16384
  buffer_load_dwordx4 v98, s[20:23], 0 offen offset:2048 lds
  v_mfma_f32_16x16x32_bf16 v[164:167], a[228:231], v[116:119], v[164:167]
  v_exp_f32 v45, v29
  v_mfma_f32_16x16x32_bf16 v[168:171], a[232:235], v[116:119], v[168:171]
  ds_read_b128 a[68:71], v69 offset:16384
  v_cvt_pk_bf16_f32 v38, v44, v45
  v_mfma_f32_16x16x32_bf16 v[172:175], a[236:239], v[116:119], v[172:175]
  v_exp_f32 v46, v30
  v_mfma_f32_16x16x32_bf16 v[176:179], a[240:243], v[116:119], v[176:179]
  ds_read_b128 a[72:75], v70 offset:16384
  buffer_load_dwordx4 v99, s[20:23], 0 offen offset:3072 lds
  v_mfma_f32_16x16x32_bf16 v[180:183], a[244:247], v[116:119], v[180:183]
  s_add_u32 m0, s64, 4096
  v_exp_f32 v47, v31
  v_mfma_f32_16x16x32_bf16 v[184:187], a[248:251], v[116:119], v[184:187]
  ds_read_b128 a[76:79], v71 offset:16384
  v_cvt_pk_bf16_f32 v39, v46, v47
  v_mfma_f32_16x16x32_bf16 v[188:191], a[252:255], v[116:119], v[188:191]
  buffer_load_dwordx4 v100, s[20:23], 0 offen offset:0 lds
  s_branch L_A1
L_T0_hi:
  s_cbranch_scc1 L_T0_3
L_T0_2:
  v_mfma_f32_16x16x32_bf16 v[24:27], a[64:67], a[16:19], v[56:59]
  s_waitcnt vmcnt(23)
  v_exp_f32 v40, v16
  v_mfma_f32_16x16x32_bf16 v[24:27], a[68:71], a[20:23], v[24:27]
  ds_read_b128 a[112:115], v68 offset:8192
  ds_read_b128 a[192:195], v84 offset:0
  v_mfma_f32_16x16x32_bf16 v[24:27], a[72:75], a[24:27], v[24:27]
  v_exp_f32 v41, v17
  v_mfma_f32_16x16x32_bf16 v[24:27], a[76:79], a[28:31], v[24:27]
  ds_read_b128 a[116:119], v69 offset:8192
  v_cvt_pk_bf16_f32 v32, v40, v41
  v_mfma_f32_16x16x32_bf16 v[28:31], a[80:83], a[16:19], v[56:59]
  v_exp_f32 v42, v18
  v_mfma_f32_16x16x32_bf16 v[28:31], a[84:87], a[20:23], v[28:31]
  ds_read_b128 a[120:123], v70 offset:8192
  ds_read_b128 a[196:199], v85 offset:0
  v_mfma_f32_16x16x32_bf16 v[28:31], a[88:91], a[24:27], v[28:31]
  v_exp_f32 v43, v19
  v_mfma_f32_16x16x32_bf16 v[28:31], a[92:95], a[28:31], v[28:31]
  ds_read_b128 a[124:127], v71 offset:8192
  v_cvt_pk_bf16_f32 v33, v42, v43
  v_mfma_f32_16x16x32_bf16 v[120:123], v[8:11], v[36:39], v[120:123]
  v_exp_f32 v44, v20
  v_mfma_f32_16x16x32_bf16 v[224:227], a[160:163], v[36:39], v[224:227]
  ds_read_b128 a[200:203], v86 offset:0
  ds_read_b128 a[204:207], v87 offset:0
  v_mfma_f32_16x16x32_bf16 v[228:231], a[164:167], v[36:39], v[228:231]
  v_exp_f32 v45, v21
  v_mfma_f32_16x16x32_bf16 v[232:235], a[168:171], v[36:39], v[232:235]
  ds_read_b128 a[208:211], v84 offset:4096
  v_cvt_pk_bf16_f32 v34, v44, v45
  v_mfma_f32_16x16x32_bf16 v[236:239], a[172:175], v[36:39], v[236:239]
  v_exp_f32 v46, v22
  v_mfma_f32_16x16x32_bf16 v[240:243], a[176:179], v[36:39], v[240:243]
  ds_read_b128 a[212:215], v85 offset:4096
  ds_read_b128 a[216:219], v86 offset:4096
  v_mfma_f32_16x16x32_bf16 v[244:247], a[180:183], v[36:39], v[244:247]
  s_waitcnt vmcnt(15) lgkmcnt(5)
  v_exp_f32 v47, v23
  v_mfma_f32_16x16x32_bf16 v[248:251], a[184:187], v[36:39], v[248:251]
  ds_read_b128 a[220:223], v87 offset:4096
  v_cvt_pk_bf16_f32 v35, v46, v47
  v_mfma_f32_16x16x32_bf16 v[252:255], a[188:191], v[36:39], v[252:255]
  s_barrier
  v_mfma_f32_16x16x32_bf16 v[16:19], a[64:67], a[32:35], v[60:63]
  v_exp_f32 v40, v24
  v_mfma_f32_16x16x32_bf16 v[16:19], a[68:71], a[36:39], v[16:19]
  ds_read_b64_tr_b16 a[160:161], v72 offset:16384
  v_mfma_f32_16x16x32_bf16 v[16:19], a[72:75], a[40:43], v[16:19]
  s_add_u32 m0, s43, 0
  v_exp_f32 v41, v25
  v_mfma_f32_16x16x32_bf16 v[16:19], a[76:79], a[44:47], v[16:19]
  ds_read_b64_tr_b16 a[162:163], v72 offset:24576
  v_cvt_pk_bf16_f32 v36, v40, v41
  v_mfma_f32_16x16x32_bf16 v[20:23], a[80:83], a[32:35], v[60:63]
  v_exp_f32 v42, v26
  v_mfma_f32_16x16x32_bf16 v[20:23], a[84:87], a[36:39], v[20:23]
  buffer_load_dwordx4 v80, s[8:11], s41 offen lds
  v_mfma_f32_16x16x32_bf16 v[20:23], a[88:91], a[40:43], v[20:23]
  v_exp_f32 v43, v27
  v_mfma_f32_16x16x32_bf16 v[20:23], a[92:95], a[44:47], v[20:23]
  ds_read_b64_tr_b16 a[164:165], v73 offset:16384
  v_cvt_pk_bf16_f32 v37, v42, v43
  v_mfma_f32_16x16x32_bf16 v[48:51], v[124:127], v[32:35], v[48:51]
  v_exp_f32 v44, v28
  v_mfma_f32_16x16x32_bf16 v[128:131], a[128:131], v[32:35], v[128:131]
  buffer_load_dwordx4 v81, s[8:11], s41 offen offset:1024 lds
  v_mfma_f32_16x16x32_bf16 v[132:135], a[132:135], v[32:35], v[132:135]
  s_add_u32 s41, s41, 8192
  v_exp_f32 v45, v29
  v_mfma_f32_16x16x32_bf16 v[136:139], a[136:139], v[32:35], v[136:139]
  ds_read_b64_tr_b16 a[166:167], v73 offset:24576
  v_cvt_pk_bf16_f32 v38, v44, v45
  v_mfma_f32_16x16x32_bf16 v[140:143], a[140:143], v[32:35], v[140:143]
  s_waitcnt vmcnt(13)
  v_exp_f32 v46, v30
  v_mfma_f32_16x16x32_bf16 v[144:147], a[144:147], v[32:35], v[144:147]
  ds_read_b64_tr_b16 a[168:169], v74 offset:16384
  ds_read_b64_tr_b16 a[224:225], v88 offset:0
  v_mfma_f32_16x16x32_bf16 v[148:151], a[148:151], v[32:35], v[148:151]
  s_waitcnt lgkmcnt(6)
  v_exp_f32 v47, v31
  v_mfma_f32_16x16x32_bf16 v[152:155], a[152:155], v[32:35], v[152:155]
  ds_read_b64_tr_b16 a[170:171], v74 offset:24576
  v_cvt_pk_bf16_f32 v39, v46, v47
  v_mfma_f32_16x16x32_bf16 v[156:159], a[156:159], v[32:35], v[156:159]
  ds_read_b64_tr_b16 a[226:227], v88 offset:4096
  ds_read_b64_tr_b16 a[228:229], v89 offset:0
  v_mfma_f32_16x16x32_bf16 v[108:111], a[192:195], a[32:35], v[60:63]
  s_add_u32 m0, s43, 2048
  v_exp_f32 v40, v16
  v_mfma_f32_16x16x32_bf16 v[108:111], a[196:199], a[36:39], v[108:111]
  buffer_load_dwordx4 v82, s[12:15], s42 offen lds
  v_mfma_f32_16x16x32_bf16 v[108:111], a[200:203], a[40:43], v[108:111]
  v_exp_f32 v41, v17
  v_mfma_f32_16x16x32_bf16 v[108:111], a[204:207], a[44:47], v[108:111]
  ds_read_b64_tr_b16 a[172:173], v75 offset:16384
  v_cvt_pk_bf16_f32 v32, v40, v41
  v_mfma_f32_16x16x32_bf16 v[112:115], a[208:211], a[32:35], v[60:63]
  v_exp_f32 v42, v18
  v_mfma_f32_16x16x32_bf16 v[112:115], a[212:215], a[36:39], v[112:115]
  buffer_load_dwordx4 v83, s[12:15], s42 offen offset:1024 lds
  v_mfma_f32_16x16x32_bf16 v[112:115], a[216:219], a[40:43], v[112:115]
  s_add_u32 s42, s42, 8192
  v_exp_f32 v43, v19
  v_mfma_f32_16x16x32_bf16 v[112:115], a[220:223], a[44:47], v[112:115]
  ds_read_b64_tr_b16 a[174:175], v75 offset:24576
  v_cvt_pk_bf16_f32 v33, v42, v43
  v_mfma_f32_16x16x32_bf16 v[48:51], v[8:11], v[36:39], v[48:51]
  v_exp_f32 v44, v20
  v_mfma_f32_16x16x32_bf16 v[160:163], a[128:131], v[36:39], v[160:163]
  ds_read_b64_tr_b16 a[176:177], v76 offset:16384
  ds_read_b64_tr_b16 a[230:231], v89 offset:4096
  v_mfma_f32_16x16x32_bf16 v[164:167], a[132:135], v[36:39], v[164:167]
  s_waitcnt vmcnt(12)
  v_exp_f32 v45, v21
  v_mfma_f32_16x16x32_bf16 v[168:171], a[136:139], v[36:39], v[168:171]
  ds_read_b64_tr_b16 a[178:179], v76 offset:24576
  v_cvt_pk_bf16_f32 v34, v44, v45
  v_mfma_f32_16x16x32_bf16 v[172:175], a[140:143], v[36:39], v[172:175]
  s_mov_b32 m0, s64
  v_exp_f32 v46, v22
  v_mfma_f32_16x16x32_bf16 v[176:179], a[144:147], v[36:39], v[176:179]
  ds_read_b64_tr_b16 a[180:181], v77 offset:16384
  ds_read_b64_tr_b16 a[232:233], v90 offset:0
  v_mfma_f32_16x16x32_bf16 v[180:183], a[148:151], v[36:39], v[180:183]
  v_exp_f32 v47, v23
  v_mfma_f32_16x16x32_bf16 v[184:187], a[152:155], v[36:39], v[184:187]
  ds_read_b64_tr_b16 a[182:183], v77 offset:24576
  v_cvt_pk_bf16_f32 v35, v46, v47
  v_mfma_f32_16x16x32_bf16 v[188:191], a[156:159], v[36:39], v[188:191]
  buffer_load_dwordx4 v96, s[20:23], 0 offen offset:0 lds
  v_mfma_f32_16x16x32_bf16 v[24:27], a[64:67], a[48:51], v[64:67]
  v_exp_f32 v40, v108
  v_mfma_f32_16x16x32_bf16 v[24:27], a[68:71], a[52:55], v[24:27]
  ds_read_b64_tr_b16 a[234:235], v90 offset:4096
  ds_read_b64_tr_b16 a[236:237], v91 offset:0
  v_mfma_f32_16x16x32_bf16 v[24:27], a[72:75], a[56:59], v[24:27]
  v_exp_f32 v41, v109
  v_mfma_f32_16x16x32_bf16 v[24:27], a[76:79], a[60:63], v[24:27]
  ds_read_b64_tr_b16 a[238:239], v91 offset:4096
  v_cvt_pk_bf16_f32 v116, v40, v41
  v_mfma_f32_16x16x32_bf16 v[28:31], a[80:83], a[48:51], v[64:67]
  v_exp_f32 v42, v110
  v_mfma_f32_16x16x32_bf16 v[28:31], a[84:87], a[52:55], v[28:31]
  ds_read_b64_tr_b16 a[240:241], v92 offset:0
  v_and_b32 v116, v116, v104
  v_mfma_f32_16x16x32_bf16 v[28:31], a[88:91], a[56:59], v[28:31]
  v_exp_f32 v43, v111
  v_mfma_f32_16x16x32_bf16 v[28:31], a[92:95], a[60:63], v[28:31]
  ds_read_b64_tr_b16 a[242:243], v92 offset:4096
  v_cvt_pk_bf16_f32 v117, v42, v43
  v_mfma_f32_16x16x32_bf16 v[120:123], v[124:127], v[32:35], v[120:123]
  v_exp_f32 v44, v112
  v_mfma_f32_16x16x32_bf16 v[192:195], a[128:131], v[32:35], v[192:195]
  ds_read_b64_tr_b16 a[244:245], v93 offset:0
  v_and_b32 v117, v117, v105
  v_mfma_f32_16x16x32_bf16 v[196:199], a[132:135], v[32:35], v[196:199]
  v_exp_f32 v45, v113
  v_mfma_f32_16x16x32_bf16 v[200:203], a[136:139], v[32:35], v[200:203]
  ds_read_b64_tr_b16 a[246:247], v93 offset:4096
  v_cvt_pk_bf16_f32 v118, v44, v45
  v_mfma_f32_16x16x32_bf16 v[204:207], a[140:143], v[32:35], v[204:207]
  v_exp_f32 v46, v114
  v_mfma_f32_16x16x32_bf16 v[208:211], a[144:147], v[32:35], v[208:211]
  ds_read_b64_tr_b16 a[248:249], v94 offset:0
  v_and_b32 v118, v118, v106
  v_mfma_f32_16x16x32_bf16 v[212:215], a[148:151], v[32:35], v[212:215]
  v_exp_f32 v47, v115
  v_mfma_f32_16x16x32_bf16 v[216:219], a[152:155], v[32:35], v[216:219]
  ds_read_b64_tr_b16 a[250:251], v94 offset:4096
  v_cvt_pk_bf16_f32 v119, v46, v47
  v_mfma_f32_16x16x32_bf16 v[220:223], a[156:159], v[32:35], v[220:223]
  ds_read_b64_tr_b16 a[252:253], v95 offset:0
  ds_read_b64_tr_b16 a[254:255], v95 offset:4096
  v_mfma_f32_16x16x32_bf16 v[16:19], a[96:99], a[0:3], v[52:55]
  v_exp_f32 v40, v24
  v_mfma_f32_16x16x32_bf16 v[16:19], a[100:103], a[4:7], v[16:19]
  ds_read_b64_tr_b16 a[184:185], v78 offset:16384
  v_and_b32 v119, v119, v107
  v_mfma_f32_16x16x32_bf16 v[16:19], a[104:107], a[8:11], v[16:19]
  v_exp_f32 v41, v25
  v_mfma_f32_16x16x32_bf16 v[16:19], a[108:111], a[12:15], v[16:19]
  ds_read_b64_tr_b16 a[186:187], v78 offset:24576
  v_cvt_pk_bf16_f32 v36, v40, v41
  v_mfma_f32_16x16x32_bf16 v[20:23], a[112:115], a[0:3], v[52:55]
  v_exp_f32 v42, v26
  v_mfma_f32_16x16x32_bf16 v[20:23], a[116:119], a[4:7], v[20:23]
  ds_read_b64_tr_b16 a[188:189], v79 offset:16384
  buffer_load_dwordx4 v97, s[20:23], 0 offen offset:1024 lds
  v_mfma_f32_16x16x32_bf16 v[20:23], a[120:123], a[8:11], v[20:23]
  s_waitcnt lgkmcnt(3)
  v_exp_f32 v43, v27
  v_mfma_f32_16x16x32_bf16 v[20:23], a[124:127], a[12:15], v[20:23]
  ds_read_b64_tr_b16 a[190:191], v79 offset:24576
  v_cvt_pk_bf16_f32 v37, v42, v43
  v_mfma_f32_16x16x32_bf16 v[120:123], v[124:127], v[116:119], v[120:123]
  v_exp_f32 v44, v28
  v_mfma_f32_16x16x32_bf16 v[192:195], a[224:227], v[116:119], v[192:195]
  ds_read_b128 a[64:67], v68 offset:16384
  buffer_load_dwordx4 v98, s[20:23], 0 offen offset:2048 lds
  v_mfma_f32_16x16x32_bf16 v[196:199], a[228:231], v[116:119], v[196:199]
  v_exp_f32 v45, v29
  v_mfma_f32_16x16x32_bf16 v[200:203], a[232:235], v[116:119], v[200:203]
  ds_read_b128 a[68:71], v69 offset:16384
  v_cvt_pk_bf16_f32 v38, v44, v45
  v_mfma_f32_16x16x32_bf16 v[204:207], a[236:239], v[116:119], v[204:207]
  v_exp_f32 v46, v30
  v_mfma_f32_16x16x32_bf16 v[208:211], a[240:243], v[116:119], v[208:211]
  ds_read_b128 a[72:75], v70 offset:16384
  buffer_load_dwordx4 v99, s[20:23], 0 offen offset:3072 lds
  v_mfma_f32_16x16x32_bf16 v[212:215], a[244:247], v[116:119], v[212:215]
  s_add_u32 m0, s64, 4096
  v_exp_f32 v47, v31
  v_mfma_f32_16x16x32_bf16 v[216:219], a[248:251], v[116:119], v[216:219]
  ds_read_b128 a[76:79], v71 offset:16384
  v_cvt_pk_bf16_f32 v39, v46, v47
  v_mfma_f32_16x16x32_bf16 v[220:223], a[252:255], v[116:119], v[220:223]
  buffer_load_dwordx4 v100, s[20:23], 0 offen offset:0 lds
  s_branch L_A1
.p2align 3
L_T0_3:
  v_mfma_f32_16x16x32_bf16 v[24:27], a[64:67], a[16:19], v[56:59]
  s_waitcnt vmcnt(23)
  v_exp_f32 v40, v16
  v_mfma_f32_16x16x32_bf16 v[24:27], a[68:71], a[20:23], v[24:27]
  ds_read_b128 a[112:115], v68 offset:8192
  ds_read_b128 a[192:195], v84 offset:0
  v_mfma_f32_16x16x32_bf16 v[24:27], a[72:75], a[24:27], v[24:27]
  v_exp_f32 v41, v17
  v_mfma_f32_16x16x32_bf16 v[24:27], a[76:79], a[28:31], v[24:27]
  ds_read_b128 a[116:119], v69 offset:8192
  v_cvt_pk_bf16_f32 v32, v40, v41
  v_mfma_f32_16x16x32_bf16 v[28:31], a[80:83], a[16:19], v[56:59]
  v_exp_f32 v42, v18
  v_mfma_f32_16x16x32_bf16 v[28:31], a[84:87], a[20:23], v[28:31]
  ds_read_b128 a[120:123], v70 offset:8192
  ds_read_b128 a[196:199], v85 offset:0
  v_mfma_f32_16x16x32_bf16 v[28:31], a[88:91], a[24:27], v[28:31]
  v_exp_f32 v43, v19
  v_mfma_f32_16x16x32_bf16 v[28:31], a[92:95], a[28:31], v[28:31]
  ds_read_b128 a[124:127], v71 offset:8192
  v_cvt_pk_bf16_f32 v33, v42, v43
  v_mfma_f32_16x16x32_bf16 v[120:123], v[8:11], v[36:39], v[120:123]
  v_exp_f32 v44, v20
  v_mfma_f32_16x16x32_bf16 v[224:227], a[160:163], v[36:39], v[224:227]
  ds_read_b128 a[200:203], v86 offset:0
  ds_read_b128 a[204:207], v87 offset:0
  v_mfma_f32_16x16x32_bf16 v[228:231], a[164:167], v[36:39], v[228:231]
  v_exp_f32 v45, v21
  v_mfma_f32_16x16x32_bf16 v[232:235], a[168:171], v[36:39], v[232:235]
  ds_read_b128 a[208:211], v84 offset:4096
  v_cvt_pk_bf16_f32 v34, v44, v45
  v_mfma_f32_16x16x32_bf16 v[236:239], a[172:175], v[36:39], v[236:239]
  v_exp_f32 v46, v22
  v_mfma_f32_16x16x32_bf16 v[240:243], a[176:179], v[36:39], v[240:243]
  ds_read_b128 a[212:215], v85 offset:4096
  ds_read_b128 a[216:219], v86 offset:4096
  v_mfma_f32_16x16x32_bf16 v[244:247], a[180:183], v[36:39], v[244:247]
  s_waitcnt vmcnt(15) lgkmcnt(5)
  v_exp_f32 v47, v23
  v_mfma_f32_16x16x32_bf16 v[248:251], a[184:187], v[36:39], v[248:251]
  ds_read_b128 a[220:223], v87 offset:4096
  v_cvt_pk_bf16_f32 v35, v46, v47
  v_mfma_f32_16x16x32_bf16 v[252:255], a[188:191], v[36:39], v[252:255]
  s_barrier
  v_mfma_f32_16x16x32_bf16 v[16:19], a[64:67], a[32:35], v[60:63]
  v_exp_f32 v40, v24
  v_mfma_f32_16x16x32_bf16 v[16:19], a[68:71], a[36:39], v[16:19]
  ds_read_b64_tr_b16 a[160:161], v72 offset:16384
  v_mfma_f32_16x16x32_bf16 v[16:19], a[72:75], a[40:43], v[16:19]
  s_add_u32 m0, s43, 0
  v_exp_f32 v41, v25
  v_mfma_f32_16x16x32_bf16 v[16:19], a[76:79], a[44:47], v[16:19]
  ds_read_b64_tr_b16 a[162:163], v72 offset:24576
  v_cvt_pk_bf16_f32 v36, v40, v41
  v_mfma_f32_16x16x32_bf16 v[20:23], a[80:83], a[32:35], v[60:63]
  v_exp_f32 v42, v26
  v_mfma_f32_16x16x32_bf16 v[20:23], a[84:87], a[36:39], v[20:23]
  buffer_load_dwordx4 v80, s[8:11], s41 offen lds
  v_mfma_f32_16x16x32_bf16 v[20:23], a[88:91], a[40:43], v[20:23]
  v_exp_f32 v43, v27
  v_mfma_f32_16x16x32_bf16 v[20:23], a[92:95], a[44:47], v[20:23]
  ds_read_b64_tr_b16 a[164:165], v73 offset:16384
  v_cvt_pk_bf16_f32 v37, v42, v43
  v_mfma_f32_16x16x32_bf16 v[48:51], v[124:127], v[32:35], v[48:51]
  v_exp_f32 v44, v28
  v_mfma_f32_16x16x32_bf16 v[128:131], a[128:131], v[32:35], v[128:131]
  buffer_load_dwordx4 v81, s[8:11], s41 offen offset:1024 lds
  v_mfma_f32_16x16x32_bf16 v[132:135], a[132:135], v[32:35], v[132:135]
  s_add_u32 s41, s41, 8192
  v_exp_f32 v45, v29
  v_mfma_f32_16x16x32_bf16 v[136:139], a[136:139], v[32:35], v[136:139]
  ds_read_b64_tr_b16 a[166:167], v73 offset:24576
  v_cvt_pk_bf16_f32 v38, v44, v45
  v_mfma_f32_16x16x32_bf16 v[140:143], a[140:143], v[32:35], v[140:143]
  s_waitcnt vmcnt(13)
  v_exp_f32 v46, v30
  v_mfma_f32_16x16x32_bf16 v[144:147], a[144:147], v[32:35], v[144:147]
  ds_read_b64_tr_b16 a[168:169], v74 offset:16384
  ds_read_b64_tr_b16 a[224:225], v88 offset:0
  v_mfma_f32_16x16x32_bf16 v[148:151], a[148:151], v[32:35], v[148:151]
  s_waitcnt lgkmcnt(6)
  v_exp_f32 v47, v31
  v_mfma_f32_16x16x32_bf16 v[152:155], a[152:155], v[32:35], v[152:155]
  ds_read_b64_tr_b16 a[170:171], v74 offset:24576
  v_cvt_pk_bf16_f32 v39, v46, v47
  v_mfma_f32_16x16x32_bf16 v[156:159], a[156:159], v[32:35], v[156:159]
  ds_read_b64_tr_b16 a[226:227], v88 offset:4096
  ds_read_b64_tr_b16 a[228:229], v89 offset:0
  v_mfma_f32_16x16x32_bf16 v[108:111], a[192:195], a[48:51], v[64:67]
  s_add_u32 m0, s43, 2048
  v_exp_f32 v40, v16
  v_mfma_f32_16x16x32_bf16 v[108:111], a[196:199], a[52:55], v[108:111]
  buffer_load_dwordx4 v82, s[12:15], s42 offen lds
  v_mfma_f32_16x16x32_bf16 v[108:111], a[200:203], a[56:59], v[108:111]
  v_exp_f32 v41, v17
  v_mfma_f32_16x16x32_bf16 v[108:111], a[204:207], a[60:63], v[108:111]
  ds_read_b64_tr_b16 a[172:173], v75 offset:16384
  v_cvt_pk_bf16_f32 v32, v40, v41
  v_mfma_f32_16x16x32_bf16 v[112:115], a[208:211], a[48:51], v[64:67]
  v_exp_f32 v42, v18
  v_mfma_f32_16x16x32_bf16 v[112:115], a[212:215], a[52:55], v[112:115]
  buffer_load_dwordx4 v83, s[12:15], s42 offen offset:1024 lds
  v_mfma_f32_16x16x32_bf16 v[112:115], a[216:219], a[56:59], v[112:115]
  s_add_u32 s42, s42, 8192
  v_exp_f32 v43, v19
  v_mfma_f32_16x16x32_bf16 v[112:115], a[220:223], a[60:63], v[112:115]
  ds_read_b64_tr_b16 a[174:175], v75 offset:24576
  v_cvt_pk_bf16_f32 v33, v42, v43
  v_mfma_f32_16x16x32_bf16 v[48:51], v[8:11], v[36:39], v[48:51]
  v_exp_f32 v44, v20
  v_mfma_f32_16x16x32_bf16 v[160:163], a[128:131], v[36:39], v[160:163]
  ds_read_b64_tr_b16 a[176:177], v76 offset:16384
  ds_read_b64_tr_b16 a[230:231], v89 offset:4096
  v_mfma_f32_16x16x32_bf16 v[164:167], a[132:135], v[36:39], v[164:167]
  s_waitcnt vmcnt(12)
  v_exp_f32 v45, v21
  v_mfma_f32_16x16x32_bf16 v[168:171], a[136:139], v[36:39], v[168:171]
  ds_read_b64_tr_b16 a[178:179], v76 offset:24576
  v_cvt_pk_bf16_f32 v34, v44, v45
  v_mfma_f32_16x16x32_bf16 v[172:175], a[140:143], v[36:39], v[172:175]
  s_mov_b32 m0, s64
  v_exp_f32 v46, v22
  v_mfma_f32_16x16x32_bf16 v[176:179], a[144:147], v[36:39], v[176:179]
  ds_read_b64_tr_b16 a[180:181], v77 offset:16384
  ds_read_b64_tr_b16 a[232:233], v90 offset:0
  v_mfma_f32_16x16x32_bf16 v[180:183], a[148:151], v[36:39], v[180:183]
  v_exp_f32 v47, v23
  v_mfma_f32_16x16x32_bf16 v[184:187], a[152:155], v[36:39], v[184:187]
  ds_read_b64_tr_b16 a[182:183], v77 offset:24576
  v_cvt_pk_bf16_f32 v35, v46, v47
  v_mfma_f32_16x16x32_bf16 v[188:191], a[156:159], v[36:39], v[188:191]
  buffer_load_dwordx4 v96, s[20:23], 0 offen offset:0 lds
  v_mfma_f32_16x16x32_bf16 v[24:27], a[64:67], a[48:51], v[64:67]
  v_exp_f32 v40, v108
  v_mfma_f32_16x16x32_bf16 v[24:27], a[68:71], a[52:55], v[24:27]
  ds_read_b64_tr_b16 a[234:235], v90 offset:4096
  ds_read_b64_tr_b16 a[236:237], v91 offset:0
  v_mfma_f32_16x16x32_bf16 v[24:27], a[72:75], a[56:59], v[24:27]
  v_exp_f32 v41, v109
  v_mfma_f32_16x16x32_bf16 v[24:27], a[76:79], a[60:63], v[24:27]
  ds_read_b64_tr_b16 a[238:239], v91 offset:4096
  v_cvt_pk_bf16_f32 v116, v40, v41
  v_mfma_f32_16x16x32_bf16 v[28:31], a[80:83], a[48:51], v[64:67]
  v_exp_f32 v42, v110
  v_mfma_f32_16x16x32_bf16 v[28:31], a[84:87], a[52:55], v[28:31]
  ds_read_b64_tr_b16 a[240:241], v92 offset:0
  v_and_b32 v116, v116, v104
  v_mfma_f32_16x16x32_bf16 v[28:31], a[88:91], a[56:59], v[28:31]
  v_exp_f32 v43, v111
  v_mfma_f32_16x16x32_bf16 v[28:31], a[92:95], a[60:63], v[28:31]
  ds_read_b64_tr_b16 a[242:243], v92 offset:4096
  v_cvt_pk_bf16_f32 v117, v42, v43
  v_mfma_f32_16x16x32_bf16 v[120:123], v[124:127], v[32:35], v[120:123]
  v_exp_f32 v44, v112
  v_mfma_f32_16x16x32_bf16 v[192:195], a[128:131], v[32:35], v[192:195]
  ds_read_b64_tr_b16 a[244:245], v93 offset:0
  v_and_b32 v117, v117, v105
  v_mfma_f32_16x16x32_bf16 v[196:199], a[132:135], v[32:35], v[196:199]
  v_exp_f32 v45, v113
  v_mfma_f32_16x16x32_bf16 v[200:203], a[136:139], v[32:35], v[200:203]
  ds_read_b64_tr_b16 a[246:247], v93 offset:4096
  v_cvt_pk_bf16_f32 v118, v44, v45
  v_mfma_f32_16x16x32_bf16 v[204:207], a[140:143], v[32:35], v[204:207]
  v_exp_f32 v46, v114
  v_mfma_f32_16x16x32_bf16 v[208:211], a[144:147], v[32:35], v[208:211]
  ds_read_b64_tr_b16 a[248:249], v94 offset:0
  v_and_b32 v118, v118, v106
  v_mfma_f32_16x16x32_bf16 v[212:215], a[148:151], v[32:35], v[212:215]
  v_exp_f32 v47, v115
  v_mfma_f32_16x16x32_bf16 v[216:219], a[152:155], v[32:35], v[216:219]
  ds_read_b64_tr_b16 a[250:251], v94 offset:4096
  v_cvt_pk_bf16_f32 v119, v46, v47
  v_mfma_f32_16x16x32_bf16 v[220:223], a[156:159], v[32:35], v[220:223]
  ds_read_b64_tr_b16 a[252:253], v95 offset:0
  ds_read_b64_tr_b16 a[254:255], v95 offset:4096
  v_mfma_f32_16x16x32_bf16 v[16:19], a[96:99], a[0:3], v[52:55]
  v_exp_f32 v40, v24
  v_mfma_f32_16x16x32_bf16 v[16:19], a[100:103], a[4:7], v[16:19]
  ds_read_b64_tr_b16 a[184:185], v78 offset:16384
  v_and_b32 v119, v119, v107
  v_mfma_f32_16x16x32_bf16 v[16:19], a[104:107], a[8:11], v[16:19]
  v_exp_f32 v41, v25
  v_mfma_f32_16x16x32_bf16 v[16:19], a[108:111], a[12:15], v[16:19]
  ds_read_b64_tr_b16 a[186:187], v78 offset:24576
  v_cvt_pk_bf16_f32 v36, v40, v41
  v_mfma_f32_16x16x32_bf16 v[20:23], a[112:115], a[0:3], v[52:55]
  v_exp_f32 v42, v26
  v_mfma_f32_16x16x32_bf16 v[20:23], a[116:119], a[4:7], v[20:23]
  ds_read_b64_tr_b16 a[188:189], v79 offset:16384
  buffer_load_dwordx4 v97, s[20:23], 0 offen offset:1024 lds
  v_mfma_f32_16x16x32_bf16 v[20:23], a[120:123], a[8:11], v[20:23]
  s_waitcnt lgkmcnt(3)
  v_exp_f32 v43, v27
  v_mfma_f32_16x16x32_bf16 v[20:23], a[124:127], a[12:15], v[20:23]
  ds_read_b64_tr_b16 a[190:191], v79 offset:24576
  v_cvt_pk_bf16_f32 v37, v42, v43
  v_mfma_f32_16x16x32_bf16 v[120:123], v[8:11], v[116:119], v[120:123]
  v_exp_f32 v44, v28
  v_mfma_f32_16x16x32_bf16 v[224:227], a[224:227], v[116:119], v[224:227]
  ds_read_b128 a[64:67], v68 offset:16384
  buffer_load_dwordx4 v98, s[20:23], 0 offen offset:2048 lds
  v_mfma_f32_16x16x32_bf16 v[228:231], a[228:231], v[116:119], v[228:231]
  v_exp_f32 v45, v29
  v_mfma_f32_16x16x32_bf16 v[232:235], a[232:235], v[116:119], v[232:235]
  ds_read_b128 a[68:71], v69 offset:16384
  v_cvt_pk_bf16_f32 v38, v44, v45
  v_mfma_f32_16x16x32_bf16 v[236:239], a[236:239], v[116:119], v[236:239]
  v_exp_f32 v46, v30
  v_mfma_f32_16x16x32_bf16 v[240:243], a[240:243], v[116:119], v[240:243]
  ds_read_b128 a[72:75], v70 offset:16384
  buffer_load_dwordx4 v99, s[20:23], 0 offen offset:3072 lds
  v_mfma_f32_16x16x32_bf16 v[244:247], a[244:247], v[116:119], v[244:247]
  s_add_u32 m0, s64, 4096
  v_exp_f32 v47, v31
  v_mfma_f32_16x16x32_bf16 v[248:251], a[248:251], v[116:119], v[248:251]
  ds_read_b128 a[76:79], v71 offset:16384
  v_cvt_pk_bf16_f32 v39, v46, v47
  v_mfma_f32_16x16x32_bf16 v[252:255], a[252:255], v[116:119], v[252:255]
  buffer_load_dwordx4 v100, s[20:23], 0 offen offset:0 lds
  s_branch L_A1
L_B_entry:
  s_or_b32 s87, s76, s77
  s_cmp_gt_u32 s68, 15
  s_cselect_b32 s87, 1, s87
  s_cmp_gt_u32 s69, 15
  s_cselect_b32 s87, 1, s87
  s_cmp_gt_u32 s70, 15
  s_cselect_b32 s87, 1, s87
  s_cmp_gt_u32 s71, 15
  s_cselect_b32 s87, 1, s87
  s_cmp_lg_u32 s87, 0
  s_addc_u32 s44, s44, 0
  s_cmp_eq_u32 s44, 0
  s_cbranch_scc1 L_bdone
.p2align 3
L_B:
  v_mfma_f32_16x16x32_bf16 v[24:27], a[64:67], a[16:19], v[56:59]
  v_exp_f32 v40, v16
  v_mfma_f32_16x16x32_bf16 v[24:27], a[68:71], a[20:23], v[24:27]
  ds_read_b128 a[112:115], v68 offset:8192
  v_mfma_f32_16x16x32_bf16 v[24:27], a[72:75], a[24:27], v[24:27]
  v_exp_f32 v41, v17
  v_mfma_f32_16x16x32_bf16 v[24:27], a[76:79], a[28:31], v[24:27]
  ds_read_b128 a[116:119], v69 offset:8192
  v_cvt_pk_bf16_f32 v32, v40, v41
  v_mfma_f32_16x16x32_bf16 v[28:31], a[80:83], a[16:19], v[56:59]
  v_exp_f32 v42, v18
  v_mfma_f32_16x16x32_bf16 v[28:31], a[84:87], a[20:23], v[28:31]
  ds_read_b128 a[120:123], v70 offset:8192
  v_mfma_f32_16x16x32_bf16 v[28:31], a[88:91], a[24:27], v[28:31]
  v_exp_f32 v43, v19
  v_mfma_f32_16x16x32_bf16 v[28:31], a[92:95], a[28:31], v[28:31]
  ds_read_b128 a[124:127], v71 offset:8192
  v_cvt_pk_bf16_f32 v33, v42, v43
  v_mfma_f32_16x16x32_bf16 v[120:123], v[8:11], v[36:39], v[120:123]
  v_exp_f32 v44, v20
  v_mfma_f32_16x16x32_bf16 v[224:227], a[160:163], v[36:39], v[224:227]
  v_mfma_f32_16x16x32_bf16 v[228:231], a[164:167], v[36:39], v[228:231]
  v_exp_f32 v45, v21
  v_mfma_f32_16x16x32_bf16 v[232:235], a[168:171], v[36:39], v[232:235]
  v_cvt_pk_bf16_f32 v34, v44, v45
  v_mfma_f32_16x16x32_bf16 v[236:239], a[172:175], v[36:39], v[236:239]
  v_exp_f32 v46, v22
  v_mfma_f32_16x16x32_bf16 v[240:243], a[176:179], v[36:39], v[240:243]
  v_mfma_f32_16x16x32_bf16 v[244:247], a[180:183], v[36:39], v[244:247]
  s_waitcnt vmcnt(8) lgkmcnt(0)
  v_exp_f32 v47, v23
  v_mfma_f32_16x16x32_bf16 v[248:251], a[184:187], v[36:39], v[248:251]
  v_cvt_pk_bf16_f32 v35, v46, v47
  v_mfma_f32_16x16x32_bf16 v[252:255], a[188:191], v[36:39], v[252:255]
  s_barrier
  v_mfma_f32_16x16x32_bf16 v[16:19], a[64:67], a[32:35], v[60:63]
  v_exp_f32 v40, v24
  v_mfma_f32_16x16x32_bf16 v[16:19], a[68:71], a[36:39], v[16:19]
  ds_read_b64_tr_b16 a[160:161], v72 offset:16384
  v_mfma_f32_16x16x32_bf16 v[16:19], a[72:75], a[40:43], v[16:19]
  s_add_u32 m0, s43, 0
  v_exp_f32 v41, v25
  v_mfma_f32_16x16x32_bf16 v[16:19], a[76:79], a[44:47], v[16:19]
  ds_read_b64_tr_b16 a[162:163], v72 offset:24576
  v_cvt_pk_bf16_f32 v36, v40, v41
  v_mfma_f32_16x16x32_bf16 v[20:23], a[80:83], a[32:35], v[60:63]
  v_exp_f32 v42, v26
  v_mfma_f32_16x16x32_bf16 v[20:23], a[84:87], a[36:39], v[20:23]
  buffer_load_dwordx4 v80, s[8:11], s41 offen lds
  v_mfma_f32_16x16x32_bf16 v[20:23], a[88:91], a[40:43], v[20:23]
  v_exp_f32 v43, v27
  v_mfma_f32_16x16x32_bf16 v[20:23], a[92:95], a[44:47], v[20:23]
  ds_read_b64_tr_b16 a[164:165], v73 offset:16384
  v_cvt_pk_bf16_f32 v37, v42, v43
  v_mfma_f32_16x16x32_bf16 v[48:51], v[124:127], v[32:35], v[48:51]
  v_exp_f32 v44, v28
  v_mfma_f32_16x16x32_bf16 v[128:131], a[128:131], v[32:35], v[128:131]
  buffer_load_dwordx4 v81, s[8:11], s41 offen offset:1024 lds
  v_mfma_f32_16x16x32_bf16 v[132:135], a[132:135], v[32:35], v[132:135]
  s_add_u32 s41, s41, 8192
  v_exp_f32 v45, v29
  v_mfma_f32_16x16x32_bf16 v[136:139], a[136:139], v[32:35], v[136:139]
  ds_read_b64_tr_b16 a[166:167], v73 offset:24576
  v_cvt_pk_bf16_f32 v38, v44, v45
  v_mfma_f32_16x16x32_bf16 v[140:143], a[140:143], v[32:35], v[140:143]
  v_exp_f32 v46, v30
  v_mfma_f32_16x16x32_bf16 v[144:147], a[144:147], v[32:35], v[144:147]
  ds_read_b64_tr_b16 a[168:169], v74 offset:16384
  v_mfma_f32_16x16x32_bf16 v[148:151], a[148:151], v[32:35], v[148:151]
  v_exp_f32 v47, v31
  v_mfma_f32_16x16x32_bf16 v[152:155], a[152:155], v[32:35], v[152:155]
  ds_read_b64_tr_b16 a[170:171], v74 offset:24576
  v_cvt_pk_bf16_f32 v39, v46, v47
  v_mfma_f32_16x16x32_bf16 v[156:159], a[156:159], v[32:35], v[156:159]
  v_mfma_f32_16x16x32_bf16 v[24:27], a[64:67], a[48:51], v[64:67]
  s_add_u32 m0, s43, 2048
  v_exp_f32 v40, v16
  v_mfma_f32_16x16x32_bf16 v[24:27], a[68:71], a[52:55], v[24:27]
  buffer_load_dwordx4 v82, s[12:15], s42 offen lds
  v_mfma_f32_16x16x32_bf16 v[24:27], a[72:75], a[56:59], v[24:27]
  v_exp_f32 v41, v17
  v_mfma_f32_16x16x32_bf16 v[24:27], a[76:79], a[60:63], v[24:27]
  ds_read_b64_tr_b16 a[172:173], v75 offset:16384
  v_cvt_pk_bf16_f32 v32, v40, v41
  v_mfma_f32_16x16x32_bf16 v[28:31], a[80:83], a[48:51], v[64:67]
  v_exp_f32 v42, v18
  v_mfma_f32_16x16x32_bf16 v[28:31], a[84:87], a[52:55], v[28:31]
  buffer_load_dwordx4 v83, s[12:15], s42 offen offset:1024 lds
  v_mfma_f32_16x16x32_bf16 v[28:31], a[88:91], a[56:59], v[28:31]
  s_add_u32 s42, s42, 8192
  v_exp_f32 v43, v19
  v_mfma_f32_16x16x32_bf16 v[28:31], a[92:95], a[60:63], v[28:31]
  ds_read_b64_tr_b16 a[174:175], v75 offset:24576
  v_cvt_pk_bf16_f32 v33, v42, v43
  v_mfma_f32_16x16x32_bf16 v[48:51], v[8:11], v[36:39], v[48:51]
  v_exp_f32 v44, v20
  v_mfma_f32_16x16x32_bf16 v[160:163], a[128:131], v[36:39], v[160:163]
  ds_read_b64_tr_b16 a[176:177], v76 offset:16384
  v_mfma_f32_16x16x32_bf16 v[164:167], a[132:135], v[36:39], v[164:167]
  v_exp_f32 v45, v21
  v_mfma_f32_16x16x32_bf16 v[168:171], a[136:139], v[36:39], v[168:171]
  ds_read_b64_tr_b16 a[178:179], v76 offset:24576
  v_cvt_pk_bf16_f32 v34, v44, v45
  v_mfma_f32_16x16x32_bf16 v[172:175], a[140:143], v[36:39], v[172:175]
  v_exp_f32 v46, v22
  v_mfma_f32_16x16x32_bf16 v[176:179], a[144:147], v[36:39], v[176:179]
  ds_read_b64_tr_b16 a[180:181], v77 offset:16384
  v_mfma_f32_16x16x32_bf16 v[180:183], a[148:151], v[36:39], v[180:183]
  v_exp_f32 v47, v23
  v_mfma_f32_16x16x32_bf16 v[184:187], a[152:155], v[36:39], v[184:187]
  ds_read_b64_tr_b16 a[182:183], v77 offset:24576
  v_cvt_pk_bf16_f32 v35, v46, v47
  v_mfma_f32_16x16x32_bf16 v[188:191], a[156:159], v[36:39], v[188:191]
  v_mfma_f32_16x16x32_bf16 v[16:19], a[96:99], a[0:3], v[52:55]
  v_exp_f32 v40, v24
  v_mfma_f32_16x16x32_bf16 v[16:19], a[100:103], a[4:7], v[16:19]
  ds_read_b64_tr_b16 a[184:185], v78 offset:16384
  v_mfma_f32_16x16x32_bf16 v[16:19], a[104:107], a[8:11], v[16:19]
  v_exp_f32 v41, v25
  v_mfma_f32_16x16x32_bf16 v[16:19], a[108:111], a[12:15], v[16:19]
  ds_read_b64_tr_b16 a[186:187], v78 offset:24576
  v_cvt_pk_bf16_f32 v36, v40, v41
  v_mfma_f32_16x16x32_bf16 v[20:23], a[112:115], a[0:3], v[52:55]
  v_exp_f32 v42, v26
  v_mfma_f32_16x16x32_bf16 v[20:23], a[116:119], a[4:7], v[20:23]
  ds_read_b64_tr_b16 a[188:189], v79 offset:16384
  v_mfma_f32_16x16x32_bf16 v[20:23], a[120:123], a[8:11], v[20:23]
  v_exp_f32 v43, v27
  v_mfma_f32_16x16x32_bf16 v[20:23], a[124:127], a[12:15], v[20:23]
  ds_read_b64_tr_b16 a[190:191], v79 offset:24576
  v_cvt_pk_bf16_f32 v37, v42, v43
  v_mfma_f32_16x16x32_bf16 v[120:123], v[124:127], v[32:35], v[120:123]
  v_exp_f32 v44, v28
  v_mfma_f32_16x16x32_bf16 v[192:195], a[128:131], v[32:35], v[192:195]
  ds_read_b128 a[64:67], v68 offset:16384
  v_mfma_f32_16x16x32_bf16 v[196:199], a[132:135], v[32:35], v[196:199]
  v_exp_f32 v45, v29
  v_mfma_f32_16x16x32_bf16 v[200:203], a[136:139], v[32:35], v[200:203]
  ds_read_b128 a[68:71], v69 offset:16384
  v_cvt_pk_bf16_f32 v38, v44, v45
  v_mfma_f32_16x16x32_bf16 v[204:207], a[140:143], v[32:35], v[204:207]
  v_exp_f32 v46, v30
  v_mfma_f32_16x16x32_bf16 v[208:211], a[144:147], v[32:35], v[208:211]
  ds_read_b128 a[72:75], v70 offset:16384
  v_mfma_f32_16x16x32_bf16 v[212:215], a[148:151], v[32:35], v[212:215]
  v_exp_f32 v47, v31
  v_mfma_f32_16x16x32_bf16 v[216:219], a[152:155], v[32:35], v[216:219]
  ds_read_b128 a[76:79], v71 offset:16384
  v_cvt_pk_bf16_f32 v39, v46, v47
  v_mfma_f32_16x16x32_bf16 v[220:223], a[156:159], v[32:35], v[220:223]
  v_mfma_f32_16x16x32_bf16 v[24:27], a[96:99], a[16:19], v[56:59]
  v_exp_f32 v40, v16
  v_mfma_f32_16x16x32_bf16 v[24:27], a[100:103], a[20:23], v[24:27]
  ds_read_b128 a[80:83], v68 offset:24576
  v_mfma_f32_16x16x32_bf16 v[24:27], a[104:107], a[24:27], v[24:27]
  v_exp_f32 v41, v17
  v_mfma_f32_16x16x32_bf16 v[24:27], a[108:111], a[28:31], v[24:27]
  ds_read_b128 a[84:87], v69 offset:24576
  v_cvt_pk_bf16_f32 v32, v40, v41
  v_mfma_f32_16x16x32_bf16 v[28:31], a[112:115], a[16:19], v[56:59]
  v_exp_f32 v42, v18
  v_mfma_f32_16x16x32_bf16 v[28:31], a[116:119], a[20:23], v[28:31]
  ds_read_b128 a[88:91], v70 offset:24576
  v_mfma_f32_16x16x32_bf16 v[28:31], a[120:123], a[24:27], v[28:31]
  v_exp_f32 v43, v19
  v_mfma_f32_16x16x32_bf16 v[28:31], a[124:127], a[28:31], v[28:31]
  ds_read_b128 a[92:95], v71 offset:24576
  v_cvt_pk_bf16_f32 v33, v42, v43
  v_mfma_f32_16x16x32_bf16 v[120:123], v[8:11], v[36:39], v[120:123]
  v_exp_f32 v44, v20
  v_mfma_f32_16x16x32_bf16 v[224:227], a[128:131], v[36:39], v[224:227]
  v_mfma_f32_16x16x32_bf16 v[228:231], a[132:135], v[36:39], v[228:231]
  v_exp_f32 v45, v21
  v_mfma_f32_16x16x32_bf16 v[232:235], a[136:139], v[36:39], v[232:235]
  v_cvt_pk_bf16_f32 v34, v44, v45
  v_mfma_f32_16x16x32_bf16 v[236:239], a[140:143], v[36:39], v[236:239]
  v_exp_f32 v46, v22
  v_mfma_f32_16x16x32_bf16 v[240:243], a[144:147], v[36:39], v[240:243]
  v_mfma_f32_16x16x32_bf16 v[244:247], a[148:151], v[36:39], v[244:247]
  s_waitcnt vmcnt(8) lgkmcnt(0)
  v_exp_f32 v47, v23
  v_mfma_f32_16x16x32_bf16 v[248:251], a[152:155], v[36:39], v[248:251]
  v_cvt_pk_bf16_f32 v35, v46, v47
  v_mfma_f32_16x16x32_bf16 v[252:255], a[156:159], v[36:39], v[252:255]
  s_barrier
  v_mfma_f32_16x16x32_bf16 v[16:19], a[96:99], a[32:35], v[60:63]
  v_exp_f32 v40, v24
  v_mfma_f32_16x16x32_bf16 v[16:19], a[100:103], a[36:39], v[16:19]
  ds_read_b64_tr_b16 a[128:129], v72 offset:32768
  v_mfma_f32_16x16x32_bf16 v[16:19], a[104:107], a[40:43], v[16:19]
  s_add_u32 m0, s43, 16384
  v_exp_f32 v41, v25
  v_mfma_f32_16x16x32_bf16 v[16:19], a[108:111], a[44:47], v[16:19]
  ds_read_b64_tr_b16 a[130:131], v72 offset:40960
  v_cvt_pk_bf16_f32 v36, v40, v41
  v_mfma_f32_16x16x32_bf16 v[20:23], a[112:115], a[32:35], v[60:63]
  v_exp_f32 v42, v26
  v_mfma_f32_16x16x32_bf16 v[20:23], a[116:119], a[36:39], v[20:23]
  buffer_load_dwordx4 v80, s[8:11], s41 offen lds
  v_mfma_f32_16x16x32_bf16 v[20:23], a[120:123], a[40:43], v[20:23]
  v_exp_f32 v43, v27
  v_mfma_f32_16x16x32_bf16 v[20:23], a[124:127], a[44:47], v[20:23]
  ds_read_b64_tr_b16 a[132:133], v73 offset:32768
  v_cvt_pk_bf16_f32 v37, v42, v43
  v_mfma_f32_16x16x32_bf16 v[48:51], v[124:127], v[32:35], v[48:51]
  v_exp_f32 v44, v28
  v_mfma_f32_16x16x32_bf16 v[128:131], a[160:163], v[32:35], v[128:131]
  buffer_load_dwordx4 v81, s[8:11], s41 offen offset:1024 lds
  v_mfma_f32_16x16x32_bf16 v[132:135], a[164:167], v[32:35], v[132:135]
  s_add_u32 s41, s41, 8192
  v_exp_f32 v45, v29
  v_mfma_f32_16x16x32_bf16 v[136:139], a[168:171], v[32:35], v[136:139]
  ds_read_b64_tr_b16 a[134:135], v73 offset:40960
  v_cvt_pk_bf16_f32 v38, v44, v45
  v_mfma_f32_16x16x32_bf16 v[140:143], a[172:175], v[32:35], v[140:143]
  v_exp_f32 v46, v30
  v_mfma_f32_16x16x32_bf16 v[144:147], a[176:179], v[32:35], v[144:147]
  ds_read_b64_tr_b16 a[136:137], v74 offset:32768
  v_mfma_f32_16x16x32_bf16 v[148:151], a[180:183], v[32:35], v[148:151]
  v_exp_f32 v47, v31
  v_mfma_f32_16x16x32_bf16 v[152:155], a[184:187], v[32:35], v[152:155]
  ds_read_b64_tr_b16 a[138:139], v74 offset:40960
  v_cvt_pk_bf16_f32 v39, v46, v47
  v_mfma_f32_16x16x32_bf16 v[156:159], a[188:191], v[32:35], v[156:159]
  v_mfma_f32_16x16x32_bf16 v[24:27], a[96:99], a[48:51], v[64:67]
  s_add_u32 m0, s43, 18432
  v_exp_f32 v40, v16
  v_mfma_f32_16x16x32_bf16 v[24:27], a[100:103], a[52:55], v[24:27]
  buffer_load_dwordx4 v82, s[12:15], s42 offen lds
  v_mfma_f32_16x16x32_bf16 v[24:27], a[104:107], a[56:59], v[24:27]
  v_exp_f32 v41, v17
  v_mfma_f32_16x16x32_bf16 v[24:27], a[108:111], a[60:63], v[24:27]
  ds_read_b64_tr_b16 a[140:141], v75 offset:32768
  v_cvt_pk_bf16_f32 v32, v40, v41
  v_mfma_f32_16x16x32_bf16 v[28:31], a[112:115], a[48:51], v[64:67]
  v_exp_f32 v42, v18
  v_mfma_f32_16x16x32_bf16 v[28:31], a[116:119], a[52:55], v[28:31]
  buffer_load_dwordx4 v83, s[12:15], s42 offen offset:1024 lds
  v_mfma_f32_16x16x32_bf16 v[28:31], a[120:123], a[56:59], v[28:31]
  s_add_u32 s42, s42, 8192
  v_exp_f32 v43, v19
  v_mfma_f32_16x16x32_bf16 v[28:31], a[124:127], a[60:63], v[28:31]
  ds_read_b64_tr_b16 a[142:143], v75 offset:40960
  v_cvt_pk_bf16_f32 v33, v42, v43
  v_mfma_f32_16x16x32_bf16 v[48:51], v[8:11], v[36:39], v[48:51]
  v_exp_f32 v44, v20
  v_mfma_f32_16x16x32_bf16 v[160:163], a[160:163], v[36:39], v[160:163]
  ds_read_b64_tr_b16 a[144:145], v76 offset:32768
  v_mfma_f32_16x16x32_bf16 v[164:167], a[164:167], v[36:39], v[164:167]
  v_exp_f32 v45, v21
  v_mfma_f32_16x16x32_bf16 v[168:171], a[168:171], v[36:39], v[168:171]
  ds_read_b64_tr_b16 a[146:147], v76 offset:40960
  v_cvt_pk_bf16_f32 v34, v44, v45
  v_mfma_f32_16x16x32_bf16 v[172:175], a[172:175], v[36:39], v[172:175]
  v_exp_f32 v46, v22
  v_mfma_f32_16x16x32_bf16 v[176:179], a[176:179], v[36:39], v[176:179]
  ds_read_b64_tr_b16 a[148:149], v77 offset:32768
  v_mfma_f32_16x16x32_bf16 v[180:183], a[180:183], v[36:39], v[180:183]
  v_exp_f32 v47, v23
  v_mfma_f32_16x16x32_bf16 v[184:187], a[184:187], v[36:39], v[184:187]
  ds_read_b64_tr_b16 a[150:151], v77 offset:40960
  v_cvt_pk_bf16_f32 v35, v46, v47
  v_mfma_f32_16x16x32_bf16 v[188:191], a[188:191], v[36:39], v[188:191]
  v_mfma_f32_16x16x32_bf16 v[16:19], a[64:67], a[0:3], v[52:55]
  v_exp_f32 v40, v24
  v_mfma_f32_16x16x32_bf16 v[16:19], a[68:71], a[4:7], v[16:19]
  ds_read_b64_tr_b16 a[152:153], v78 offset:32768
  v_mfma_f32_16x16x32_bf16 v[16:19], a[72:75], a[8:11], v[16:19]
  v_exp_f32 v41, v25
  v_mfma_f32_16x16x32_bf16 v[16:19], a[76:79], a[12:15], v[16:19]
  ds_read_b64_tr_b16 a[154:155], v78 offset:40960
  v_cvt_pk_bf16_f32 v36, v40, v41
  v_mfma_f32_16x16x32_bf16 v[20:23], a[80:83], a[0:3], v[52:55]
  v_exp_f32 v42, v26
  v_mfma_f32_16x16x32_bf16 v[20:23], a[84:87], a[4:7], v[20:23]
  ds_read_b64_tr_b16 a[156:157], v79 offset:32768
  v_mfma_f32_16x16x32_bf16 v[20:23], a[88:91], a[8:11], v[20:23]
  v_exp_f32 v43, v27
  v_mfma_f32_16x16x32_bf16 v[20:23], a[92:95], a[12:15], v[20:23]
  ds_read_b64_tr_b16 a[158:159], v79 offset:40960
  v_cvt_pk_bf16_f32 v37, v42, v43
  v_mfma_f32_16x16x32_bf16 v[120:123], v[124:127], v[32:35], v[120:123]
  v_exp_f32 v44, v28
  v_mfma_f32_16x16x32_bf16 v[192:195], a[160:163], v[32:35], v[192:195]
  ds_read_b128 a[96:99], v68 offset:32768
  v_mfma_f32_16x16x32_bf16 v[196:199], a[164:167], v[32:35], v[196:199]
  v_exp_f32 v45, v29
  v_mfma_f32_16x16x32_bf16 v[200:203], a[168:171], v[32:35], v[200:203]
  ds_read_b128 a[100:103], v69 offset:32768
  v_cvt_pk_bf16_f32 v38, v44, v45
  v_mfma_f32_16x16x32_bf16 v[204:207], a[172:175], v[32:35], v[204:207]
  v_exp_f32 v46, v30
  v_mfma_f32_16x16x32_bf16 v[208:211], a[176:179], v[32:35], v[208:211]
  ds_read_b128 a[104:107], v70 offset:32768
  v_mfma_f32_16x16x32_bf16 v[212:215], a[180:183], v[32:35], v[212:215]
  v_exp_f32 v47, v31
  v_mfma_f32_16x16x32_bf16 v[216:219], a[184:187], v[32:35], v[216:219]
  ds_read_b128 a[108:111], v71 offset:32768
  v_cvt_pk_bf16_f32 v39, v46, v47
  v_mfma_f32_16x16x32_bf16 v[220:223], a[188:191], v[32:35], v[220:223]
  v_mfma_f32_16x16x32_bf16 v[24:27], a[64:67], a[16:19], v[56:59]
  v_exp_f32 v40, v16
  v_mfma_f32_16x16x32_bf16 v[24:27], a[68:71], a[20:23], v[24:27]
  ds_read_b128 a[112:115], v68 offset:40960
  v_mfma_f32_16x16x32_bf16 v[24:27], a[72:75], a[24:27], v[24:27]
  v_exp_f32 v41, v17
  v_mfma_f32_16x16x32_bf16 v[24:27], a[76:79], a[28:31], v[24:27]
  ds_read_b128 a[116:119], v69 offset:40960
  v_cvt_pk_bf16_f32 v32, v40, v41
  v_mfma_f32_16x16x32_bf16 v[28:31], a[80:83], a[16:19], v[56:59]
  v_exp_f32 v42, v18
  v_mfma_f32_16x16x32_bf16 v[28:31], a[84:87], a[20:23], v[28:31]
  ds_read_b128 a[120:123], v70 offset:40960
  v_mfma_f32_16x16x32_bf16 v[28:31], a[88:91], a[24:27], v[28:31]
  v_exp_f32 v43, v19
  v_mfma_f32_16x16x32_bf16 v[28:31], a[92:95], a[28:31], v[28:31]
  ds_read_b128 a[124:127], v71 offset:40960
  v_cvt_pk_bf16_f32 v33, v42, v43
  v_mfma_f32_16x16x32_bf16 v[120:123], v[8:11], v[36:39], v[120:123]
  v_exp_f32 v44, v20
  v_mfma_f32_16x16x32_bf16 v[224:227], a[160:163], v[36:39], v[224:227]
  v_mfma_f32_16x16x32_bf16 v[228:231], a[164:167], v[36:39], v[228:231]
  v_exp_f32 v45, v21
  v_mfma_f32_16x16x32_bf16 v[232:235], a[168:171], v[36:39], v[232:235]
  v_cvt_pk_bf16_f32 v34, v44, v45
  v_mfma_f32_16x16x32_bf16 v[236:239], a[172:175], v[36:39], v[236:239]
  v_exp_f32 v46, v22
  v_mfma_f32_16x16x32_bf16 v[240:243], a[176:179], v[36:39], v[240:243]
  v_mfma_f32_16x16x32_bf16 v[244:247], a[180:183], v[36:39], v[244:247]
  s_waitcnt vmcnt(8) lgkmcnt(0)
  v_exp_f32 v47, v23
  v_mfma_f32_16x16x32_bf16 v[248:251], a[184:187], v[36:39], v[248:251]
  v_cvt_pk_bf16_f32 v35, v46, v47
  v_mfma_f32_16x16x32_bf16 v[252:255], a[188:191], v[36:39], v[252:255]
  s_barrier
  v_mfma_f32_16x16x32_bf16 v[16:19], a[64:67], a[32:35], v[60:63]
  v_exp_f32 v40, v24
  v_mfma_f32_16x16x32_bf16 v[16:19], a[68:71], a[36:39], v[16:19]
  ds_read_b64_tr_b16 a[160:161], v72 offset:49152
  v_mfma_f32_16x16x32_bf16 v[16:19], a[72:75], a[40:43], v[16:19]
  s_add_u32 m0, s43, 32768
  v_exp_f32 v41, v25
  v_mfma_f32_16x16x32_bf16 v[16:19], a[76:79], a[44:47], v[16:19]
  ds_read_b64_tr_b16 a[162:163], v72 offset:57344
  v_cvt_pk_bf16_f32 v36, v40, v41
  v_mfma_f32_16x16x32_bf16 v[20:23], a[80:83], a[32:35], v[60:63]
  v_exp_f32 v42, v26
  v_mfma_f32_16x16x32_bf16 v[20:23], a[84:87], a[36:39], v[20:23]
  buffer_load_dwordx4 v80, s[8:11], s41 offen lds
  v_mfma_f32_16x16x32_bf16 v[20:23], a[88:91], a[40:43], v[20:23]
  v_exp_f32 v43, v27
  v_mfma_f32_16x16x32_bf16 v[20:23], a[92:95], a[44:47], v[20:23]
  ds_read_b64_tr_b16 a[164:165], v73 offset:49152
  v_cvt_pk_bf16_f32 v37, v42, v43
  v_mfma_f32_16x16x32_bf16 v[48:51], v[124:127], v[32:35], v[48:51]
  v_exp_f32 v44, v28
  v_mfma_f32_16x16x32_bf16 v[128:131], a[128:131], v[32:35], v[128:131]
  buffer_load_dwordx4 v81, s[8:11], s41 offen offset:1024 lds
  v_mfma_f32_16x16x32_bf16 v[132:135], a[132:135], v[32:35], v[132:135]
  s_add_u32 s41, s41, 8192
  v_exp_f32 v45, v29
  v_mfma_f32_16x16x32_bf16 v[136:139], a[136:139], v[32:35], v[136:139]
  ds_read_b64_tr_b16 a[166:167], v73 offset:57344
  v_cvt_pk_bf16_f32 v38, v44, v45
  v_mfma_f32_16x16x32_bf16 v[140:143], a[140:143], v[32:35], v[140:143]
  v_exp_f32 v46, v30
  v_mfma_f32_16x16x32_bf16 v[144:147], a[144:147], v[32:35], v[144:147]
  ds_read_b64_tr_b16 a[168:169], v74 offset:49152
  v_mfma_f32_16x16x32_bf16 v[148:151], a[148:151], v[32:35], v[148:151]
  v_exp_f32 v47, v31
  v_mfma_f32_16x16x32_bf16 v[152:155], a[152:155], v[32:35], v[152:155]
  ds_read_b64_tr_b16 a[170:171], v74 offset:57344
  v_cvt_pk_bf16_f32 v39, v46, v47
  v_mfma_f32_16x16x32_bf16 v[156:159], a[156:159], v[32:35], v[156:159]
  v_mfma_f32_16x16x32_bf16 v[24:27], a[64:67], a[48:51], v[64:67]
  s_add_u32 m0, s43, 34816
  v_exp_f32 v40, v16
  v_mfma_f32_16x16x32_bf16 v[24:27], a[68:71], a[52:55], v[24:27]
  buffer_load_dwordx4 v82, s[12:15], s42 offen lds
  v_mfma_f32_16x16x32_bf16 v[24:27], a[72:75], a[56:59], v[24:27]
  v_exp_f32 v41, v17
  v_mfma_f32_16x16x32_bf16 v[24:27], a[76:79], a[60:63], v[24:27]
  ds_read_b64_tr_b16 a[172:173], v75 offset:49152
  v_cvt_pk_bf16_f32 v32, v40, v41
  v_mfma_f32_16x16x32_bf16 v[28:31], a[80:83], a[48:51], v[64:67]
  v_exp_f32 v42, v18
  v_mfma_f32_16x16x32_bf16 v[28:31], a[84:87], a[52:55], v[28:31]
  buffer_load_dwordx4 v83, s[12:15], s42 offen offset:1024 lds
  v_mfma_f32_16x16x32_bf16 v[28:31], a[88:91], a[56:59], v[28:31]
  s_add_u32 s42, s42, 8192
  v_exp_f32 v43, v19
  v_mfma_f32_16x16x32_bf16 v[28:31], a[92:95], a[60:63], v[28:31]
  ds_read_b64_tr_b16 a[174:175], v75 offset:57344
  v_cvt_pk_bf16_f32 v33, v42, v43
  v_mfma_f32_16x16x32_bf16 v[48:51], v[8:11], v[36:39], v[48:51]
  v_exp_f32 v44, v20
  v_mfma_f32_16x16x32_bf16 v[160:163], a[128:131], v[36:39], v[160:163]
  ds_read_b64_tr_b16 a[176:177], v76 offset:49152
  v_mfma_f32_16x16x32_bf16 v[164:167], a[132:135], v[36:39], v[164:167]
  v_exp_f32 v45, v21
  v_mfma_f32_16x16x32_bf16 v[168:171], a[136:139], v[36:39], v[168:171]
  ds_read_b64_tr_b16 a[178:179], v76 offset:57344
  v_cvt_pk_bf16_f32 v34, v44, v45
  v_mfma_f32_16x16x32_bf16 v[172:175], a[140:143], v[36:39], v[172:175]
  v_exp_f32 v46, v22
  v_mfma_f32_16x16x32_bf16 v[176:179], a[144:147], v[36:39], v[176:179]
  ds_read_b64_tr_b16 a[180:181], v77 offset:49152
  v_mfma_f32_16x16x32_bf16 v[180:183], a[148:151], v[36:39], v[180:183]
  v_exp_f32 v47, v23
  v_mfma_f32_16x16x32_bf16 v[184:187], a[152:155], v[36:39], v[184:187]
  ds_read_b64_tr_b16 a[182:183], v77 offset:57344
  v_cvt_pk_bf16_f32 v35, v46, v47
  v_mfma_f32_16x16x32_bf16 v[188:191], a[156:159], v[36:39], v[188:191]
  v_mfma_f32_16x16x32_bf16 v[16:19], a[96:99], a[0:3], v[52:55]
  v_exp_f32 v40, v24
  v_mfma_f32_16x16x32_bf16 v[16:19], a[100:103], a[4:7], v[16:19]
  ds_read_b64_tr_b16 a[184:185], v78 offset:49152
  v_mfma_f32_16x16x32_bf16 v[16:19], a[104:107], a[8:11], v[16:19]
  v_exp_f32 v41, v25
  v_mfma_f32_16x16x32_bf16 v[16:19], a[108:111], a[12:15], v[16:19]
  ds_read_b64_tr_b16 a[186:187], v78 offset:57344
  v_cvt_pk_bf16_f32 v36, v40, v41
  v_mfma_f32_16x16x32_bf16 v[20:23], a[112:115], a[0:3], v[52:55]
  v_exp_f32 v42, v26
  v_mfma_f32_16x16x32_bf16 v[20:23], a[116:119], a[4:7], v[20:23]
  ds_read_b64_tr_b16 a[188:189], v79 offset:49152
  v_mfma_f32_16x16x32_bf16 v[20:23], a[120:123], a[8:11], v[20:23]
  v_exp_f32 v43, v27
  v_mfma_f32_16x16x32_bf16 v[20:23], a[124:127], a[12:15], v[20:23]
  ds_read_b64_tr_b16 a[190:191], v79 offset:57344
  v_cvt_pk_bf16_f32 v37, v42, v43
  v_mfma_f32_16x16x32_bf16 v[120:123], v[124:127], v[32:35], v[120:123]
  v_exp_f32 v44, v28
  v_mfma_f32_16x16x32_bf16 v[192:195], a[128:131], v[32:35], v[192:195]
  ds_read_b128 a[64:67], v68 offset:49152
  v_mfma_f32_16x16x32_bf16 v[196:199], a[132:135], v[32:35], v[196:199]
  v_exp_f32 v45, v29
  v_mfma_f32_16x16x32_bf16 v[200:203], a[136:139], v[32:35], v[200:203]
  ds_read_b128 a[68:71], v69 offset:49152
  v_cvt_pk_bf16_f32 v38, v44, v45
  v_mfma_f32_16x16x32_bf16 v[204:207], a[140:143], v[32:35], v[204:207]
  v_exp_f32 v46, v30
  v_mfma_f32_16x16x32_bf16 v[208:211], a[144:147], v[32:35], v[208:211]
  ds_read_b128 a[72:75], v70 offset:49152
  v_mfma_f32_16x16x32_bf16 v[212:215], a[148:151], v[32:35], v[212:215]
  v_exp_f32 v47, v31
  v_mfma_f32_16x16x32_bf16 v[216:219], a[152:155], v[32:35], v[216:219]
  ds_read_b128 a[76:79], v71 offset:49152
  v_cvt_pk_bf16_f32 v39, v46, v47
  v_mfma_f32_16x16x32_bf16 v[220:223], a[156:159], v[32:35], v[220:223]
  v_mfma_f32_16x16x32_bf16 v[24:27], a[96:99], a[16:19], v[56:59]
  v_exp_f32 v40, v16
  v_mfma_f32_16x16x32_bf16 v[24:27], a[100:103], a[20:23], v[24:27]
  ds_read_b128 a[80:83], v68 offset:57344
  v_mfma_f32_16x16x32_bf16 v[24:27], a[104:107], a[24:27], v[24:27]
  v_exp_f32 v41, v17
  v_mfma_f32_16x16x32_bf16 v[24:27], a[108:111], a[28:31], v[24:27]
  ds_read_b128 a[84:87], v69 offset:57344
  v_cvt_pk_bf16_f32 v32, v40, v41
  v_mfma_f32_16x16x32_bf16 v[28:31], a[112:115], a[16:19], v[56:59]
  v_exp_f32 v42, v18
  v_mfma_f32_16x16x32_bf16 v[28:31], a[116:119], a[20:23], v[28:31]
  ds_read_b128 a[88:91], v70 offset:57344
  v_mfma_f32_16x16x32_bf16 v[28:31], a[120:123], a[24:27], v[28:31]
  v_exp_f32 v43, v19
  v_mfma_f32_16x16x32_bf16 v[28:31], a[124:127], a[28:31], v[28:31]
  ds_read_b128 a[92:95], v71 offset:57344
  v_cvt_pk_bf16_f32 v33, v42, v43
  v_mfma_f32_16x16x32_bf16 v[120:123], v[8:11], v[36:39], v[120:123]
  v_exp_f32 v44, v20
  v_mfma_f32_16x16x32_bf16 v[224:227], a[128:131], v[36:39], v[224:227]
  v_mfma_f32_16x16x32_bf16 v[228:231], a[132:135], v[36:39], v[228:231]
  v_exp_f32 v45, v21
  v_mfma_f32_16x16x32_bf16 v[232:235], a[136:139], v[36:39], v[232:235]
  v_cvt_pk_bf16_f32 v34, v44, v45
  v_mfma_f32_16x16x32_bf16 v[236:239], a[140:143], v[36:39], v[236:239]
  v_exp_f32 v46, v22
  v_mfma_f32_16x16x32_bf16 v[240:243], a[144:147], v[36:39], v[240:243]
  v_mfma_f32_16x16x32_bf16 v[244:247], a[148:151], v[36:39], v[244:247]
  s_waitcnt vmcnt(8) lgkmcnt(0)
  v_exp_f32 v47, v23
  v_mfma_f32_16x16x32_bf16 v[248:251], a[152:155], v[36:39], v[248:251]
  v_cvt_pk_bf16_f32 v35, v46, v47
  v_mfma_f32_16x16x32_bf16 v[252:255], a[156:159], v[36:39], v[252:255]
  s_barrier
  v_mfma_f32_16x16x32_bf16 v[16:19], a[96:99], a[32:35], v[60:63]
  v_exp_f32 v40, v24
  v_mfma_f32_16x16x32_bf16 v[16:19], a[100:103], a[36:39], v[16:19]
  ds_read_b64_tr_b16 a[128:129], v72 offset:0
  v_mfma_f32_16x16x32_bf16 v[16:19], a[104:107], a[40:43], v[16:19]
  s_add_u32 m0, s43, 49152
  v_exp_f32 v41, v25
  v_mfma_f32_16x16x32_bf16 v[16:19], a[108:111], a[44:47], v[16:19]
  ds_read_b64_tr_b16 a[130:131], v72 offset:8192
  v_cvt_pk_bf16_f32 v36, v40, v41
  v_mfma_f32_16x16x32_bf16 v[20:23], a[112:115], a[32:35], v[60:63]
  v_exp_f32 v42, v26
  v_mfma_f32_16x16x32_bf16 v[20:23], a[116:119], a[36:39], v[20:23]
  buffer_load_dwordx4 v80, s[8:11], s41 offen lds
  v_mfma_f32_16x16x32_bf16 v[20:23], a[120:123], a[40:43], v[20:23]
  v_exp_f32 v43, v27
  v_mfma_f32_16x16x32_bf16 v[20:23], a[124:127], a[44:47], v[20:23]
  ds_read_b64_tr_b16 a[132:133], v73 offset:0
  v_cvt_pk_bf16_f32 v37, v42, v43
  v_mfma_f32_16x16x32_bf16 v[48:51], v[124:127], v[32:35], v[48:51]
  v_exp_f32 v44, v28
  v_mfma_f32_16x16x32_bf16 v[128:131], a[160:163], v[32:35], v[128:131]
  buffer_load_dwordx4 v81, s[8:11], s41 offen offset:1024 lds
  v_mfma_f32_16x16x32_bf16 v[132:135], a[164:167], v[32:35], v[132:135]
  s_add_u32 s41, s41, 8192
  v_exp_f32 v45, v29
  v_mfma_f32_16x16x32_bf16 v[136:139], a[168:171], v[32:35], v[136:139]
  ds_read_b64_tr_b16 a[134:135], v73 offset:8192
  v_cvt_pk_bf16_f32 v38, v44, v45
  v_mfma_f32_16x16x32_bf16 v[140:143], a[172:175], v[32:35], v[140:143]
  v_exp_f32 v46, v30
  v_mfma_f32_16x16x32_bf16 v[144:147], a[176:179], v[32:35], v[144:147]
  ds_read_b64_tr_b16 a[136:137], v74 offset:0
  v_mfma_f32_16x16x32_bf16 v[148:151], a[180:183], v[32:35], v[148:151]
  v_exp_f32 v47, v31
  v_mfma_f32_16x16x32_bf16 v[152:155], a[184:187], v[32:35], v[152:155]
  ds_read_b64_tr_b16 a[138:139], v74 offset:8192
  v_cvt_pk_bf16_f32 v39, v46, v47
  v_mfma_f32_16x16x32_bf16 v[156:159], a[188:191], v[32:35], v[156:159]
  v_mfma_f32_16x16x32_bf16 v[24:27], a[96:99], a[48:51], v[64:67]
  s_add_u32 m0, s43, 51200
  v_exp_f32 v40, v16
  v_mfma_f32_16x16x32_bf16 v[24:27], a[100:103], a[52:55], v[24:27]
  buffer_load_dwordx4 v82, s[12:15], s42 offen lds
  v_mfma_f32_16x16x32_bf16 v[24:27], a[104:107], a[56:59], v[24:27]
  v_exp_f32 v41, v17
  v_mfma_f32_16x16x32_bf16 v[24:27], a[108:111], a[60:63], v[24:27]
  ds_read_b64_tr_b16 a[140:141], v75 offset:0
  v_cvt_pk_bf16_f32 v32, v40, v41
  v_mfma_f32_16x16x32_bf16 v[28:31], a[112:115], a[48:51], v[64:67]
  v_exp_f32 v42, v18
  v_mfma_f32_16x16x32_bf16 v[28:31], a[116:119], a[52:55], v[28:31]
  buffer_load_dwordx4 v83, s[12:15], s42 offen offset:1024 lds
  v_mfma_f32_16x16x32_bf16 v[28:31], a[120:123], a[56:59], v[28:31]
  s_add_u32 s42, s42, 8192
  v_exp_f32 v43, v19
  v_mfma_f32_16x16x32_bf16 v[28:31], a[124:127], a[60:63], v[28:31]
  ds_read_b64_tr_b16 a[142:143], v75 offset:8192
  v_cvt_pk_bf16_f32 v33, v42, v43
  v_mfma_f32_16x16x32_bf16 v[48:51], v[8:11], v[36:39], v[48:51]
  v_exp_f32 v44, v20
  v_mfma_f32_16x16x32_bf16 v[160:163], a[160:163], v[36:39], v[160:163]
  ds_read_b64_tr_b16 a[144:145], v76 offset:0
  v_mfma_f32_16x16x32_bf16 v[164:167], a[164:167], v[36:39], v[164:167]
  v_exp_f32 v45, v21
  v_mfma_f32_16x16x32_bf16 v[168:171], a[168:171], v[36:39], v[168:171]
  ds_read_b64_tr_b16 a[146:147], v76 offset:8192
  v_cvt_pk_bf16_f32 v34, v44, v45
  v_mfma_f32_16x16x32_bf16 v[172:175], a[172:175], v[36:39], v[172:175]
  v_exp_f32 v46, v22
  v_mfma_f32_16x16x32_bf16 v[176:179], a[176:179], v[36:39], v[176:179]
  ds_read_b64_tr_b16 a[148:149], v77 offset:0
  v_mfma_f32_16x16x32_bf16 v[180:183], a[180:183], v[36:39], v[180:183]
  v_exp_f32 v47, v23
  v_mfma_f32_16x16x32_bf16 v[184:187], a[184:187], v[36:39], v[184:187]
  ds_read_b64_tr_b16 a[150:151], v77 offset:8192
  v_cvt_pk_bf16_f32 v35, v46, v47
  v_mfma_f32_16x16x32_bf16 v[188:191], a[188:191], v[36:39], v[188:191]
  v_mfma_f32_16x16x32_bf16 v[16:19], a[64:67], a[0:3], v[52:55]
  v_exp_f32 v40, v24
  v_mfma_f32_16x16x32_bf16 v[16:19], a[68:71], a[4:7], v[16:19]
  ds_read_b64_tr_b16 a[152:153], v78 offset:0
  v_mfma_f32_16x16x32_bf16 v[16:19], a[72:75], a[8:11], v[16:19]
  v_exp_f32 v41, v25
  v_mfma_f32_16x16x32_bf16 v[16:19], a[76:79], a[12:15], v[16:19]
  ds_read_b64_tr_b16 a[154:155], v78 offset:8192
  v_cvt_pk_bf16_f32 v36, v40, v41
  v_mfma_f32_16x16x32_bf16 v[20:23], a[80:83], a[0:3], v[52:55]
  v_exp_f32 v42, v26
  v_mfma_f32_16x16x32_bf16 v[20:23], a[84:87], a[4:7], v[20:23]
  ds_read_b64_tr_b16 a[156:157], v79 offset:0
  v_mfma_f32_16x16x32_bf16 v[20:23], a[88:91], a[8:11], v[20:23]
  v_exp_f32 v43, v27
  v_mfma_f32_16x16x32_bf16 v[20:23], a[92:95], a[12:15], v[20:23]
  ds_read_b64_tr_b16 a[158:159], v79 offset:8192
  v_cvt_pk_bf16_f32 v37, v42, v43
  v_mfma_f32_16x16x32_bf16 v[120:123], v[124:127], v[32:35], v[120:123]
  v_exp_f32 v44, v28
  v_mfma_f32_16x16x32_bf16 v[192:195], a[160:163], v[32:35], v[192:195]
  ds_read_b128 a[96:99], v68 offset:0
  v_mfma_f32_16x16x32_bf16 v[196:199], a[164:167], v[32:35], v[196:199]
  v_exp_f32 v45, v29
  v_mfma_f32_16x16x32_bf16 v[200:203], a[168:171], v[32:35], v[200:203]
  ds_read_b128 a[100:103], v69 offset:0
  v_cvt_pk_bf16_f32 v38, v44, v45
  v_mfma_f32_16x16x32_bf16 v[204:207], a[172:175], v[32:35], v[204:207]
  s_sub_u32 s44, s44, 1
  v_exp_f32 v46, v30
  v_mfma_f32_16x16x32_bf16 v[208:211], a[176:179], v[32:35], v[208:211]
  ds_read_b128 a[104:107], v70 offset:0
  v_mfma_f32_16x16x32_bf16 v[212:215], a[180:183], v[32:35], v[212:215]
  s_cmp_lg_u32 s44, 0
  v_exp_f32 v47, v31
  v_mfma_f32_16x16x32_bf16 v[216:219], a[184:187], v[32:35], v[216:219]
  ds_read_b128 a[108:111], v71 offset:0
  v_cvt_pk_bf16_f32 v39, v46, v47
  v_mfma_f32_16x16x32_bf16 v[220:223], a[188:191], v[32:35], v[220:223]
  s_cbranch_scc1 L_B
L_bdone:
  s_cmp_lg_u32 s87, 0
  s_cbranch_scc1 L_drain
.p2align 3
  v_mfma_f32_16x16x32_bf16 v[24:27], a[64:67], a[16:19], v[56:59]
  v_exp_f32 v40, v16
  v_mfma_f32_16x16x32_bf16 v[24:27], a[68:71], a[20:23], v[24:27]
  ds_read_b128 a[112:115], v68 offset:8192
  v_mfma_f32_16x16x32_bf16 v[24:27], a[72:75], a[24:27], v[24:27]
  v_exp_f32 v41, v17
  v_mfma_f32_16x16x32_bf16 v[24:27], a[76:79], a[28:31], v[24:27]
  ds_read_b128 a[116:119], v69 offset:8192
  v_cvt_pk_bf16_f32 v32, v40, v41
  v_mfma_f32_16x16x32_bf16 v[28:31], a[80:83], a[16:19], v[56:59]
  v_exp_f32 v42, v18
  v_mfma_f32_16x16x32_bf16 v[28:31], a[84:87], a[20:23], v[28:31]
  ds_read_b128 a[120:123], v70 offset:8192
  v_mfma_f32_16x16x32_bf16 v[28:31], a[88:91], a[24:27], v[28:31]
  v_exp_f32 v43, v19
  v_mfma_f32_16x16x32_bf16 v[28:31], a[92:95], a[28:31], v[28:31]
  ds_read_b128 a[124:127], v71 offset:8192
  v_cvt_pk_bf16_f32 v33, v42, v43
  v_mfma_f32_16x16x32_bf16 v[120:123], v[8:11], v[36:39], v[120:123]
  v_exp_f32 v44, v20
  v_mfma_f32_16x16x32_bf16 v[224:227], a[160:163], v[36:39], v[224:227]
  v_mfma_f32_16x16x32_bf16 v[228:231], a[164:167], v[36:39], v[228:231]
  v_exp_f32 v45, v21
  v_mfma_f32_16x16x32_bf16 v[232:235], a[168:171], v[36:39], v[232:235]
  v_cvt_pk_bf16_f32 v34, v44, v45
  v_mfma_f32_16x16x32_bf16 v[236:239], a[172:175], v[36:39], v[236:239]
  v_exp_f32 v46, v22
  v_mfma_f32_16x16x32_bf16 v[240:243], a[176:179], v[36:39], v[240:243]
  v_mfma_f32_16x16x32_bf16 v[244:247], a[180:183], v[36:39], v[244:247]
  s_waitcnt vmcnt(8) lgkmcnt(0)
  v_exp_f32 v47, v23
  v_mfma_f32_16x16x32_bf16 v[248:251], a[184:187], v[36:39], v[248:251]
  v_cvt_pk_bf16_f32 v35, v46, v47
  v_mfma_f32_16x16x32_bf16 v[252:255], a[188:191], v[36:39], v[252:255]
  s_barrier
  v_mfma_f32_16x16x32_bf16 v[16:19], a[64:67], a[32:35], v[60:63]
  v_exp_f32 v40, v24
  v_mfma_f32_16x16x32_bf16 v[16:19], a[68:71], a[36:39], v[16:19]
  ds_read_b64_tr_b16 a[160:161], v72 offset:16384
  v_mfma_f32_16x16x32_bf16 v[16:19], a[72:75], a[40:43], v[16:19]
  v_exp_f32 v41, v25
  v_mfma_f32_16x16x32_bf16 v[16:19], a[76:79], a[44:47], v[16:19]
  ds_read_b64_tr_b16 a[162:163], v72 offset:24576
  v_cvt_pk_bf16_f32 v36, v40, v41
  v_mfma_f32_16x16x32_bf16 v[20:23], a[80:83], a[32:35], v[60:63]
  v_exp_f32 v42, v26
  v_mfma_f32_16x16x32_bf16 v[20:23], a[84:87], a[36:39], v[20:23]
  v_mfma_f32_16x16x32_bf16 v[20:23], a[88:91], a[40:43], v[20:23]
  v_exp_f32 v43, v27
  v_mfma_f32_16x16x32_bf16 v[20:23], a[92:95], a[44:47], v[20:23]
  ds_read_b64_tr_b16 a[164:165], v73 offset:16384
  v_cvt_pk_bf16_f32 v37, v42, v43
  v_mfma_f32_16x16x32_bf16 v[48:51], v[124:127], v[32:35], v[48:51]
  v_exp_f32 v44, v28
  v_mfma_f32_16x16x32_bf16 v[128:131], a[128:131], v[32:35], v[128:131]
  v_mfma_f32_16x16x32_bf16 v[132:135], a[132:135], v[32:35], v[132:135]
  v_exp_f32 v45, v29
  v_mfma_f32_16x16x32_bf16 v[136:139], a[136:139], v[32:35], v[136:139]
  ds_read_b64_tr_b16 a[166:167], v73 offset:24576
  v_cvt_pk_bf16_f32 v38, v44, v45
  v_mfma_f32_16x16x32_bf16 v[140:143], a[140:143], v[32:35], v[140:143]
  v_exp_f32 v46, v30
  v_mfma_f32_16x16x32_bf16 v[144:147], a[144:147], v[32:35], v[144:147]
  ds_read_b64_tr_b16 a[168:169], v74 offset:16384
  v_mfma_f32_16x16x32_bf16 v[148:151], a[148:151], v[32:35], v[148:151]
  v_exp_f32 v47, v31
  v_mfma_f32_16x16x32_bf16 v[152:155], a[152:155], v[32:35], v[152:155]
  ds_read_b64_tr_b16 a[170:171], v74 offset:24576
  v_cvt_pk_bf16_f32 v39, v46, v47
  v_mfma_f32_16x16x32_bf16 v[156:159], a[156:159], v[32:35], v[156:159]
  v_mfma_f32_16x16x32_bf16 v[24:27], a[64:67], a[48:51], v[64:67]
  v_exp_f32 v40, v16
  v_mfma_f32_16x16x32_bf16 v[24:27], a[68:71], a[52:55], v[24:27]
  v_mfma_f32_16x16x32_bf16 v[24:27], a[72:75], a[56:59], v[24:27]
  v_exp_f32 v41, v17
  v_mfma_f32_16x16x32_bf16 v[24:27], a[76:79], a[60:63], v[24:27]
  ds_read_b64_tr_b16 a[172:173], v75 offset:16384
  v_cvt_pk_bf16_f32 v32, v40, v41
  v_mfma_f32_16x16x32_bf16 v[28:31], a[80:83], a[48:51], v[64:67]
  v_exp_f32 v42, v18
  v_mfma_f32_16x16x32_bf16 v[28:31], a[84:87], a[52:55], v[28:31]
  v_mfma_f32_16x16x32_bf16 v[28:31], a[88:91], a[56:59], v[28:31]
  v_exp_f32 v43, v19
  v_mfma_f32_16x16x32_bf16 v[28:31], a[92:95], a[60:63], v[28:31]
  ds_read_b64_tr_b16 a[174:175], v75 offset:24576
  v_cvt_pk_bf16_f32 v33, v42, v43
  v_mfma_f32_16x16x32_bf16 v[48:51], v[8:11], v[36:39], v[48:51]
  v_exp_f32 v44, v20
  v_mfma_f32_16x16x32_bf16 v[160:163], a[128:131], v[36:39], v[160:163]
  ds_read_b64_tr_b16 a[176:177], v76 offset:16384
  v_mfma_f32_16x16x32_bf16 v[164:167], a[132:135], v[36:39], v[164:167]
  v_exp_f32 v45, v21
  v_mfma_f32_16x16x32_bf16 v[168:171], a[136:139], v[36:39], v[168:171]
  ds_read_b64_tr_b16 a[178:179], v76 offset:24576
  v_cvt_pk_bf16_f32 v34, v44, v45
  v_mfma_f32_16x16x32_bf16 v[172:175], a[140:143], v[36:39], v[172:175]
  v_exp_f32 v46, v22
  v_mfma_f32_16x16x32_bf16 v[176:179], a[144:147], v[36:39], v[176:179]
  ds_read_b64_tr_b16 a[180:181], v77 offset:16384
  v_mfma_f32_16x16x32_bf16 v[180:183], a[148:151], v[36:39], v[180:183]
  v_exp_f32 v47, v23
  v_mfma_f32_16x16x32_bf16 v[184:187], a[152:155], v[36:39], v[184:187]
  ds_read_b64_tr_b16 a[182:183], v77 offset:24576
  v_cvt_pk_bf16_f32 v35, v46, v47
  v_mfma_f32_16x16x32_bf16 v[188:191], a[156:159], v[36:39], v[188:191]
  v_mfma_f32_16x16x32_bf16 v[16:19], a[96:99], a[0:3], v[52:55]
  v_exp_f32 v40, v24
  v_mfma_f32_16x16x32_bf16 v[16:19], a[100:103], a[4:7], v[16:19]
  ds_read_b128 a[64:67], v68 offset:16384
  ds_read_b128 a[68:71], v69 offset:16384
  v_mfma_f32_16x16x32_bf16 v[16:19], a[104:107], a[8:11], v[16:19]
  ds_read_b128 a[72:75], v70 offset:16384
  v_exp_f32 v41, v25
  v_mfma_f32_16x16x32_bf16 v[16:19], a[108:111], a[12:15], v[16:19]
  ds_read_b128 a[76:79], v71 offset:16384
  v_cvt_pk_bf16_f32 v36, v40, v41
  v_mfma_f32_16x16x32_bf16 v[20:23], a[112:115], a[0:3], v[52:55]
  v_exp_f32 v42, v26
  v_mfma_f32_16x16x32_bf16 v[20:23], a[116:119], a[4:7], v[20:23]
  ds_read_b128 a[80:83], v68 offset:24576
  ds_read_b128 a[84:87], v69 offset:24576
  v_mfma_f32_16x16x32_bf16 v[20:23], a[120:123], a[8:11], v[20:23]
  v_exp_f32 v43, v27
  v_mfma_f32_16x16x32_bf16 v[20:23], a[124:127], a[12:15], v[20:23]
  ds_read_b128 a[88:91], v70 offset:24576
  v_cvt_pk_bf16_f32 v37, v42, v43
  v_mfma_f32_16x16x32_bf16 v[120:123], v[124:127], v[32:35], v[120:123]
  v_exp_f32 v44, v28
  v_mfma_f32_16x16x32_bf16 v[192:195], a[128:131], v[32:35], v[192:195]
  ds_read_b128 a[92:95], v71 offset:24576
  ds_read_b64_tr_b16 a[184:185], v78 offset:16384
  v_mfma_f32_16x16x32_bf16 v[196:199], a[132:135], v[32:35], v[196:199]
  v_exp_f32 v45, v29
  v_mfma_f32_16x16x32_bf16 v[200:203], a[136:139], v[32:35], v[200:203]
  ds_read_b64_tr_b16 a[186:187], v78 offset:24576
  v_cvt_pk_bf16_f32 v38, v44, v45
  v_mfma_f32_16x16x32_bf16 v[204:207], a[140:143], v[32:35], v[204:207]
  v_exp_f32 v46, v30
  v_mfma_f32_16x16x32_bf16 v[208:211], a[144:147], v[32:35], v[208:211]
  ds_read_b64_tr_b16 a[188:189], v79 offset:16384
  ds_read_b64_tr_b16 a[190:191], v79 offset:24576
  v_mfma_f32_16x16x32_bf16 v[212:215], a[148:151], v[32:35], v[212:215]
  s_waitcnt vmcnt(4) lgkmcnt(0)
  v_exp_f32 v47, v31
  v_mfma_f32_16x16x32_bf16 v[216:219], a[152:155], v[32:35], v[216:219]
  v_cvt_pk_bf16_f32 v39, v46, v47
  v_mfma_f32_16x16x32_bf16 v[220:223], a[156:159], v[32:35], v[220:223]
  s_barrier
  v_mfma_f32_16x16x32_bf16 v[24:27], a[64:67], a[0:3], v[52:55]
  v_exp_f32 v40, v16
  v_mfma_f32_16x16x32_bf16 v[24:27], a[68:71], a[4:7], v[24:27]
  ds_read_b128 a[192:195], v68 offset:32768
  ds_read_b128 a[196:199], v69 offset:32768
  v_mfma_f32_16x16x32_bf16 v[24:27], a[72:75], a[8:11], v[24:27]
  v_exp_f32 v41, v17
  v_mfma_f32_16x16x32_bf16 v[24:27], a[76:79], a[12:15], v[24:27]
  ds_read_b128 a[200:203], v70 offset:32768
  v_cvt_pk_bf16_f32 v32, v40, v41
  v_mfma_f32_16x16x32_bf16 v[28:31], a[80:83], a[0:3], v[52:55]
  v_exp_f32 v42, v18
  v_mfma_f32_16x16x32_bf16 v[28:31], a[84:87], a[4:7], v[28:31]
  ds_read_b128 a[204:207], v71 offset:32768
  ds_read_b128 a[208:211], v68 offset:40960
  v_mfma_f32_16x16x32_bf16 v[28:31], a[88:91], a[8:11], v[28:31]
  v_exp_f32 v43, v19
  v_mfma_f32_16x16x32_bf16 v[28:31], a[92:95], a[12:15], v[28:31]
  ds_read_b128 a[212:215], v69 offset:40960
  v_cvt_pk_bf16_f32 v33, v42, v43
  v_mfma_f32_16x16x32_bf16 v[120:123], v[8:11], v[36:39], v[120:123]
  v_exp_f32 v44, v20
  v_mfma_f32_16x16x32_bf16 v[224:227], a[128:131], v[36:39], v[224:227]
  ds_read_b128 a[216:219], v70 offset:40960
  ds_read_b128 a[220:223], v71 offset:40960
  v_mfma_f32_16x16x32_bf16 v[228:231], a[132:135], v[36:39], v[228:231]
  v_exp_f32 v45, v21
  v_mfma_f32_16x16x32_bf16 v[232:235], a[136:139], v[36:39], v[232:235]
  ds_read_b64_tr_b16 a[224:225], v72 offset:32768
  v_cvt_pk_bf16_f32 v34, v44, v45
  v_mfma_f32_16x16x32_bf16 v[236:239], a[140:143], v[36:39], v[236:239]
  v_exp_f32 v46, v22
  v_mfma_f32_16x16x32_bf16 v[240:243], a[144:147], v[36:39], v[240:243]
  ds_read_b64_tr_b16 a[226:227], v72 offset:40960
  ds_read_b64_tr_b16 a[228:229], v73 offset:32768
  v_mfma_f32_16x16x32_bf16 v[244:247], a[148:151], v[36:39], v[244:247]
  s_waitcnt lgkmcnt(3)
  v_exp_f32 v47, v23
  v_mfma_f32_16x16x32_bf16 v[248:251], a[152:155], v[36:39], v[248:251]
  ds_read_b64_tr_b16 a[230:231], v73 offset:40960
  v_cvt_pk_bf16_f32 v35, v46, v47
  v_mfma_f32_16x16x32_bf16 v[252:255], a[156:159], v[36:39], v[252:255]
  ds_read_b64_tr_b16 a[232:233], v74 offset:32768
  ds_read_b64_tr_b16 a[234:235], v74 offset:40960
  v_mfma_f32_16x16x32_bf16 v[16:19], a[192:195], a[0:3], v[52:55]
  v_exp_f32 v40, v24
  v_mfma_f32_16x16x32_bf16 v[16:19], a[196:199], a[4:7], v[16:19]
  ds_read_b64_tr_b16 a[236:237], v75 offset:32768
  ds_read_b64_tr_b16 a[238:239], v75 offset:40960
  v_mfma_f32_16x16x32_bf16 v[16:19], a[200:203], a[8:11], v[16:19]
  v_exp_f32 v41, v25
  v_mfma_f32_16x16x32_bf16 v[16:19], a[204:207], a[12:15], v[16:19]
  ds_read_b64_tr_b16 a[240:241], v76 offset:32768
  v_cvt_pk_bf16_f32 v36, v40, v41
  v_mfma_f32_16x16x32_bf16 v[20:23], a[208:211], a[0:3], v[52:55]
  v_exp_f32 v42, v26
  v_mfma_f32_16x16x32_bf16 v[20:23], a[212:215], a[4:7], v[20:23]
  ds_read_b64_tr_b16 a[242:243], v76 offset:40960
  ds_read_b64_tr_b16 a[244:245], v77 offset:32768
  v_mfma_f32_16x16x32_bf16 v[20:23], a[216:219], a[8:11], v[20:23]
  v_exp_f32 v43, v27
  v_mfma_f32_16x16x32_bf16 v[20:23], a[220:223], a[12:15], v[20:23]
  ds_read_b64_tr_b16 a[246:247], v77 offset:40960
  v_cvt_pk_bf16_f32 v37, v42, v43
  v_mfma_f32_16x16x32_bf16 v[48:51], v[124:127], v[32:35], v[48:51]
  v_exp_f32 v44, v28
  v_mfma_f32_16x16x32_bf16 v[128:131], a[160:163], v[32:35], v[128:131]
  ds_read_b64_tr_b16 a[248:249], v78 offset:32768
  ds_read_b64_tr_b16 a[250:251], v78 offset:40960
  v_mfma_f32_16x16x32_bf16 v[132:135], a[164:167], v[32:35], v[132:135]
  v_exp_f32 v45, v29
  v_mfma_f32_16x16x32_bf16 v[136:139], a[168:171], v[32:35], v[136:139]
  ds_read_b64_tr_b16 a[252:253], v79 offset:32768
  v_cvt_pk_bf16_f32 v38, v44, v45
  v_mfma_f32_16x16x32_bf16 v[140:143], a[172:175], v[32:35], v[140:143]
  v_exp_f32 v46, v30
  v_mfma_f32_16x16x32_bf16 v[144:147], a[176:179], v[32:35], v[144:147]
  ds_read_b64_tr_b16 a[254:255], v79 offset:40960
  v_mfma_f32_16x16x32_bf16 v[148:151], a[180:183], v[32:35], v[148:151]
  s_waitcnt vmcnt(0) lgkmcnt(0)
  v_exp_f32 v47, v31
  v_mfma_f32_16x16x32_bf16 v[152:155], a[184:187], v[32:35], v[152:155]
  v_cvt_pk_bf16_f32 v39, v46, v47
  v_mfma_f32_16x16x32_bf16 v[156:159], a[188:191], v[32:35], v[156:159]
  s_barrier
  v_mfma_f32_16x16x32_bf16 v[24:27], a[96:99], a[16:19], v[56:59]
  v_exp_f32 v40, v16
  v_mfma_f32_16x16x32_bf16 v[24:27], a[100:103], a[20:23], v[24:27]
  ds_read_b64_tr_b16 a[128:129], v72 offset:49152
  ds_read_b64_tr_b16 a[130:131], v72 offset:57344
  v_mfma_f32_16x16x32_bf16 v[24:27], a[104:107], a[24:27], v[24:27]
  v_exp_f32 v41, v17
  v_mfma_f32_16x16x32_bf16 v[24:27], a[108:111], a[28:31], v[24:27]
  ds_read_b64_tr_b16 a[132:133], v73 offset:49152
  v_cvt_pk_bf16_f32 v32, v40, v41
  v_mfma_f32_16x16x32_bf16 v[28:31], a[112:115], a[16:19], v[56:59]
  v_exp_f32 v42, v18
  v_mfma_f32_16x16x32_bf16 v[28:31], a[116:119], a[20:23], v[28:31]
  ds_read_b64_tr_b16 a[134:135], v73 offset:57344
  ds_read_b64_tr_b16 a[136:137], v74 offset:49152
  v_mfma_f32_16x16x32_bf16 v[28:31], a[120:123], a[24:27], v[28:31]
  v_exp_f32 v43, v19
  v_mfma_f32_16x16x32_bf16 v[28:31], a[124:127], a[28:31], v[28:31]
  ds_read_b64_tr_b16 a[138:139], v74 offset:57344
  v_cvt_pk_bf16_f32 v33, v42, v43
  v_mfma_f32_16x16x32_bf16 v[48:51], v[124:127], v[36:39], v[48:51]
  v_exp_f32 v44, v20
  v_mfma_f32_16x16x32_bf16 v[128:131], a[224:227], v[36:39], v[128:131]
  ds_read_b64_tr_b16 a[140:141], v75 offset:49152
  ds_read_b64_tr_b16 a[142:143], v75 offset:57344
  v_mfma_f32_16x16x32_bf16 v[132:135], a[228:231], v[36:39], v[132:135]
  v_exp_f32 v45, v21
  v_mfma_f32_16x16x32_bf16 v[136:139], a[232:235], v[36:39], v[136:139]
  ds_read_b64_tr_b16 a[144:145], v76 offset:49152
  v_cvt_pk_bf16_f32 v34, v44, v45
  v_mfma_f32_16x16x32_bf16 v[140:143], a[236:239], v[36:39], v[140:143]
  v_exp_f32 v46, v22
  v_mfma_f32_16x16x32_bf16 v[144:147], a[240:243], v[36:39], v[144:147]
  ds_read_b64_tr_b16 a[146:147], v76 offset:57344
  ds_read_b64_tr_b16 a[148:149], v77 offset:49152
  v_mfma_f32_16x16x32_bf16 v[148:151], a[244:247], v[36:39], v[148:151]
  v_exp_f32 v47, v23
  v_mfma_f32_16x16x32_bf16 v[152:155], a[248:251], v[36:39], v[152:155]
  ds_read_b64_tr_b16 a[150:151], v77 offset:57344
  v_cvt_pk_bf16_f32 v35, v46, v47
  v_mfma_f32_16x16x32_bf16 v[156:159], a[252:255], v[36:39], v[156:159]
  ds_read_b64_tr_b16 a[152:153], v78 offset:49152
  ds_read_b64_tr_b16 a[154:155], v78 offset:57344
  v_mfma_f32_16x16x32_bf16 v[16:19], a[64:67], a[16:19], v[56:59]
  v_exp_f32 v40, v24
  v_mfma_f32_16x16x32_bf16 v[16:19], a[68:71], a[20:23], v[16:19]
  ds_read_b64_tr_b16 a[156:157], v79 offset:49152
  ds_read_b64_tr_b16 a[158:159], v79 offset:57344
  v_mfma_f32_16x16x32_bf16 v[16:19], a[72:75], a[24:27], v[16:19]
  v_exp_f32 v41, v25
  v_mfma_f32_16x16x32_bf16 v[16:19], a[76:79], a[28:31], v[16:19]
  v_cvt_pk_bf16_f32 v36, v40, v41
  v_mfma_f32_16x16x32_bf16 v[20:23], a[80:83], a[16:19], v[56:59]
  v_exp_f32 v42, v26
  v_mfma_f32_16x16x32_bf16 v[20:23], a[84:87], a[20:23], v[20:23]
  v_mfma_f32_16x16x32_bf16 v[20:23], a[88:91], a[24:27], v[20:23]
  s_waitcnt lgkmcnt(0)
  v_exp_f32 v43, v27
  v_mfma_f32_16x16x32_bf16 v[20:23], a[92:95], a[28:31], v[20:23]
  v_cvt_pk_bf16_f32 v37, v42, v43
  v_mfma_f32_16x16x32_bf16 v[48:51], v[124:127], v[32:35], v[48:51]
  v_exp_f32 v44, v28
  v_mfma_f32_16x16x32_bf16 v[128:131], a[128:131], v[32:35], v[128:131]
  v_mfma_f32_16x16x32_bf16 v[132:135], a[132:135], v[32:35], v[132:135]
  v_exp_f32 v45, v29
  v_mfma_f32_16x16x32_bf16 v[136:139], a[136:139], v[32:35], v[136:139]
  v_cvt_pk_bf16_f32 v38, v44, v45
  v_mfma_f32_16x16x32_bf16 v[140:143], a[140:143], v[32:35], v[140:143]
  v_exp_f32 v46, v30
  v_mfma_f32_16x16x32_bf16 v[144:147], a[144:147], v[32:35], v[144:147]
  v_mfma_f32_16x16x32_bf16 v[148:151], a[148:151], v[32:35], v[148:151]
  v_exp_f32 v47, v31
  v_mfma_f32_16x16x32_bf16 v[152:155], a[152:155], v[32:35], v[152:155]
  v_cvt_pk_bf16_f32 v39, v46, v47
  v_mfma_f32_16x16x32_bf16 v[156:159], a[156:159], v[32:35], v[156:159]
  s_waitcnt vmcnt(8)
  v_and_b32 v6, 15, v1
  v_lshrrev_b32 v7, 4, v1
  v_and_b32 v12, 12, v6
  v_bfe_u32 v13, v6, 1, 1
  v_or_b32 v12, v12, v13
  v_and_b32 v13, 1, v6
  v_lshl_or_b32 v12, v13, 1, v12
  v_add_u32 v4, 0, v7
  v_xor_b32 v5, v12, v4
  v_lshlrev_b32 v5, 4, v5
  v_lshl_add_u32 v5, v4, 8, v5
  v_add_u32 v100, s64, v5
  v_and_b32 v4, 7, v4
  v_lshlrev_b32 v4, 16, v4
  v_lshl_add_u32 v4, v6, 4, v4
  v_mov_b32 v96, v4
  v_add_u32 v4, 4, v7
  v_xor_b32 v5, v12, v4
  v_lshlrev_b32 v5, 4, v5
  v_lshl_add_u32 v5, v4, 8, v5
  v_add_u32 v101, s64, v5
  v_and_b32 v4, 7, v4
  v_lshlrev_b32 v4, 16, v4
  v_lshl_add_u32 v4, v6, 4, v4
  v_mov_b32 v97, v4
  v_add_u32 v4, 8, v7
  v_xor_b32 v5, v12, v4
  v_lshlrev_b32 v5, 4, v5
  v_lshl_add_u32 v5, v4, 8, v5
  v_add_u32 v102, s64, v5
  v_and_b32 v4, 7, v4
  v_lshlrev_b32 v4, 16, v4
  v_lshl_add_u32 v4, v6, 4, v4
  v_add_u32 v98, 524288, v4
  v_add_u32 v4, 12, v7
  v_xor_b32 v5, v12, v4
  v_lshlrev_b32 v5, 4, v5
  v_lshl_add_u32 v5, v4, 8, v5
  v_add_u32 v103, s64, v5
  v_and_b32 v4, 7, v4
  v_lshlrev_b32 v4, 16, v4
  v_lshl_add_u32 v4, v6, 4, v4
  v_add_u32 v99, 524288, v4
  s_mov_b32 s61, 0x5f800000
  v_cmp_nlt_f32 s[48:49], v48, s61
  v_rcp_f32 v2, v48
  s_add_u32 s60, s45, 0
  s_cmp_lg_u64 s[48:49], 0
  s_cbranch_scc1 L_fix
  v_mov_b32 v3, v2
  v_pk_mul_f32 v[128:129], v[128:129], v[2:3]
  v_pk_mul_f32 v[130:131], v[130:131], v[2:3]
  v_pk_mul_f32 v[132:133], v[132:133], v[2:3]
  v_pk_mul_f32 v[134:135], v[134:135], v[2:3]
  v_cvt_pk_bf16_f32 v104, v128, v129
  v_cvt_pk_bf16_f32 v105, v130, v131
  v_cvt_pk_bf16_f32 v106, v132, v133
  v_cvt_pk_bf16_f32 v107, v134, v135
  v_pk_mul_f32 v[136:137], v[136:137], v[2:3]
  v_pk_mul_f32 v[138:139], v[138:139], v[2:3]
  v_pk_mul_f32 v[140:141], v[140:141], v[2:3]
  v_pk_mul_f32 v[142:143], v[142:143], v[2:3]
  v_cvt_pk_bf16_f32 v108, v136, v137
  v_cvt_pk_bf16_f32 v109, v138, v139
  v_cvt_pk_bf16_f32 v110, v140, v141
  v_cvt_pk_bf16_f32 v111, v142, v143
  v_permlane16_swap_b32 v104, v106
  v_permlane16_swap_b32 v105, v107
  ds_write_b128 v84, v[104:107] offset:0
  v_pk_mul_f32 v[144:145], v[144:145], v[2:3]
  v_pk_mul_f32 v[146:147], v[146:147], v[2:3]
  v_pk_mul_f32 v[148:149], v[148:149], v[2:3]
  v_pk_mul_f32 v[150:151], v[150:151], v[2:3]
  v_cvt_pk_bf16_f32 v112, v144, v145
  v_cvt_pk_bf16_f32 v113, v146, v147
  v_cvt_pk_bf16_f32 v114, v148, v149
  v_cvt_pk_bf16_f32 v115, v150, v151
  v_permlane16_swap_b32 v108, v110
  v_permlane16_swap_b32 v109, v111
  ds_write_b128 v85, v[108:111] offset:0
  v_pk_mul_f32 v[152:153], v[152:153], v[2:3]
  v_pk_mul_f32 v[154:155], v[154:155], v[2:3]
  v_pk_mul_f32 v[156:157], v[156:157], v[2:3]
  v_pk_mul_f32 v[158:159], v[158:159], v[2:3]
  v_cvt_pk_bf16_f32 v116, v152, v153
  v_cvt_pk_bf16_f32 v117, v154, v155
  v_cvt_pk_bf16_f32 v118, v156, v157
  v_cvt_pk_bf16_f32 v119, v158, v159
  v_permlane16_swap_b32 v112, v114
  v_permlane16_swap_b32 v113, v115
  ds_write_b128 v86, v[112:115] offset:0
  s_nop 1
  v_permlane16_swap_b32 v116, v118
  v_permlane16_swap_b32 v117, v119
  ds_write_b128 v87, v[116:119] offset:0
  ds_read_b128 v[128:131], v100 offset:0
  ds_read_b128 v[132:135], v101 offset:0
  ds_read_b128 v[136:139], v102 offset:0
  ds_read_b128 v[140:143], v103 offset:0
  v_mfma_f32_16x16x32_bf16 v[24:27], a[192:195], a[16:19], v[56:59]
  s_add_u32 s56, s45, 0
  v_exp_f32 v40, v16
  v_mfma_f32_16x16x32_bf16 v[24:27], a[196:199], a[20:23], v[24:27]
  v_mfma_f32_16x16x32_bf16 v[24:27], a[200:203], a[24:27], v[24:27]
  v_exp_f32 v41, v17
  v_mfma_f32_16x16x32_bf16 v[24:27], a[204:207], a[28:31], v[24:27]
  v_cvt_pk_bf16_f32 v32, v40, v41
  v_mfma_f32_16x16x32_bf16 v[28:31], a[208:211], a[16:19], v[56:59]
  v_exp_f32 v42, v18
  v_mfma_f32_16x16x32_bf16 v[28:31], a[212:215], a[20:23], v[28:31]
  v_mfma_f32_16x16x32_bf16 v[28:31], a[216:219], a[24:27], v[28:31]
  v_exp_f32 v43, v19
  v_mfma_f32_16x16x32_bf16 v[28:31], a[220:223], a[28:31], v[28:31]
  v_cvt_pk_bf16_f32 v33, v42, v43
  v_mfma_f32_16x16x32_bf16 v[48:51], v[8:11], v[36:39], v[48:51]
  s_waitcnt lgkmcnt(0)
  v_exp_f32 v44, v20
  v_mfma_f32_16x16x32_bf16 v[160:163], a[160:163], v[36:39], v[160:163]
  buffer_store_dwordx4 v[128:131], v96, s[16:19], s56 offen sc1
  v_mfma_f32_16x16x32_bf16 v[164:167], a[164:167], v[36:39], v[164:167]
  v_exp_f32 v45, v21
  v_mfma_f32_16x16x32_bf16 v[168:171], a[168:171], v[36:39], v[168:171]
  v_cvt_pk_bf16_f32 v34, v44, v45
  v_mfma_f32_16x16x32_bf16 v[172:175], a[172:175], v[36:39], v[172:175]
  v_exp_f32 v46, v22
  v_mfma_f32_16x16x32_bf16 v[176:179], a[176:179], v[36:39], v[176:179]
  v_mfma_f32_16x16x32_bf16 v[180:183], a[180:183], v[36:39], v[180:183]
  v_exp_f32 v47, v23
  v_mfma_f32_16x16x32_bf16 v[184:187], a[184:187], v[36:39], v[184:187]
  v_cvt_pk_bf16_f32 v35, v46, v47
  v_mfma_f32_16x16x32_bf16 v[188:191], a[188:191], v[36:39], v[188:191]
  buffer_store_dwordx4 v[132:135], v97, s[16:19], s56 offen sc1
  v_mfma_f32_16x16x32_bf16 v[16:19], a[96:99], a[32:35], v[60:63]
  v_exp_f32 v40, v24
  v_mfma_f32_16x16x32_bf16 v[16:19], a[100:103], a[36:39], v[16:19]
  v_mfma_f32_16x16x32_bf16 v[16:19], a[104:107], a[40:43], v[16:19]
  v_exp_f32 v41, v25
  v_mfma_f32_16x16x32_bf16 v[16:19], a[108:111], a[44:47], v[16:19]
  v_cvt_pk_bf16_f32 v36, v40, v41
  v_mfma_f32_16x16x32_bf16 v[20:23], a[112:115], a[32:35], v[60:63]
  v_exp_f32 v42, v26
  v_mfma_f32_16x16x32_bf16 v[20:23], a[116:119], a[36:39], v[20:23]
  buffer_store_dwordx4 v[136:139], v98, s[16:19], s56 offen sc1
  v_mfma_f32_16x16x32_bf16 v[20:23], a[120:123], a[40:43], v[20:23]
  v_exp_f32 v43, v27
  v_mfma_f32_16x16x32_bf16 v[20:23], a[124:127], a[44:47], v[20:23]
  v_cvt_pk_bf16_f32 v37, v42, v43
  v_mfma_f32_16x16x32_bf16 v[48:51], v[8:11], v[32:35], v[48:51]
  v_exp_f32 v44, v28
  v_mfma_f32_16x16x32_bf16 v[160:163], a[224:227], v[32:35], v[160:163]
  v_mfma_f32_16x16x32_bf16 v[164:167], a[228:231], v[32:35], v[164:167]
  v_exp_f32 v45, v29
  v_mfma_f32_16x16x32_bf16 v[168:171], a[232:235], v[32:35], v[168:171]
  v_cvt_pk_bf16_f32 v38, v44, v45
  v_mfma_f32_16x16x32_bf16 v[172:175], a[236:239], v[32:35], v[172:175]
  v_exp_f32 v46, v30
  v_mfma_f32_16x16x32_bf16 v[176:179], a[240:243], v[32:35], v[176:179]
  buffer_store_dwordx4 v[140:143], v99, s[16:19], s56 offen sc1
  v_mfma_f32_16x16x32_bf16 v[180:183], a[244:247], v[32:35], v[180:183]
  v_exp_f32 v47, v31
  v_mfma_f32_16x16x32_bf16 v[184:187], a[248:251], v[32:35], v[184:187]
  v_cvt_pk_bf16_f32 v39, v46, v47
  v_mfma_f32_16x16x32_bf16 v[188:191], a[252:255], v[32:35], v[188:191]
  v_mfma_f32_16x16x32_bf16 v[24:27], a[64:67], a[32:35], v[60:63]
  v_exp_f32 v40, v16
  v_mfma_f32_16x16x32_bf16 v[24:27], a[68:71], a[36:39], v[24:27]
  v_mfma_f32_16x16x32_bf16 v[24:27], a[72:75], a[40:43], v[24:27]
  v_exp_f32 v41, v17
  v_mfma_f32_16x16x32_bf16 v[24:27], a[76:79], a[44:47], v[24:27]
  v_cvt_pk_bf16_f32 v32, v40, v41
  v_mfma_f32_16x16x32_bf16 v[28:31], a[80:83], a[32:35], v[60:63]
  v_exp_f32 v42, v18
  v_mfma_f32_16x16x32_bf16 v[28:31], a[84:87], a[36:39], v[28:31]
  v_mfma_f32_16x16x32_bf16 v[28:31], a[88:91], a[40:43], v[28:31]
  v_exp_f32 v43, v19
  v_mfma_f32_16x16x32_bf16 v[28:31], a[92:95], a[44:47], v[28:31]
  v_cvt_pk_bf16_f32 v33, v42, v43
  v_mfma_f32_16x16x32_bf16 v[48:51], v[8:11], v[36:39], v[48:51]
  v_exp_f32 v44, v20
  v_mfma_f32_16x16x32_bf16 v[160:163], a[128:131], v[36:39], v[160:163]
  v_mfma_f32_16x16x32_bf16 v[164:167], a[132:135], v[36:39], v[164:167]
  v_exp_f32 v45, v21
  v_mfma_f32_16x16x32_bf16 v[168:171], a[136:139], v[36:39], v[168:171]
  v_cvt_pk_bf16_f32 v34, v44, v45
  v_mfma_f32_16x16x32_bf16 v[172:175], a[140:143], v[36:39], v[172:175]
  v_exp_f32 v46, v22
  v_mfma_f32_16x16x32_bf16 v[176:179], a[144:147], v[36:39], v[176:179]
  v_mfma_f32_16x16x32_bf16 v[180:183], a[148:151], v[36:39], v[180:183]
  v_exp_f32 v47, v23
  v_mfma_f32_16x16x32_bf16 v[184:187], a[152:155], v[36:39], v[184:187]
  v_cvt_pk_bf16_f32 v35, v46, v47
  v_mfma_f32_16x16x32_bf16 v[188:191], a[156:159], v[36:39], v[188:191]
  v_cmp_nlt_f32 s[48:49], v49, s61
  v_rcp_f32 v2, v49
  s_add_u32 s60, s45, 256
  s_cmp_lg_u64 s[48:49], 0
  s_cbranch_scc1 L_fix
  v_mov_b32 v3, v2
  v_pk_mul_f32 v[160:161], v[160:161], v[2:3]
  v_pk_mul_f32 v[162:163], v[162:163], v[2:3]
  v_pk_mul_f32 v[164:165], v[164:165], v[2:3]
  v_pk_mul_f32 v[166:167], v[166:167], v[2:3]
  v_cvt_pk_bf16_f32 v104, v160, v161
  v_cvt_pk_bf16_f32 v105, v162, v163
  v_cvt_pk_bf16_f32 v106, v164, v165
  v_cvt_pk_bf16_f32 v107, v166, v167
  v_pk_mul_f32 v[168:169], v[168:169], v[2:3]
  v_pk_mul_f32 v[170:171], v[170:171], v[2:3]
  v_pk_mul_f32 v[172:173], v[172:173], v[2:3]
  v_pk_mul_f32 v[174:175], v[174:175], v[2:3]
  v_cvt_pk_bf16_f32 v108, v168, v169
  v_cvt_pk_bf16_f32 v109, v170, v171
  v_cvt_pk_bf16_f32 v110, v172, v173
  v_cvt_pk_bf16_f32 v111, v174, v175
  v_permlane16_swap_b32 v104, v106
  v_permlane16_swap_b32 v105, v107
  ds_write_b128 v84, v[104:107] offset:4096
  v_pk_mul_f32 v[176:177], v[176:177], v[2:3]
  v_pk_mul_f32 v[178:179], v[178:179], v[2:3]
  v_pk_mul_f32 v[180:181], v[180:181], v[2:3]
  v_pk_mul_f32 v[182:183], v[182:183], v[2:3]
  v_cvt_pk_bf16_f32 v112, v176, v177
  v_cvt_pk_bf16_f32 v113, v178, v179
  v_cvt_pk_bf16_f32 v114, v180, v181
  v_cvt_pk_bf16_f32 v115, v182, v183
  v_permlane16_swap_b32 v108, v110
  v_permlane16_swap_b32 v109, v111
  ds_write_b128 v85, v[108:111] offset:4096
  v_pk_mul_f32 v[184:185], v[184:185], v[2:3]
  v_pk_mul_f32 v[186:187], v[186:187], v[2:3]
  v_pk_mul_f32 v[188:189], v[188:189], v[2:3]
  v_pk_mul_f32 v[190:191], v[190:191], v[2:3]
  v_cvt_pk_bf16_f32 v116, v184, v185
  v_cvt_pk_bf16_f32 v117, v186, v187
  v_cvt_pk_bf16_f32 v118, v188, v189
  v_cvt_pk_bf16_f32 v119, v190, v191
  v_permlane16_swap_b32 v112, v114
  v_permlane16_swap_b32 v113, v115
  ds_write_b128 v86, v[112:115] offset:4096
  s_nop 1
  v_permlane16_swap_b32 v116, v118
  v_permlane16_swap_b32 v117, v119
  ds_write_b128 v87, v[116:119] offset:4096
  ds_read_b128 v[160:163], v100 offset:4096
  ds_read_b128 v[164:167], v101 offset:4096
  ds_read_b128 v[168:171], v102 offset:4096
  ds_read_b128 v[172:175], v103 offset:4096
  v_mfma_f32_16x16x32_bf16 v[16:19], a[192:195], a[32:35], v[60:63]
  s_add_u32 s57, s45, 256
  v_exp_f32 v40, v24
  v_mfma_f32_16x16x32_bf16 v[16:19], a[196:199], a[36:39], v[16:19]
  v_mfma_f32_16x16x32_bf16 v[16:19], a[200:203], a[40:43], v[16:19]
  v_exp_f32 v41, v25
  v_mfma_f32_16x16x32_bf16 v[16:19], a[204:207], a[44:47], v[16:19]
  v_cvt_pk_bf16_f32 v36, v40, v41
  v_mfma_f32_16x16x32_bf16 v[20:23], a[208:211], a[32:35], v[60:63]
  v_exp_f32 v42, v26
  v_mfma_f32_16x16x32_bf16 v[20:23], a[212:215], a[36:39], v[20:23]
  v_mfma_f32_16x16x32_bf16 v[20:23], a[216:219], a[40:43], v[20:23]
  v_exp_f32 v43, v27
  v_mfma_f32_16x16x32_bf16 v[20:23], a[220:223], a[44:47], v[20:23]
  v_cvt_pk_bf16_f32 v37, v42, v43
  v_mfma_f32_16x16x32_bf16 v[120:123], v[124:127], v[32:35], v[120:123]
  s_waitcnt lgkmcnt(0)
  v_exp_f32 v44, v28
  v_mfma_f32_16x16x32_bf16 v[192:195], a[160:163], v[32:35], v[192:195]
  buffer_store_dwordx4 v[160:163], v96, s[16:19], s57 offen sc1
  v_mfma_f32_16x16x32_bf16 v[196:199], a[164:167], v[32:35], v[196:199]
  v_exp_f32 v45, v29
  v_mfma_f32_16x16x32_bf16 v[200:203], a[168:171], v[32:35], v[200:203]
  v_cvt_pk_bf16_f32 v38, v44, v45
  v_mfma_f32_16x16x32_bf16 v[204:207], a[172:175], v[32:35], v[204:207]
  v_exp_f32 v46, v30
  v_mfma_f32_16x16x32_bf16 v[208:211], a[176:179], v[32:35], v[208:211]
  v_mfma_f32_16x16x32_bf16 v[212:215], a[180:183], v[32:35], v[212:215]
  v_exp_f32 v47, v31
  v_mfma_f32_16x16x32_bf16 v[216:219], a[184:187], v[32:35], v[216:219]
  v_cvt_pk_bf16_f32 v39, v46, v47
  v_mfma_f32_16x16x32_bf16 v[220:223], a[188:191], v[32:35], v[220:223]
  buffer_store_dwordx4 v[164:167], v97, s[16:19], s57 offen sc1
  v_mfma_f32_16x16x32_bf16 v[24:27], a[96:99], a[48:51], v[64:67]
  v_exp_f32 v40, v16
  v_mfma_f32_16x16x32_bf16 v[24:27], a[100:103], a[52:55], v[24:27]
  v_mfma_f32_16x16x32_bf16 v[24:27], a[104:107], a[56:59], v[24:27]
  v_exp_f32 v41, v17
  v_mfma_f32_16x16x32_bf16 v[24:27], a[108:111], a[60:63], v[24:27]
  v_cvt_pk_bf16_f32 v32, v40, v41
  v_mfma_f32_16x16x32_bf16 v[28:31], a[112:115], a[48:51], v[64:67]
  v_exp_f32 v42, v18
  v_mfma_f32_16x16x32_bf16 v[28:31], a[116:119], a[52:55], v[28:31]
  buffer_store_dwordx4 v[168:171], v98, s[16:19], s57 offen sc1
  v_mfma_f32_16x16x32_bf16 v[28:31], a[120:123], a[56:59], v[28:31]
  v_exp_f32 v43, v19
  v_mfma_f32_16x16x32_bf16 v[28:31], a[124:127], a[60:63], v[28:31]
  v_cvt_pk_bf16_f32 v33, v42, v43
  v_mfma_f32_16x16x32_bf16 v[120:123], v[124:127], v[36:39], v[120:123]
  v_exp_f32 v44, v20
  v_mfma_f32_16x16x32_bf16 v[192:195], a[224:227], v[36:39], v[192:195]
  v_mfma_f32_16x16x32_bf16 v[196:199], a[228:231], v[36:39], v[196:199]
  v_exp_f32 v45, v21
  v_mfma_f32_16x16x32_bf16 v[200:203], a[232:235], v[36:39], v[200:203]
  v_cvt_pk_bf16_f32 v34, v44, v45
  v_mfma_f32_16x16x32_bf16 v[204:207], a[236:239], v[36:39], v[204:207]
  v_exp_f32 v46, v22
  v_mfma_f32_16x16x32_bf16 v[208:211], a[240:243], v[36:39], v[208:211]
  buffer_store_dwordx4 v[172:175], v99, s[16:19], s57 offen sc1
  v_mfma_f32_16x16x32_bf16 v[212:215], a[244:247], v[36:39], v[212:215]
  v_exp_f32 v47, v23
  v_mfma_f32_16x16x32_bf16 v[216:219], a[248:251], v[36:39], v[216:219]
  v_cvt_pk_bf16_f32 v35, v46, v47
  v_mfma_f32_16x16x32_bf16 v[220:223], a[252:255], v[36:39], v[220:223]
  v_mfma_f32_16x16x32_bf16 v[16:19], a[64:67], a[48:51], v[64:67]
  v_exp_f32 v40, v24
  v_mfma_f32_16x16x32_bf16 v[16:19], a[68:71], a[52:55], v[16:19]
  v_mfma_f32_16x16x32_bf16 v[16:19], a[72:75], a[56:59], v[16:19]
  v_exp_f32 v41, v25
  v_mfma_f32_16x16x32_bf16 v[16:19], a[76:79], a[60:63], v[16:19]
  v_cvt_pk_bf16_f32 v36, v40, v41
  v_mfma_f32_16x16x32_bf16 v[20:23], a[80:83], a[48:51], v[64:67]
  v_exp_f32 v42, v26
  v_mfma_f32_16x16x32_bf16 v[20:23], a[84:87], a[52:55], v[20:23]
  v_mfma_f32_16x16x32_bf16 v[20:23], a[88:91], a[56:59], v[20:23]
  v_exp_f32 v43, v27
  v_mfma_f32_16x16x32_bf16 v[20:23], a[92:95], a[60:63], v[20:23]
  v_cvt_pk_bf16_f32 v37, v42, v43
  v_mfma_f32_16x16x32_bf16 v[120:123], v[124:127], v[32:35], v[120:123]
  v_exp_f32 v44, v28
  v_mfma_f32_16x16x32_bf16 v[192:195], a[128:131], v[32:35], v[192:195]
  v_mfma_f32_16x16x32_bf16 v[196:199], a[132:135], v[32:35], v[196:199]
  v_exp_f32 v45, v29
  v_mfma_f32_16x16x32_bf16 v[200:203], a[136:139], v[32:35], v[200:203]
  v_cvt_pk_bf16_f32 v38, v44, v45
  v_mfma_f32_16x16x32_bf16 v[204:207], a[140:143], v[32:35], v[204:207]
  v_exp_f32 v46, v30
  v_mfma_f32_16x16x32_bf16 v[208:211], a[144:147], v[32:35], v[208:211]
  v_mfma_f32_16x16x32_bf16 v[212:215], a[148:151], v[32:35], v[212:215]
  v_exp_f32 v47, v31
  v_mfma_f32_16x16x32_bf16 v[216:219], a[152:155], v[32:35], v[216:219]
  v_cvt_pk_bf16_f32 v39, v46, v47
  v_mfma_f32_16x16x32_bf16 v[220:223], a[156:159], v[32:35], v[220:223]
  v_cmp_nlt_f32 s[48:49], v120, s61
  v_rcp_f32 v2, v120
  s_add_u32 s60, s45, 512
  s_cmp_lg_u64 s[48:49], 0
  s_cbranch_scc1 L_fix
  v_mov_b32 v3, v2
  v_pk_mul_f32 v[192:193], v[192:193], v[2:3]
  v_pk_mul_f32 v[194:195], v[194:195], v[2:3]
  v_pk_mul_f32 v[196:197], v[196:197], v[2:3]
  v_pk_mul_f32 v[198:199], v[198:199], v[2:3]
  v_cvt_pk_bf16_f32 v104, v192, v193
  v_cvt_pk_bf16_f32 v105, v194, v195
  v_cvt_pk_bf16_f32 v106, v196, v197
  v_cvt_pk_bf16_f32 v107, v198, v199
  v_pk_mul_f32 v[200:201], v[200:201], v[2:3]
  v_pk_mul_f32 v[202:203], v[202:203], v[2:3]
  v_pk_mul_f32 v[204:205], v[204:205], v[2:3]
  v_pk_mul_f32 v[206:207], v[206:207], v[2:3]
  v_cvt_pk_bf16_f32 v108, v200, v201
  v_cvt_pk_bf16_f32 v109, v202, v203
  v_cvt_pk_bf16_f32 v110, v204, v205
  v_cvt_pk_bf16_f32 v111, v206, v207
  v_permlane16_swap_b32 v104, v106
  v_permlane16_swap_b32 v105, v107
  ds_write_b128 v84, v[104:107] offset:8192
  v_pk_mul_f32 v[208:209], v[208:209], v[2:3]
  v_pk_mul_f32 v[210:211], v[210:211], v[2:3]
  v_pk_mul_f32 v[212:213], v[212:213], v[2:3]
  v_pk_mul_f32 v[214:215], v[214:215], v[2:3]
  v_cvt_pk_bf16_f32 v112, v208, v209
  v_cvt_pk_bf16_f32 v113, v210, v211
  v_cvt_pk_bf16_f32 v114, v212, v213
  v_cvt_pk_bf16_f32 v115, v214, v215
  v_permlane16_swap_b32 v108, v110
  v_permlane16_swap_b32 v109, v111
  ds_write_b128 v85, v[108:111] offset:8192
  v_pk_mul_f32 v[216:217], v[216:217], v[2:3]
  v_pk_mul_f32 v[218:219], v[218:219], v[2:3]
  v_pk_mul_f32 v[220:221], v[220:221], v[2:3]
  v_pk_mul_f32 v[222:223], v[222:223], v[2:3]
  v_cvt_pk_bf16_f32 v116, v216, v217
  v_cvt_pk_bf16_f32 v117, v218, v219
  v_cvt_pk_bf16_f32 v118, v220, v221
  v_cvt_pk_bf16_f32 v119, v222, v223
  v_permlane16_swap_b32 v112, v114
  v_permlane16_swap_b32 v113, v115
  ds_write_b128 v86, v[112:115] offset:8192
  s_nop 1
  v_permlane16_swap_b32 v116, v118
  v_permlane16_swap_b32 v117, v119
  ds_write_b128 v87, v[116:119] offset:8192
  ds_read_b128 v[192:195], v100 offset:8192
  ds_read_b128 v[196:199], v101 offset:8192
  ds_read_b128 v[200:203], v102 offset:8192
  ds_read_b128 v[204:207], v103 offset:8192
  v_mfma_f32_16x16x32_bf16 v[24:27], a[192:195], a[48:51], v[64:67]
  s_add_u32 s58, s45, 512
  v_exp_f32 v40, v16
  v_mfma_f32_16x16x32_bf16 v[24:27], a[196:199], a[52:55], v[24:27]
  v_mfma_f32_16x16x32_bf16 v[24:27], a[200:203], a[56:59], v[24:27]
  v_exp_f32 v41, v17
  v_mfma_f32_16x16x32_bf16 v[24:27], a[204:207], a[60:63], v[24:27]
  v_cvt_pk_bf16_f32 v32, v40, v41
  v_mfma_f32_16x16x32_bf16 v[28:31], a[208:211], a[48:51], v[64:67]
  v_exp_f32 v42, v18
  v_mfma_f32_16x16x32_bf16 v[28:31], a[212:215], a[52:55], v[28:31]
  v_mfma_f32_16x16x32_bf16 v[28:31], a[216:219], a[56:59], v[28:31]
  v_exp_f32 v43, v19
  v_mfma_f32_16x16x32_bf16 v[28:31], a[220:223], a[60:63], v[28:31]
  v_cvt_pk_bf16_f32 v33, v42, v43
  v_mfma_f32_16x16x32_bf16 v[120:123], v[8:11], v[36:39], v[120:123]
  s_waitcnt lgkmcnt(0)
  v_exp_f32 v44, v20
  v_mfma_f32_16x16x32_bf16 v[224:227], a[160:163], v[36:39], v[224:227]
  buffer_store_dwordx4 v[192:195], v96, s[16:19], s58 offen sc1
  v_mfma_f32_16x16x32_bf16 v[228:231], a[164:167], v[36:39], v[228:231]
  v_exp_f32 v45, v21
  v_mfma_f32_16x16x32_bf16 v[232:235], a[168:171], v[36:39], v[232:235]
  v_cvt_pk_bf16_f32 v34, v44, v45
  v_mfma_f32_16x16x32_bf16 v[236:239], a[172:175], v[36:39], v[236:239]
  v_exp_f32 v46, v22
  v_mfma_f32_16x16x32_bf16 v[240:243], a[176:179], v[36:39], v[240:243]
  v_mfma_f32_16x16x32_bf16 v[244:247], a[180:183], v[36:39], v[244:247]
  v_exp_f32 v47, v23
  v_mfma_f32_16x16x32_bf16 v[248:251], a[184:187], v[36:39], v[248:251]
  v_cvt_pk_bf16_f32 v35, v46, v47
  v_mfma_f32_16x16x32_bf16 v[252:255], a[188:191], v[36:39], v[252:255]
  buffer_store_dwordx4 v[196:199], v97, s[16:19], s58 offen sc1
  s_nop 0
  v_exp_f32 v40, v24
  s_nop 0
  s_nop 0
  v_exp_f32 v41, v25
  s_nop 0
  v_cvt_pk_bf16_f32 v36, v40, v41
  s_nop 0
  v_exp_f32 v42, v26
  s_nop 0
  buffer_store_dwordx4 v[200:203], v98, s[16:19], s58 offen sc1
  s_nop 0
  v_exp_f32 v43, v27
  s_nop 0
  v_cvt_pk_bf16_f32 v37, v42, v43
  v_mfma_f32_16x16x32_bf16 v[120:123], v[8:11], v[32:35], v[120:123]
  v_exp_f32 v44, v28
  v_mfma_f32_16x16x32_bf16 v[224:227], a[224:227], v[32:35], v[224:227]
  v_mfma_f32_16x16x32_bf16 v[228:231], a[228:231], v[32:35], v[228:231]
  v_exp_f32 v45, v29
  v_mfma_f32_16x16x32_bf16 v[232:235], a[232:235], v[32:35], v[232:235]
  v_cvt_pk_bf16_f32 v38, v44, v45
  v_mfma_f32_16x16x32_bf16 v[236:239], a[236:239], v[32:35], v[236:239]
  v_exp_f32 v46, v30
  v_mfma_f32_16x16x32_bf16 v[240:243], a[240:243], v[32:35], v[240:243]
  buffer_store_dwordx4 v[204:207], v99, s[16:19], s58 offen sc1
  v_mfma_f32_16x16x32_bf16 v[244:247], a[244:247], v[32:35], v[244:247]
  v_exp_f32 v47, v31
  v_mfma_f32_16x16x32_bf16 v[248:251], a[248:251], v[32:35], v[248:251]
  v_cvt_pk_bf16_f32 v39, v46, v47
  v_mfma_f32_16x16x32_bf16 v[252:255], a[252:255], v[32:35], v[252:255]
  s_nop 1
  v_mfma_f32_16x16x32_bf16 v[120:123], v[8:11], v[36:39], v[120:123]
  v_mfma_f32_16x16x32_bf16 v[224:227], a[128:131], v[36:39], v[224:227]
  v_mfma_f32_16x16x32_bf16 v[228:231], a[132:135], v[36:39], v[228:231]
  v_mfma_f32_16x16x32_bf16 v[232:235], a[136:139], v[36:39], v[232:235]
  v_mfma_f32_16x16x32_bf16 v[236:239], a[140:143], v[36:39], v[236:239]
  v_mfma_f32_16x16x32_bf16 v[240:243], a[144:147], v[36:39], v[240:243]
  v_mfma_f32_16x16x32_bf16 v[244:247], a[148:151], v[36:39], v[244:247]
  v_mfma_f32_16x16x32_bf16 v[248:251], a[152:155], v[36:39], v[248:251]
  v_mfma_f32_16x16x32_bf16 v[252:255], a[156:159], v[36:39], v[252:255]
  v_cmp_nlt_f32 s[48:49], v121, s61
  v_rcp_f32 v2, v121
  s_add_u32 s60, s45, 768
  s_cmp_lg_u64 s[48:49], 0
  s_cbranch_scc1 L_fix
  v_mov_b32 v3, v2
  v_pk_mul_f32 v[224:225], v[224:225], v[2:3]
  v_pk_mul_f32 v[226:227], v[226:227], v[2:3]
  v_pk_mul_f32 v[228:229], v[228:229], v[2:3]
  v_pk_mul_f32 v[230:231], v[230:231], v[2:3]
  v_cvt_pk_bf16_f32 v104, v224, v225
  v_cvt_pk_bf16_f32 v105, v226, v227
  v_cvt_pk_bf16_f32 v106, v228, v229
  v_cvt_pk_bf16_f32 v107, v230, v231
  v_pk_mul_f32 v[232:233], v[232:233], v[2:3]
  v_pk_mul_f32 v[234:235], v[234:235], v[2:3]
  v_pk_mul_f32 v[236:237], v[236:237], v[2:3]
  v_pk_mul_f32 v[238:239], v[238:239], v[2:3]
  v_cvt_pk_bf16_f32 v108, v232, v233
  v_cvt_pk_bf16_f32 v109, v234, v235
  v_cvt_pk_bf16_f32 v110, v236, v237
  v_cvt_pk_bf16_f32 v111, v238, v239
  v_permlane16_swap_b32 v104, v106
  v_permlane16_swap_b32 v105, v107
  ds_write_b128 v84, v[104:107] offset:12288
  v_pk_mul_f32 v[240:241], v[240:241], v[2:3]
  v_pk_mul_f32 v[242:243], v[242:243], v[2:3]
  v_pk_mul_f32 v[244:245], v[244:245], v[2:3]
  v_pk_mul_f32 v[246:247], v[246:247], v[2:3]
  v_cvt_pk_bf16_f32 v112, v240, v241
  v_cvt_pk_bf16_f32 v113, v242, v243
  v_cvt_pk_bf16_f32 v114, v244, v245
  v_cvt_pk_bf16_f32 v115, v246, v247
  v_permlane16_swap_b32 v108, v110
  v_permlane16_swap_b32 v109, v111
  ds_write_b128 v85, v[108:111] offset:12288
  v_pk_mul_f32 v[248:249], v[248:249], v[2:3]
  v_pk_mul_f32 v[250:251], v[250:251], v[2:3]
  v_pk_mul_f32 v[252:253], v[252:253], v[2:3]
  v_pk_mul_f32 v[254:255], v[254:255], v[2:3]
  v_cvt_pk_bf16_f32 v116, v248, v249
  v_cvt_pk_bf16_f32 v117, v250, v251
  v_cvt_pk_bf16_f32 v118, v252, v253
  v_cvt_pk_bf16_f32 v119, v254, v255
  v_permlane16_swap_b32 v112, v114
  v_permlane16_swap_b32 v113, v115
  ds_write_b128 v86, v[112:115] offset:12288
  s_nop 1
  v_permlane16_swap_b32 v116, v118
  v_permlane16_swap_b32 v117, v119
  ds_write_b128 v87, v[116:119] offset:12288
  ds_read_b128 v[224:227], v100 offset:12288
  ds_read_b128 v[228:231], v101 offset:12288
  ds_read_b128 v[232:235], v102 offset:12288
  ds_read_b128 v[236:239], v103 offset:12288
  s_add_u32 s60, s45, 768
  s_waitcnt lgkmcnt(0)
  buffer_store_dwordx4 v[224:227], v96, s[16:19], s60 offen sc1
  buffer_store_dwordx4 v[228:231], v97, s[16:19], s60 offen sc1
  buffer_store_dwordx4 v[232:235], v98, s[16:19], s60 offen sc1
  buffer_store_dwordx4 v[236:239], v99, s[16:19], s60 offen sc1
  s_waitcnt vmcnt(0)
  s_branch L_done
L_drain:
  s_nop 1
  v_mfma_f32_16x16x32_bf16 v[120:123], v[8:11], v[36:39], v[120:123]
  v_mfma_f32_16x16x32_bf16 v[224:227], a[160:163], v[36:39], v[224:227]
  v_mfma_f32_16x16x32_bf16 v[228:231], a[164:167], v[36:39], v[228:231]
  v_mfma_f32_16x16x32_bf16 v[232:235], a[168:171], v[36:39], v[232:235]
  v_mfma_f32_16x16x32_bf16 v[236:239], a[172:175], v[36:39], v[236:239]
  v_mfma_f32_16x16x32_bf16 v[240:243], a[176:179], v[36:39], v[240:243]
  v_mfma_f32_16x16x32_bf16 v[244:247], a[180:183], v[36:39], v[244:247]
  v_mfma_f32_16x16x32_bf16 v[248:251], a[184:187], v[36:39], v[248:251]
  v_mfma_f32_16x16x32_bf16 v[252:255], a[188:191], v[36:39], v[252:255]
L_tail:
  s_or_b32 s60, s76, s77
  s_cmp_gt_u32 s68, 15
  s_cselect_b32 s60, 1, s60
  s_cmp_gt_u32 s69, 15
  s_cselect_b32 s60, 1, s60
  s_cmp_gt_u32 s70, 15
  s_cselect_b32 s60, 1, s60
  s_cmp_gt_u32 s71, 15
  s_cselect_b32 s60, 1, s60
  s_cmp_eq_u32 s60, 0
  s_cbranch_scc1 L_tail_done
  s_waitcnt vmcnt(0) lgkmcnt(0)
  s_mul_i32 s60, s66, 3072
  s_add_u32 s60, s60, 524288
  s_mov_b32 s67, 0
L_item0:
  s_cmp_ge_u32 s67, s68
  s_cbranch_scc1 L_item0_done
  s_cmp_ge_u32 s67, 15
  s_cbranch_scc1 L_item0_do
  s_lshl_b32 s61, s67, 2
  s_add_u32 s61, s61, 0
  s_bitcmp1_b64 s[76:77], s61
  s_cbranch_scc0 L_item0_next
L_item0_do:
  buffer_load_dwordx4 v[96:99], v15, s[32:35], s60 offen offset:0 sc1
  buffer_load_dwordx4 v[100:103], v15, s[32:35], s60 offen offset:1024 sc1
  buffer_load_dwordx4 v[104:107], v15, s[32:35], s60 offen offset:2048 sc1
  s_waitcnt vmcnt(0)
  s_add_u32 m0, s64, 0
  s_nop 0
  buffer_load_dwordx4 v96, s[20:23], 0 offen offset:0 lds
  buffer_load_dwordx4 v97, s[20:23], 0 offen offset:1024 lds
  buffer_load_dwordx4 v98, s[20:23], 0 offen offset:2048 lds
  buffer_load_dwordx4 v99, s[20:23], 0 offen offset:3072 lds
  s_add_u32 m0, s64, 4096
  s_nop 0
  buffer_load_dwordx4 v100, s[20:23], 0 offen offset:0 lds
  buffer_load_dwordx4 v101, s[20:23], 0 offen offset:1024 lds
  buffer_load_dwordx4 v102, s[20:23], 0 offen offset:2048 lds
  buffer_load_dwordx4 v103, s[20:23], 0 offen offset:3072 lds
  s_add_u32 m0, s64, 8192
  s_nop 0
  buffer_load_dwordx4 v96, s[24:27], 0 offen offset:0 lds
  buffer_load_dwordx4 v97, s[24:27], 0 offen offset:1024 lds
  buffer_load_dwordx4 v98, s[24:27], 0 offen offset:2048 lds
  buffer_load_dwordx4 v99, s[24:27], 0 offen offset:3072 lds
  s_add_u32 m0, s64, 12288
  s_nop 0
  buffer_load_dwordx4 v100, s[24:27], 0 offen offset:0 lds
  buffer_load_dwordx4 v101, s[24:27], 0 offen offset:1024 lds
  buffer_load_dwordx4 v102, s[24:27], 0 offen offset:2048 lds
  buffer_load_dwordx4 v103, s[24:27], 0 offen offset:3072 lds
  s_waitcnt vmcnt(0)
  ds_read_b128 a[192:195], v84 offset:0
  ds_read_b128 a[196:199], v85 offset:0
  ds_read_b128 a[200:203], v86 offset:0
  ds_read_b128 a[204:207], v87 offset:0
  ds_read_b128 a[208:211], v84 offset:4096
  ds_read_b128 a[212:215], v85 offset:4096
  ds_read_b128 a[216:219], v86 offset:4096
  ds_read_b128 a[220:223], v87 offset:4096
  ds_read_b64_tr_b16 a[224:225], v88 offset:0
  ds_read_b64_tr_b16 a[226:227], v88 offset:4096
  ds_read_b64_tr_b16 a[228:229], v89 offset:0
  ds_read_b64_tr_b16 a[230:231], v89 offset:4096
  ds_read_b64_tr_b16 a[232:233], v90 offset:0
  ds_read_b64_tr_b16 a[234:235], v90 offset:4096
  ds_read_b64_tr_b16 a[236:237], v91 offset:0
  ds_read_b64_tr_b16 a[238:239], v91 offset:4096
  ds_read_b64_tr_b16 a[240:241], v92 offset:0
  ds_read_b64_tr_b16 a[242:243], v92 offset:4096
  ds_read_b64_tr_b16 a[244:245], v93 offset:0
  ds_read_b64_tr_b16 a[246:247], v93 offset:4096
  ds_read_b64_tr_b16 a[248:249], v94 offset:0
  ds_read_b64_tr_b16 a[250:251], v94 offset:4096
  ds_read_b64_tr_b16 a[252:253], v95 offset:0
  ds_read_b64_tr_b16 a[254:255], v95 offset:4096
  s_waitcnt lgkmcnt(0)
  v_mfma_f32_16x16x32_bf16 v[108:111], a[192:195], a[0:3], v[52:55]
  v_mfma_f32_16x16x32_bf16 v[108:111], a[196:199], a[4:7], v[108:111]
  v_mfma_f32_16x16x32_bf16 v[108:111], a[200:203], a[8:11], v[108:111]
  v_mfma_f32_16x16x32_bf16 v[108:111], a[204:207], a[12:15], v[108:111]
  v_mfma_f32_16x16x32_bf16 v[112:115], a[208:211], a[0:3], v[52:55]
  v_mfma_f32_16x16x32_bf16 v[112:115], a[212:215], a[4:7], v[112:115]
  v_mfma_f32_16x16x32_bf16 v[112:115], a[216:219], a[8:11], v[112:115]
  v_mfma_f32_16x16x32_bf16 v[112:115], a[220:223], a[12:15], v[112:115]
  s_nop 7
  v_exp_f32 v40, v108
  v_exp_f32 v41, v109
  v_exp_f32 v42, v110
  v_exp_f32 v43, v111
  v_exp_f32 v44, v112
  v_exp_f32 v45, v113
  v_exp_f32 v46, v114
  v_exp_f32 v47, v115
  s_nop 0
  v_cvt_pk_bf16_f32 v116, v40, v41
  v_cvt_pk_bf16_f32 v117, v42, v43
  v_cvt_pk_bf16_f32 v118, v44, v45
  v_cvt_pk_bf16_f32 v119, v46, v47
  v_and_b32 v116, v116, v104
  v_and_b32 v117, v117, v105
  v_and_b32 v118, v118, v106
  v_and_b32 v119, v119, v107
  s_nop 1
  v_mfma_f32_16x16x32_bf16 v[48:51], v[124:127], v[116:119], v[48:51]
  v_mfma_f32_16x16x32_bf16 v[128:131], a[224:227], v[116:119], v[128:131]
  v_mfma_f32_16x16x32_bf16 v[132:135], a[228:231], v[116:119], v[132:135]
  v_mfma_f32_16x16x32_bf16 v[136:139], a[232:235], v[116:119], v[136:139]
  v_mfma_f32_16x16x32_bf16 v[140:143], a[236:239], v[116:119], v[140:143]
  v_mfma_f32_16x16x32_bf16 v[144:147], a[240:243], v[116:119], v[144:147]
  v_mfma_f32_16x16x32_bf16 v[148:151], a[244:247], v[116:119], v[148:151]
  v_mfma_f32_16x16x32_bf16 v[152:155], a[248:251], v[116:119], v[152:155]
  v_mfma_f32_16x16x32_bf16 v[156:159], a[252:255], v[116:119], v[156:159]
L_item0_next:
  s_add_u32 s60, s60, 786432
  s_add_u32 s67, s67, 1
  s_branch L_item0
L_item0_done:
  s_mul_i32 s60, s66, 3072
  s_add_u32 s60, s60, 527360
  s_mov_b32 s67, 0
L_item1:
  s_cmp_ge_u32 s67, s69
  s_cbranch_scc1 L_item1_done
  s_cmp_ge_u32 s67, 15
  s_cbranch_scc1 L_item1_do
  s_lshl_b32 s61, s67, 2
  s_add_u32 s61, s61, 1
  s_bitcmp1_b64 s[76:77], s61
  s_cbranch_scc0 L_item1_next
L_item1_do:
  buffer_load_dwordx4 v[96:99], v15, s[32:35], s60 offen offset:0 sc1
  buffer_load_dwordx4 v[100:103], v15, s[32:35], s60 offen offset:1024 sc1
  buffer_load_dwordx4 v[104:107], v15, s[32:35], s60 offen offset:2048 sc1
  s_waitcnt vmcnt(0)
  s_add_u32 m0, s64, 0
  s_nop 0
  buffer_load_dwordx4 v96, s[20:23], 0 offen offset:0 lds
  buffer_load_dwordx4 v97, s[20:23], 0 offen offset:1024 lds
  buffer_load_dwordx4 v98, s[20:23], 0 offen offset:2048 lds
  buffer_load_dwordx4 v99, s[20:23], 0 offen offset:3072 lds
  s_add_u32 m0, s64, 4096
  s_nop 0
  buffer_load_dwordx4 v100, s[20:23], 0 offen offset:0 lds
  buffer_load_dwordx4 v101, s[20:23], 0 offen offset:1024 lds
  buffer_load_dwordx4 v102, s[20:23], 0 offen offset:2048 lds
  buffer_load_dwordx4 v103, s[20:23], 0 offen offset:3072 lds
  s_add_u32 m0, s64, 8192
  s_nop 0
  buffer_load_dwordx4 v96, s[24:27], 0 offen offset:0 lds
  buffer_load_dwordx4 v97, s[24:27], 0 offen offset:1024 lds
  buffer_load_dwordx4 v98, s[24:27], 0 offen offset:2048 lds
  buffer_load_dwordx4 v99, s[24:27], 0 offen offset:3072 lds
  s_add_u32 m0, s64, 12288
  s_nop 0
  buffer_load_dwordx4 v100, s[24:27], 0 offen offset:0 lds
  buffer_load_dwordx4 v101, s[24:27], 0 offen offset:1024 lds
  buffer_load_dwordx4 v102, s[24:27], 0 offen offset:2048 lds
  buffer_load_dwordx4 v103, s[24:27], 0 offen offset:3072 lds
  s_waitcnt vmcnt(0)
  ds_read_b128 a[192:195], v84 offset:0
  ds_read_b128 a[196:199], v85 offset:0
  ds_read_b128 a[200:203], v86 offset:0
  ds_read_b128 a[204:207], v87 offset:0
  ds_read_b128 a[208:211], v84 offset:4096
  ds_read_b128 a[212:215], v85 offset:4096
  ds_read_b128 a[216:219], v86 offset:4096
  ds_read_b128 a[220:223], v87 offset:4096
  ds_read_b64_tr_b16 a[224:225], v88 offset:0
  ds_read_b64_tr_b16 a[226:227], v88 offset:4096
  ds_read_b64_tr_b16 a[228:229], v89 offset:0
  ds_read_b64_tr_b16 a[230:231], v89 offset:4096
  ds_read_b64_tr_b16 a[232:233], v90 offset:0
  ds_read_b64_tr_b16 a[234:235], v90 offset:4096
  ds_read_b64_tr_b16 a[236:237], v91 offset:0
  ds_read_b64_tr_b16 a[238:239], v91 offset:4096
  ds_read_b64_tr_b16 a[240:241], v92 offset:0
  ds_read_b64_tr_b16 a[242:243], v92 offset:4096
  ds_read_b64_tr_b16 a[244:245], v93 offset:0
  ds_read_b64_tr_b16 a[246:247], v93 offset:4096
  ds_read_b64_tr_b16 a[248:249], v94 offset:0
  ds_read_b64_tr_b16 a[250:251], v94 offset:4096
  ds_read_b64_tr_b16 a[252:253], v95 offset:0
  ds_read_b64_tr_b16 a[254:255], v95 offset:4096
  s_waitcnt lgkmcnt(0)
  v_mfma_f32_16x16x32_bf16 v[108:111], a[192:195], a[16:19], v[56:59]
  v_mfma_f32_16x16x32_bf16 v[108:111], a[196:199], a[20:23], v[108:111]
  v_mfma_f32_16x16x32_bf16 v[108:111], a[200:203], a[24:27], v[108:111]
  v_mfma_f32_16x16x32_bf16 v[108:111], a[204:207], a[28:31], v[108:111]
  v_mfma_f32_16x16x32_bf16 v[112:115], a[208:211], a[16:19], v[56:59]
  v_mfma_f32_16x16x32_bf16 v[112:115], a[212:215], a[20:23], v[112:115]
  v_mfma_f32_16x16x32_bf16 v[112:115], a[216:219], a[24:27], v[112:115]
  v_mfma_f32_16x16x32_bf16 v[112:115], a[220:223], a[28:31], v[112:115]
  s_nop 7
  v_exp_f32 v40, v108
  v_exp_f32 v41, v109
  v_exp_f32 v42, v110
  v_exp_f32 v43, v111
  v_exp_f32 v44, v112
  v_exp_f32 v45, v113
  v_exp_f32 v46, v114
  v_exp_f32 v47, v115
  s_nop 0
  v_cvt_pk_bf16_f32 v116, v40, v41
  v_cvt_pk_bf16_f32 v117, v42, v43
  v_cvt_pk_bf16_f32 v118, v44, v45
  v_cvt_pk_bf16_f32 v119, v46, v47
  v_and_b32 v116, v116, v104
  v_and_b32 v117, v117, v105
  v_and_b32 v118, v118, v106
  v_and_b32 v119, v119, v107
  s_nop 1
  v_mfma_f32_16x16x32_bf16 v[48:51], v[8:11], v[116:119], v[48:51]
  v_mfma_f32_16x16x32_bf16 v[160:163], a[224:227], v[116:119], v[160:163]
  v_mfma_f32_16x16x32_bf16 v[164:167], a[228:231], v[116:119], v[164:167]
  v_mfma_f32_16x16x32_bf16 v[168:171], a[232:235], v[116:119], v[168:171]
  v_mfma_f32_16x16x32_bf16 v[172:175], a[236:239], v[116:119], v[172:175]
  v_mfma_f32_16x16x32_bf16 v[176:179], a[240:243], v[116:119], v[176:179]
  v_mfma_f32_16x16x32_bf16 v[180:183], a[244:247], v[116:119], v[180:183]
  v_mfma_f32_16x16x32_bf16 v[184:187], a[248:251], v[116:119], v[184:187]
  v_mfma_f32_16x16x32_bf16 v[188:191], a[252:255], v[116:119], v[188:191]
L_item1_next:
  s_add_u32 s60, s60, 786432
  s_add_u32 s67, s67, 1
  s_branch L_item1
L_item1_done:
  s_mul_i32 s60, s66, 3072
  s_add_u32 s60, s60, 530432
  s_mov_b32 s67, 0
L_item2:
  s_cmp_ge_u32 s67, s70
  s_cbranch_scc1 L_item2_done
  s_cmp_ge_u32 s67, 15
  s_cbranch_scc1 L_item2_do
  s_lshl_b32 s61, s67, 2
  s_add_u32 s61, s61, 2
  s_bitcmp1_b64 s[76:77], s61
  s_cbranch_scc0 L_item2_next
L_item2_do:
  buffer_load_dwordx4 v[96:99], v15, s[32:35], s60 offen offset:0 sc1
  buffer_load_dwordx4 v[100:103], v15, s[32:35], s60 offen offset:1024 sc1
  buffer_load_dwordx4 v[104:107], v15, s[32:35], s60 offen offset:2048 sc1
  s_waitcnt vmcnt(0)
  s_add_u32 m0, s64, 0
  s_nop 0
  buffer_load_dwordx4 v96, s[20:23], 0 offen offset:0 lds
  buffer_load_dwordx4 v97, s[20:23], 0 offen offset:1024 lds
  buffer_load_dwordx4 v98, s[20:23], 0 offen offset:2048 lds
  buffer_load_dwordx4 v99, s[20:23], 0 offen offset:3072 lds
  s_add_u32 m0, s64, 4096
  s_nop 0
  buffer_load_dwordx4 v100, s[20:23], 0 offen offset:0 lds
  buffer_load_dwordx4 v101, s[20:23], 0 offen offset:1024 lds
  buffer_load_dwordx4 v102, s[20:23], 0 offen offset:2048 lds
  buffer_load_dwordx4 v103, s[20:23], 0 offen offset:3072 lds
  s_add_u32 m0, s64, 8192
  s_nop 0
  buffer_load_dwordx4 v96, s[24:27], 0 offen offset:0 lds
  buffer_load_dwordx4 v97, s[24:27], 0 offen offset:1024 lds
  buffer_load_dwordx4 v98, s[24:27], 0 offen offset:2048 lds
  buffer_load_dwordx4 v99, s[24:27], 0 offen offset:3072 lds
  s_add_u32 m0, s64, 12288
  s_nop 0
  buffer_load_dwordx4 v100, s[24:27], 0 offen offset:0 lds
  buffer_load_dwordx4 v101, s[24:27], 0 offen offset:1024 lds
  buffer_load_dwordx4 v102, s[24:27], 0 offen offset:2048 lds
  buffer_load_dwordx4 v103, s[24:27], 0 offen offset:3072 lds
  s_waitcnt vmcnt(0)
  ds_read_b128 a[192:195], v84 offset:0
  ds_read_b128 a[196:199], v85 offset:0
  ds_read_b128 a[200:203], v86 offset:0
  ds_read_b128 a[204:207], v87 offset:0
  ds_read_b128 a[208:211], v84 offset:4096
  ds_read_b128 a[212:215], v85 offset:4096
  ds_read_b128 a[216:219], v86 offset:4096
  ds_read_b128 a[220:223], v87 offset:4096
  ds_read_b64_tr_b16 a[224:225], v88 offset:0
  ds_read_b64_tr_b16 a[226:227], v88 offset:4096
  ds_read_b64_tr_b16 a[228:229], v89 offset:0
  ds_read_b64_tr_b16 a[230:231], v89 offset:4096
  ds_read_b64_tr_b16 a[232:233], v90 offset:0
  ds_read_b64_tr_b16 a[234:235], v90 offset:4096
  ds_read_b64_tr_b16 a[236:237], v91 offset:0
  ds_read_b64_tr_b16 a[238:239], v91 offset:4096
  ds_read_b64_tr_b16 a[240:241], v92 offset:0
  ds_read_b64_tr_b16 a[242:243], v92 offset:4096
  ds_read_b64_tr_b16 a[244:245], v93 offset:0
  ds_read_b64_tr_b16 a[246:247], v93 offset:4096
  ds_read_b64_tr_b16 a[248:249], v94 offset:0
  ds_read_b64_tr_b16 a[250:251], v94 offset:4096
  ds_read_b64_tr_b16 a[252:253], v95 offset:0
  ds_read_b64_tr_b16 a[254:255], v95 offset:4096
  s_waitcnt lgkmcnt(0)
  v_mfma_f32_16x16x32_bf16 v[108:111], a[192:195], a[32:35], v[60:63]
  v_mfma_f32_16x16x32_bf16 v[108:111], a[196:199], a[36:39], v[108:111]
  v_mfma_f32_16x16x32_bf16 v[108:111], a[200:203], a[40:43], v[108:111]
  v_mfma_f32_16x16x32_bf16 v[108:111], a[204:207], a[44:47], v[108:111]
  v_mfma_f32_16x16x32_bf16 v[112:115], a[208:211], a[32:35], v[60:63]
  v_mfma_f32_16x16x32_bf16 v[112:115], a[212:215], a[36:39], v[112:115]
  v_mfma_f32_16x16x32_bf16 v[112:115], a[216:219], a[40:43], v[112:115]
  v_mfma_f32_16x16x32_bf16 v[112:115], a[220:223], a[44:47], v[112:115]
  s_nop 7
  v_exp_f32 v40, v108
  v_exp_f32 v41, v109
  v_exp_f32 v42, v110
  v_exp_f32 v43, v111
  v_exp_f32 v44, v112
  v_exp_f32 v45, v113
  v_exp_f32 v46, v114
  v_exp_f32 v47, v115
  s_nop 0
  v_cvt_pk_bf16_f32 v116, v40, v41
  v_cvt_pk_bf16_f32 v117, v42, v43
  v_cvt_pk_bf16_f32 v118, v44, v45
  v_cvt_pk_bf16_f32 v119, v46, v47
  v_and_b32 v116, v116, v104
  v_and_b32 v117, v117, v105
  v_and_b32 v118, v118, v106
  v_and_b32 v119, v119, v107
  s_nop 1
  v_mfma_f32_16x16x32_bf16 v[120:123], v[124:127], v[116:119], v[120:123]
  v_mfma_f32_16x16x32_bf16 v[192:195], a[224:227], v[116:119], v[192:195]
  v_mfma_f32_16x16x32_bf16 v[196:199], a[228:231], v[116:119], v[196:199]
  v_mfma_f32_16x16x32_bf16 v[200:203], a[232:235], v[116:119], v[200:203]
  v_mfma_f32_16x16x32_bf16 v[204:207], a[236:239], v[116:119], v[204:207]
  v_mfma_f32_16x16x32_bf16 v[208:211], a[240:243], v[116:119], v[208:211]
  v_mfma_f32_16x16x32_bf16 v[212:215], a[244:247], v[116:119], v[212:215]
  v_mfma_f32_16x16x32_bf16 v[216:219], a[248:251], v[116:119], v[216:219]
  v_mfma_f32_16x16x32_bf16 v[220:223], a[252:255], v[116:119], v[220:223]
L_item2_next:
  s_add_u32 s60, s60, 786432
  s_add_u32 s67, s67, 1
  s_branch L_item2
L_item2_done:
  s_mul_i32 s60, s66, 3072
  s_add_u32 s60, s60, 533504
  s_mov_b32 s67, 0
L_item3:
  s_cmp_ge_u32 s67, s71
  s_cbranch_scc1 L_item3_done
  s_cmp_ge_u32 s67, 15
  s_cbranch_scc1 L_item3_do
  s_lshl_b32 s61, s67, 2
  s_add_u32 s61, s61, 3
  s_bitcmp1_b64 s[76:77], s61
  s_cbranch_scc0 L_item3_next
L_item3_do:
  buffer_load_dwordx4 v[96:99], v15, s[32:35], s60 offen offset:0 sc1
  buffer_load_dwordx4 v[100:103], v15, s[32:35], s60 offen offset:1024 sc1
  buffer_load_dwordx4 v[104:107], v15, s[32:35], s60 offen offset:2048 sc1
  s_waitcnt vmcnt(0)
  s_add_u32 m0, s64, 0
  s_nop 0
  buffer_load_dwordx4 v96, s[20:23], 0 offen offset:0 lds
  buffer_load_dwordx4 v97, s[20:23], 0 offen offset:1024 lds
  buffer_load_dwordx4 v98, s[20:23], 0 offen offset:2048 lds
  buffer_load_dwordx4 v99, s[20:23], 0 offen offset:3072 lds
  s_add_u32 m0, s64, 4096
  s_nop 0
  buffer_load_dwordx4 v100, s[20:23], 0 offen offset:0 lds
  buffer_load_dwordx4 v101, s[20:23], 0 offen offset:1024 lds
  buffer_load_dwordx4 v102, s[20:23], 0 offen offset:2048 lds
  buffer_load_dwordx4 v103, s[20:23], 0 offen offset:3072 lds
  s_add_u32 m0, s64, 8192
  s_nop 0
  buffer_load_dwordx4 v96, s[24:27], 0 offen offset:0 lds
  buffer_load_dwordx4 v97, s[24:27], 0 offen offset:1024 lds
  buffer_load_dwordx4 v98, s[24:27], 0 offen offset:2048 lds
  buffer_load_dwordx4 v99, s[24:27], 0 offen offset:3072 lds
  s_add_u32 m0, s64, 12288
  s_nop 0
  buffer_load_dwordx4 v100, s[24:27], 0 offen offset:0 lds
  buffer_load_dwordx4 v101, s[24:27], 0 offen offset:1024 lds
  buffer_load_dwordx4 v102, s[24:27], 0 offen offset:2048 lds
  buffer_load_dwordx4 v103, s[24:27], 0 offen offset:3072 lds
  s_waitcnt vmcnt(0)
  ds_read_b128 a[192:195], v84 offset:0
  ds_read_b128 a[196:199], v85 offset:0
  ds_read_b128 a[200:203], v86 offset:0
  ds_read_b128 a[204:207], v87 offset:0
  ds_read_b128 a[208:211], v84 offset:4096
  ds_read_b128 a[212:215], v85 offset:4096
  ds_read_b128 a[216:219], v86 offset:4096
  ds_read_b128 a[220:223], v87 offset:4096
  ds_read_b64_tr_b16 a[224:225], v88 offset:0
  ds_read_b64_tr_b16 a[226:227], v88 offset:4096
  ds_read_b64_tr_b16 a[228:229], v89 offset:0
  ds_read_b64_tr_b16 a[230:231], v89 offset:4096
  ds_read_b64_tr_b16 a[232:233], v90 offset:0
  ds_read_b64_tr_b16 a[234:235], v90 offset:4096
  ds_read_b64_tr_b16 a[236:237], v91 offset:0
  ds_read_b64_tr_b16 a[238:239], v91 offset:4096
  ds_read_b64_tr_b16 a[240:241], v92 offset:0
  ds_read_b64_tr_b16 a[242:243], v92 offset:4096
  ds_read_b64_tr_b16 a[244:245], v93 offset:0
  ds_read_b64_tr_b16 a[246:247], v93 offset:4096
  ds_read_b64_tr_b16 a[248:249], v94 offset:0
  ds_read_b64_tr_b16 a[250:251], v94 offset:4096
  ds_read_b64_tr_b16 a[252:253], v95 offset:0
  ds_read_b64_tr_b16 a[254:255], v95 offset:4096
  s_waitcnt lgkmcnt(0)
  v_mfma_f32_16x16x32_bf16 v[108:111], a[192:195], a[48:51], v[64:67]
  v_mfma_f32_16x16x32_bf16 v[108:111], a[196:199], a[52:55], v[108:111]
  v_mfma_f32_16x16x32_bf16 v[108:111], a[200:203], a[56:59], v[108:111]
  v_mfma_f32_16x16x32_bf16 v[108:111], a[204:207], a[60:63], v[108:111]
  v_mfma_f32_16x16x32_bf16 v[112:115], a[208:211], a[48:51], v[64:67]
  v_mfma_f32_16x16x32_bf16 v[112:115], a[212:215], a[52:55], v[112:115]
  v_mfma_f32_16x16x32_bf16 v[112:115], a[216:219], a[56:59], v[112:115]
  v_mfma_f32_16x16x32_bf16 v[112:115], a[220:223], a[60:63], v[112:115]
  s_nop 7
  v_exp_f32 v40, v108
  v_exp_f32 v41, v109
  v_exp_f32 v42, v110
  v_exp_f32 v43, v111
  v_exp_f32 v44, v112
  v_exp_f32 v45, v113
  v_exp_f32 v46, v114
  v_exp_f32 v47, v115
  s_nop 0
  v_cvt_pk_bf16_f32 v116, v40, v41
  v_cvt_pk_bf16_f32 v117, v42, v43
  v_cvt_pk_bf16_f32 v118, v44, v45
  v_cvt_pk_bf16_f32 v119, v46, v47
  v_and_b32 v116, v116, v104
  v_and_b32 v117, v117, v105
  v_and_b32 v118, v118, v106
  v_and_b32 v119, v119, v107
  s_nop 1
  v_mfma_f32_16x16x32_bf16 v[120:123], v[8:11], v[116:119], v[120:123]
  v_mfma_f32_16x16x32_bf16 v[224:227], a[224:227], v[116:119], v[224:227]
  v_mfma_f32_16x16x32_bf16 v[228:231], a[228:231], v[116:119], v[228:231]
  v_mfma_f32_16x16x32_bf16 v[232:235], a[232:235], v[116:119], v[232:235]
  v_mfma_f32_16x16x32_bf16 v[236:239], a[236:239], v[116:119], v[236:239]
  v_mfma_f32_16x16x32_bf16 v[240:243], a[240:243], v[116:119], v[240:243]
  v_mfma_f32_16x16x32_bf16 v[244:247], a[244:247], v[116:119], v[244:247]
  v_mfma_f32_16x16x32_bf16 v[248:251], a[248:251], v[116:119], v[248:251]
  v_mfma_f32_16x16x32_bf16 v[252:255], a[252:255], v[116:119], v[252:255]
L_item3_next:
  s_add_u32 s60, s60, 786432
  s_add_u32 s67, s67, 1
  s_branch L_item3
L_item3_done:
L_tail_done:
L_epi:
  s_waitcnt vmcnt(0) lgkmcnt(0)
  s_nop 7
  s_mov_b32 s60, 0x5f800000
  v_cmp_nlt_f32 s[48:49], v48, s60
  v_cmp_nlt_f32 s[50:51], v49, s60
  v_cmp_nlt_f32 s[52:53], v120, s60
  v_cmp_nlt_f32 s[54:55], v121, s60
  v_rcp_f32 v52, v48
  v_rcp_f32 v53, v49
  v_rcp_f32 v54, v120
  v_rcp_f32 v55, v121
  s_or_b64 s[48:49], s[48:49], s[50:51]
  s_or_b64 s[52:53], s[52:53], s[54:55]
  s_or_b64 s[48:49], s[48:49], s[52:53]
  s_cselect_b32 s60, 1, 0
  s_andn2_b32 s60, s60, s95
  s_cbranch_scc1 L_fix
  v_and_b32 v2, 15, v1
  v_lshrrev_b32 v3, 4, v1
  v_and_b32 v4, 1, v3
  v_lshlrev_b32 v4, 1, v4
  v_lshrrev_b32 v5, 1, v3
  v_or_b32 v4, v4, v5
  v_xor_b32 v4, v4, v2
  v_lshlrev_b32 v4, 4, v4
  v_lshl_add_u32 v4, v2, 8, v4
  v_add_u32 v4, s64, v4
  v_xor_b32 v96, 0, v4
  v_xor_b32 v97, 64, v4
  v_xor_b32 v98, 128, v4
  v_xor_b32 v99, 192, v4
  v_add_u32 v4, 0, v3
  v_mov_b32 v5, v2
  v_lshlrev_b32 v5, 4, v5
  v_and_b32 v4, 7, v4
  v_lshl_add_u32 v5, v4, 16, v5
  v_mov_b32 v8, v5
  v_add_u32 v4, 4, v3
  v_mov_b32 v5, v2
  v_lshlrev_b32 v5, 4, v5
  v_and_b32 v4, 7, v4
  v_lshl_add_u32 v5, v4, 16, v5
  v_mov_b32 v9, v5
  v_add_u32 v4, 8, v3
  v_mov_b32 v5, v2
  v_lshlrev_b32 v5, 4, v5
  v_and_b32 v4, 7, v4
  v_lshl_add_u32 v5, v4, 16, v5
  v_add_u32 v10, 524288, v5
  v_add_u32 v4, 12, v3
  v_mov_b32 v5, v2
  v_lshlrev_b32 v5, 4, v5
  v_and_b32 v4, 7, v4
  v_lshl_add_u32 v5, v4, 16, v5
  v_add_u32 v11, 524288, v5
  v_add_u32 v4, 0, v3
  v_xor_b32 v5, v2, v4
  v_lshlrev_b32 v5, 4, v5
  v_lshl_add_u32 v5, v4, 8, v5
  v_add_u32 v100, s64, v5
  v_add_u32 v4, 4, v3
  v_xor_b32 v5, v2, v4
  v_lshlrev_b32 v5, 4, v5
  v_lshl_add_u32 v5, v4, 8, v5
  v_add_u32 v101, s64, v5
  v_add_u32 v4, 8, v3
  v_xor_b32 v5, v2, v4
  v_lshlrev_b32 v5, 4, v5
  v_lshl_add_u32 v5, v4, 8, v5
  v_add_u32 v102, s64, v5
  v_add_u32 v4, 12, v3
  v_xor_b32 v5, v2, v4
  v_lshlrev_b32 v5, 4, v5
  v_lshl_add_u32 v5, v4, 8, v5
  v_add_u32 v103, s64, v5
  v_mov_b32 v2, v52
  v_mov_b32 v3, v52
  v_pk_mul_f32 v[128:129], v[128:129], v[2:3]
  v_pk_mul_f32 v[130:131], v[130:131], v[2:3]
  v_cvt_pk_bf16_f32 v16, v128, v129
  v_cvt_pk_bf16_f32 v17, v130, v131
  v_pk_mul_f32 v[132:133], v[132:133], v[2:3]
  v_pk_mul_f32 v[134:135], v[134:135], v[2:3]
  v_cvt_pk_bf16_f32 v18, v132, v133
  v_cvt_pk_bf16_f32 v19, v134, v135
  s_nop 1
  v_permlane16_swap_b32 v16, v18
  v_permlane16_swap_b32 v17, v19
  ds_write_b128 v96, v[16:19] offset:0
  v_pk_mul_f32 v[136:137], v[136:137], v[2:3]
  v_pk_mul_f32 v[138:139], v[138:139], v[2:3]
  v_cvt_pk_bf16_f32 v20, v136, v137
  v_cvt_pk_bf16_f32 v21, v138, v139
  v_pk_mul_f32 v[140:141], v[140:141], v[2:3]
  v_pk_mul_f32 v[142:143], v[142:143], v[2:3]
  v_cvt_pk_bf16_f32 v22, v140, v141
  v_cvt_pk_bf16_f32 v23, v142, v143
  s_nop 1
  v_permlane16_swap_b32 v20, v22
  v_permlane16_swap_b32 v21, v23
  ds_write_b128 v97, v[20:23] offset:0
  v_pk_mul_f32 v[144:145], v[144:145], v[2:3]
  v_pk_mul_f32 v[146:147], v[146:147], v[2:3]
  v_cvt_pk_bf16_f32 v24, v144, v145
  v_cvt_pk_bf16_f32 v25, v146, v147
  v_pk_mul_f32 v[148:149], v[148:149], v[2:3]
  v_pk_mul_f32 v[150:151], v[150:151], v[2:3]
  v_cvt_pk_bf16_f32 v26, v148, v149
  v_cvt_pk_bf16_f32 v27, v150, v151
  s_nop 1
  v_permlane16_swap_b32 v24, v26
  v_permlane16_swap_b32 v25, v27
  ds_write_b128 v98, v[24:27] offset:0
  v_pk_mul_f32 v[152:153], v[152:153], v[2:3]
  v_pk_mul_f32 v[154:155], v[154:155], v[2:3]
  v_cvt_pk_bf16_f32 v28, v152, v153
  v_cvt_pk_bf16_f32 v29, v154, v155
  v_pk_mul_f32 v[156:157], v[156:157], v[2:3]
  v_pk_mul_f32 v[158:159], v[158:159], v[2:3]
  v_cvt_pk_bf16_f32 v30, v156, v157
  v_cvt_pk_bf16_f32 v31, v158, v159
  s_nop 1
  v_permlane16_swap_b32 v28, v30
  v_permlane16_swap_b32 v29, v31
  ds_write_b128 v99, v[28:31] offset:0
  s_waitcnt lgkmcnt(0)
  ds_read_b128 v[128:131], v100 offset:0
  ds_read_b128 v[132:135], v101 offset:0
  ds_read_b128 v[136:139], v102 offset:0
  ds_read_b128 v[140:143], v103 offset:0
  s_add_u32 s60, s45, 0
  s_waitcnt lgkmcnt(3)
  buffer_store_dwordx4 v[128:131], v8, s[16:19], s60 offen sc1
  s_waitcnt lgkmcnt(2)
  buffer_store_dwordx4 v[132:135], v9, s[16:19], s60 offen sc1
  s_waitcnt lgkmcnt(1)
  buffer_store_dwordx4 v[136:139], v10, s[16:19], s60 offen sc1
  s_waitcnt lgkmcnt(0)
  buffer_store_dwordx4 v[140:143], v11, s[16:19], s60 offen sc1
  v_mov_b32 v2, v53
  v_mov_b32 v3, v53
  v_pk_mul_f32 v[160:161], v[160:161], v[2:3]
  v_pk_mul_f32 v[162:163], v[162:163], v[2:3]
  v_cvt_pk_bf16_f32 v32, v160, v161
  v_cvt_pk_bf16_f32 v33, v162, v163
  v_pk_mul_f32 v[164:165], v[164:165], v[2:3]
  v_pk_mul_f32 v[166:167], v[166:167], v[2:3]
  v_cvt_pk_bf16_f32 v34, v164, v165
  v_cvt_pk_bf16_f32 v35, v166, v167
  s_nop 1
  v_permlane16_swap_b32 v32, v34
  v_permlane16_swap_b32 v33, v35
  ds_write_b128 v96, v[32:35] offset:4096
  v_pk_mul_f32 v[168:169], v[168:169], v[2:3]
  v_pk_mul_f32 v[170:171], v[170:171], v[2:3]
  v_cvt_pk_bf16_f32 v36, v168, v169
  v_cvt_pk_bf16_f32 v37, v170, v171
  v_pk_mul_f32 v[172:173], v[172:173], v[2:3]
  v_pk_mul_f32 v[174:175], v[174:175], v[2:3]
  v_cvt_pk_bf16_f32 v38, v172, v173
  v_cvt_pk_bf16_f32 v39, v174, v175
  s_nop 1
  v_permlane16_swap_b32 v36, v38
  v_permlane16_swap_b32 v37, v39
  ds_write_b128 v97, v[36:39] offset:4096
  v_pk_mul_f32 v[176:177], v[176:177], v[2:3]
  v_pk_mul_f32 v[178:179], v[178:179], v[2:3]
  v_cvt_pk_bf16_f32 v40, v176, v177
  v_cvt_pk_bf16_f32 v41, v178, v179
  v_pk_mul_f32 v[180:181], v[180:181], v[2:3]
  v_pk_mul_f32 v[182:183], v[182:183], v[2:3]
  v_cvt_pk_bf16_f32 v42, v180, v181
  v_cvt_pk_bf16_f32 v43, v182, v183
  s_nop 1
  v_permlane16_swap_b32 v40, v42
  v_permlane16_swap_b32 v41, v43
  ds_write_b128 v98, v[40:43] offset:4096
  v_pk_mul_f32 v[184:185], v[184:185], v[2:3]
  v_pk_mul_f32 v[186:187], v[186:187], v[2:3]
  v_cvt_pk_bf16_f32 v44, v184, v185
  v_cvt_pk_bf16_f32 v45, v186, v187
  v_pk_mul_f32 v[188:189], v[188:189], v[2:3]
  v_pk_mul_f32 v[190:191], v[190:191], v[2:3]
  v_cvt_pk_bf16_f32 v46, v188, v189
  v_cvt_pk_bf16_f32 v47, v190, v191
  s_nop 1
  v_permlane16_swap_b32 v44, v46
  v_permlane16_swap_b32 v45, v47
  ds_write_b128 v99, v[44:47] offset:4096
  s_waitcnt lgkmcnt(0)
  ds_read_b128 v[160:163], v100 offset:4096
  ds_read_b128 v[164:167], v101 offset:4096
  ds_read_b128 v[168:171], v102 offset:4096
  ds_read_b128 v[172:175], v103 offset:4096
  s_add_u32 s60, s45, 256
  s_waitcnt lgkmcnt(3)
  buffer_store_dwordx4 v[160:163], v8, s[16:19], s60 offen sc1
  s_waitcnt lgkmcnt(2)
  buffer_store_dwordx4 v[164:167], v9, s[16:19], s60 offen sc1
  s_waitcnt lgkmcnt(1)
  buffer_store_dwordx4 v[168:171], v10, s[16:19], s60 offen sc1
  s_waitcnt lgkmcnt(0)
  buffer_store_dwordx4 v[172:175], v11, s[16:19], s60 offen sc1
  v_mov_b32 v2, v54
  v_mov_b32 v3, v54
  v_pk_mul_f32 v[192:193], v[192:193], v[2:3]
  v_pk_mul_f32 v[194:195], v[194:195], v[2:3]
  v_cvt_pk_bf16_f32 v16, v192, v193
  v_cvt_pk_bf16_f32 v17, v194, v195
  v_pk_mul_f32 v[196:197], v[196:197], v[2:3]
  v_pk_mul_f32 v[198:199], v[198:199], v[2:3]
  v_cvt_pk_bf16_f32 v18, v196, v197
  v_cvt_pk_bf16_f32 v19, v198, v199
  s_nop 1
  v_permlane16_swap_b32 v16, v18
  v_permlane16_swap_b32 v17, v19
  ds_write_b128 v96, v[16:19] offset:8192
  v_pk_mul_f32 v[200:201], v[200:201], v[2:3]
  v_pk_mul_f32 v[202:203], v[202:203], v[2:3]
  v_cvt_pk_bf16_f32 v20, v200, v201
  v_cvt_pk_bf16_f32 v21, v202, v203
  v_pk_mul_f32 v[204:205], v[204:205], v[2:3]
  v_pk_mul_f32 v[206:207], v[206:207], v[2:3]
  v_cvt_pk_bf16_f32 v22, v204, v205
  v_cvt_pk_bf16_f32 v23, v206, v207
  s_nop 1
  v_permlane16_swap_b32 v20, v22
  v_permlane16_swap_b32 v21, v23
  ds_write_b128 v97, v[20:23] offset:8192
  v_pk_mul_f32 v[208:209], v[208:209], v[2:3]
  v_pk_mul_f32 v[210:211], v[210:211], v[2:3]
  v_cvt_pk_bf16_f32 v24, v208, v209
  v_cvt_pk_bf16_f32 v25, v210, v211
  v_pk_mul_f32 v[212:213], v[212:213], v[2:3]
  v_pk_mul_f32 v[214:215], v[214:215], v[2:3]
  v_cvt_pk_bf16_f32 v26, v212, v213
  v_cvt_pk_bf16_f32 v27, v214, v215
  s_nop 1
  v_permlane16_swap_b32 v24, v26
  v_permlane16_swap_b32 v25, v27
  ds_write_b128 v98, v[24:27] offset:8192
  v_pk_mul_f32 v[216:217], v[216:217], v[2:3]
  v_pk_mul_f32 v[218:219], v[218:219], v[2:3]
  v_cvt_pk_bf16_f32 v28, v216, v217
  v_cvt_pk_bf16_f32 v29, v218, v219
  v_pk_mul_f32 v[220:221], v[220:221], v[2:3]
  v_pk_mul_f32 v[222:223], v[222:223], v[2:3]
  v_cvt_pk_bf16_f32 v30, v220, v221
  v_cvt_pk_bf16_f32 v31, v222, v223
  s_nop 1
  v_permlane16_swap_b32 v28, v30
  v_permlane16_swap_b32 v29, v31
  ds_write_b128 v99, v[28:31] offset:8192
  s_waitcnt lgkmcnt(0)
  ds_read_b128 v[192:195], v100 offset:8192
  ds_read_b128 v[196:199], v101 offset:8192
  ds_read_b128 v[200:203], v102 offset:8192
  ds_read_b128 v[204:207], v103 offset:8192
  s_add_u32 s60, s45, 512
  s_waitcnt lgkmcnt(3)
  buffer_store_dwordx4 v[192:195], v8, s[16:19], s60 offen sc1
  s_waitcnt lgkmcnt(2)
  buffer_store_dwordx4 v[196:199], v9, s[16:19], s60 offen sc1
  s_waitcnt lgkmcnt(1)
  buffer_store_dwordx4 v[200:203], v10, s[16:19], s60 offen sc1
  s_waitcnt lgkmcnt(0)
  buffer_store_dwordx4 v[204:207], v11, s[16:19], s60 offen sc1
  v_mov_b32 v2, v55
  v_mov_b32 v3, v55
  v_pk_mul_f32 v[224:225], v[224:225], v[2:3]
  v_pk_mul_f32 v[226:227], v[226:227], v[2:3]
  v_cvt_pk_bf16_f32 v32, v224, v225
  v_cvt_pk_bf16_f32 v33, v226, v227
  v_pk_mul_f32 v[228:229], v[228:229], v[2:3]
  v_pk_mul_f32 v[230:231], v[230:231], v[2:3]
  v_cvt_pk_bf16_f32 v34, v228, v229
  v_cvt_pk_bf16_f32 v35, v230, v231
  s_nop 1
  v_permlane16_swap_b32 v32, v34
  v_permlane16_swap_b32 v33, v35
  ds_write_b128 v96, v[32:35] offset:12288
  v_pk_mul_f32 v[232:233], v[232:233], v[2:3]
  v_pk_mul_f32 v[234:235], v[234:235], v[2:3]
  v_cvt_pk_bf16_f32 v36, v232, v233
  v_cvt_pk_bf16_f32 v37, v234, v235
  v_pk_mul_f32 v[236:237], v[236:237], v[2:3]
  v_pk_mul_f32 v[238:239], v[238:239], v[2:3]
  v_cvt_pk_bf16_f32 v38, v236, v237
  v_cvt_pk_bf16_f32 v39, v238, v239
  s_nop 1
  v_permlane16_swap_b32 v36, v38
  v_permlane16_swap_b32 v37, v39
  ds_write_b128 v97, v[36:39] offset:12288
  v_pk_mul_f32 v[240:241], v[240:241], v[2:3]
  v_pk_mul_f32 v[242:243], v[242:243], v[2:3]
  v_cvt_pk_bf16_f32 v40, v240, v241
  v_cvt_pk_bf16_f32 v41, v242, v243
  v_pk_mul_f32 v[244:245], v[244:245], v[2:3]
  v_pk_mul_f32 v[246:247], v[246:247], v[2:3]
  v_cvt_pk_bf16_f32 v42, v244, v245
  v_cvt_pk_bf16_f32 v43, v246, v247
  s_nop 1
  v_permlane16_swap_b32 v40, v42
  v_permlane16_swap_b32 v41, v43
  ds_write_b128 v98, v[40:43] offset:12288
  v_pk_mul_f32 v[248:249], v[248:249], v[2:3]
  v_pk_mul_f32 v[250:251], v[250:251], v[2:3]
  v_cvt_pk_bf16_f32 v44, v248, v249
  v_cvt_pk_bf16_f32 v45, v250, v251
  v_pk_mul_f32 v[252:253], v[252:253], v[2:3]
  v_pk_mul_f32 v[254:255], v[254:255], v[2:3]
  v_cvt_pk_bf16_f32 v46, v252, v253
  v_cvt_pk_bf16_f32 v47, v254, v255
  s_nop 1
  v_permlane16_swap_b32 v44, v46
  v_permlane16_swap_b32 v45, v47
  ds_write_b128 v99, v[44:47] offset:12288
  s_waitcnt lgkmcnt(0)
  ds_read_b128 v[224:227], v100 offset:12288
  ds_read_b128 v[228:231], v101 offset:12288
  ds_read_b128 v[232:235], v102 offset:12288
  ds_read_b128 v[236:239], v103 offset:12288
  s_add_u32 s60, s45, 768
  s_waitcnt lgkmcnt(3)
  buffer_store_dwordx4 v[224:227], v8, s[16:19], s60 offen sc1
  s_waitcnt lgkmcnt(2)
  buffer_store_dwordx4 v[228:231], v9, s[16:19], s60 offen sc1
  s_waitcnt lgkmcnt(1)
  buffer_store_dwordx4 v[232:235], v10, s[16:19], s60 offen sc1
  s_waitcnt lgkmcnt(0)
  buffer_store_dwordx4 v[236:239], v11, s[16:19], s60 offen sc1
  s_waitcnt vmcnt(0)
L_done:
  s_waitcnt vmcnt(0)
L_end:
  s_endpgm
L_slowpoll:
  s_mov_b32 s58, 0x40000
L_slowpoll_loop:
  buffer_load_dword v14, off, s[36:39], s66 sc1
  s_waitcnt vmcnt(0)
  v_readfirstlane_b32 s56, v14
  s_nop 3
  s_lshr_b32 s57, s56, 28
  s_cmp_eq_u32 s57, 4
  s_cbranch_scc1 L_polled
  s_cmp_gt_u32 s57, 4
  s_cbranch_scc1 L_slowpoll_giveup
  s_sleep 8
  s_sub_u32 s58, s58, 1
  s_cmp_lg_u32 s58, 0
  s_cbranch_scc1 L_slowpoll_loop
L_slowpoll_giveup:
  s_mov_b32 s56, 0
  s_branch L_polled
L_code_end:
L_fix:
  s_mov_b32 s95, 1
  s_waitcnt vmcnt(0) lgkmcnt(0)
  v_and_b32 v2, 15, v1
  v_lshrrev_b32 v3, 4, v1
  v_add_u32 v4, 0, v3
  v_and_b32 v5, 15, v4
  v_xor_b32 v5, v2, v5
  v_lshlrev_b32 v5, 4, v5
  v_lshl_add_u32 v16, v4, 8, v5
  v_add_u32 v4, 4, v3
  v_and_b32 v5, 15, v4
  v_xor_b32 v5, v2, v5
  v_lshlrev_b32 v5, 4, v5
  v_lshl_add_u32 v17, v4, 8, v5
  v_add_u32 v4, 8, v3
  v_and_b32 v5, 15, v4
  v_xor_b32 v5, v2, v5
  v_lshlrev_b32 v5, 4, v5
  v_lshl_add_u32 v18, v4, 8, v5
  v_add_u32 v4, 12, v3
  v_and_b32 v5, 15, v4
  v_xor_b32 v5, v2, v5
  v_lshlrev_b32 v5, 4, v5
  v_lshl_add_u32 v19, v4, 8, v5
  v_add_u32 v4, 16, v3
  v_and_b32 v5, 15, v4
  v_xor_b32 v5, v2, v5
  v_lshlrev_b32 v5, 4, v5
  v_lshl_add_u32 v20, v4, 8, v5
  v_add_u32 v4, 20, v3
  v_and_b32 v5, 15, v4
  v_xor_b32 v5, v2, v5
  v_lshlrev_b32 v5, 4, v5
  v_lshl_add_u32 v21, v4, 8, v5
  v_add_u32 v4, 24, v3
  v_and_b32 v5, 15, v4
  v_xor_b32 v5, v2, v5
  v_lshlrev_b32 v5, 4, v5
  v_lshl_add_u32 v22, v4, 8, v5
  v_add_u32 v4, 28, v3
  v_and_b32 v5, 15, v4
  v_xor_b32 v5, v2, v5
  v_lshlrev_b32 v5, 4, v5
  v_lshl_add_u32 v23, v4, 8, v5
  v_mov_b32 v24, 0xff800000
  v_mov_b32 v25, 0xff800000
  v_mov_b32 v26, 0xff800000
  v_mov_b32 v27, 0xff800000
  s_mov_b32 s60, 0
L_fix_max:
  s_add_u32 m0, s64, 0
  s_nop 0
  buffer_load_dwordx4 v16, s[8:11], s60 offen lds
  s_add_u32 m0, s64, 1024
  s_nop 0
  buffer_load_dwordx4 v17, s[8:11], s60 offen lds
  s_add_u32 m0, s64, 2048
  s_nop 0
  buffer_load_dwordx4 v18, s[8:11], s60 offen lds
  s_add_u32 m0, s64, 3072
  s_nop 0
  buffer_load_dwordx4 v19, s[8:11], s60 offen lds
  s_add_u32 m0, s64, 4096
  s_nop 0
  buffer_load_dwordx4 v20, s[8:11], s60 offen lds
  s_add_u32 m0, s64, 5120
  s_nop 0
  buffer_load_dwordx4 v21, s[8:11], s60 offen lds
  s_add_u32 m0, s64, 6144
  s_nop 0
  buffer_load_dwordx4 v22, s[8:11], s60 offen lds
  s_add_u32 m0, s64, 7168
  s_nop 0
  buffer_load_dwordx4 v23, s[8:11], s60 offen lds
  s_waitcnt vmcnt(0)
  ds_read_b128 a[192:195], v84 offset:0
  ds_read_b128 a[196:199], v85 offset:0
  ds_read_b128 a[200:203], v86 offset:0
  ds_read_b128 a[204:207], v87 offset:0
  ds_read_b128 a[208:211], v84 offset:4096
  ds_read_b128 a[212:215], v85 offset:4096
  ds_read_b128 a[216:219], v86 offset:4096
  ds_read_b128 a[220:223], v87 offset:4096
  s_waitcnt lgkmcnt(0)
  v_mfma_f32_16x16x32_bf16 v[108:111], a[192:195], a[0:3], 0
  v_mfma_f32_16x16x32_bf16 v[108:111], a[196:199], a[4:7], v[108:111]
  v_mfma_f32_16x16x32_bf16 v[108:111], a[200:203], a[8:11], v[108:111]
  v_mfma_f32_16x16x32_bf16 v[108:111], a[204:207], a[12:15], v[108:111]
  v_mfma_f32_16x16x32_bf16 v[112:115], a[208:211], a[0:3], 0
  v_mfma_f32_16x16x32_bf16 v[112:115], a[212:215], a[4:7], v[112:115]
  v_mfma_f32_16x16x32_bf16 v[112:115], a[216:219], a[8:11], v[112:115]
  v_mfma_f32_16x16x32_bf16 v[112:115], a[220:223], a[12:15], v[112:115]
  s_nop 7
  v_max3_f32 v24, v24, v108, v109
  v_max3_f32 v24, v24, v110, v111
  v_max3_f32 v24, v24, v112, v113
  v_max3_f32 v24, v24, v114, v115
  s_nop 1
  v_mfma_f32_16x16x32_bf16 v[108:111], a[192:195], a[16:19], 0
  v_mfma_f32_16x16x32_bf16 v[108:111], a[196:199], a[20:23], v[108:111]
  v_mfma_f32_16x16x32_bf16 v[108:111], a[200:203], a[24:27], v[108:111]
  v_mfma_f32_16x16x32_bf16 v[108:111], a[204:207], a[28:31], v[108:111]
  v_mfma_f32_16x16x32_bf16 v[112:115], a[208:211], a[16:19], 0
  v_mfma_f32_16x16x32_bf16 v[112:115], a[212:215], a[20:23], v[112:115]
  v_mfma_f32_16x16x32_bf16 v[112:115], a[216:219], a[24:27], v[112:115]
  v_mfma_f32_16x16x32_bf16 v[112:115], a[220:223], a[28:31], v[112:115]
  s_nop 7
  v_max3_f32 v25, v25, v108, v109
  v_max3_f32 v25, v25, v110, v111
  v_max3_f32 v25, v25, v112, v113
  v_max3_f32 v25, v25, v114, v115
  s_nop 1
  v_mfma_f32_16x16x32_bf16 v[108:111], a[192:195], a[32:35], 0
  v_mfma_f32_16x16x32_bf16 v[108:111], a[196:199], a[36:39], v[108:111]
  v_mfma_f32_16x16x32_bf16 v[108:111], a[200:203], a[40:43], v[108:111]
  v_mfma_f32_16x16x32_bf16 v[108:111], a[204:207], a[44:47], v[108:111]
  v_mfma_f32_16x16x32_bf16 v[112:115], a[208:211], a[32:35], 0
  v_mfma_f32_16x16x32_bf16 v[112:115], a[212:215], a[36:39], v[112:115]
  v_mfma_f32_16x16x32_bf16 v[112:115], a[216:219], a[40:43], v[112:115]
  v_mfma_f32_16x16x32_bf16 v[112:115], a[220:223], a[44:47], v[112:115]
  s_nop 7
  v_max3_f32 v26, v26, v108, v109
  v_max3_f32 v26, v26, v110, v111
  v_max3_f32 v26, v26, v112, v113
  v_max3_f32 v26, v26, v114, v115
  s_nop 1
  v_mfma_f32_16x16x32_bf16 v[108:111], a[192:195], a[48:51], 0
  v_mfma_f32_16x16x32_bf16 v[108:111], a[196:199], a[52:55], v[108:111]
  v_mfma_f32_16x16x32_bf16 v[108:111], a[200:203], a[56:59], v[108:111]
  v_mfma_f32_16x16x32_bf16 v[108:111], a[204:207], a[60:63], v[108:111]
  v_mfma_f32_16x16x32_bf16 v[112:115], a[208:211], a[48:51], 0
  v_mfma_f32_16x16x32_bf16 v[112:115], a[212:215], a[52:55], v[112:115]
  v_mfma_f32_16x16x32_bf16 v[112:115], a[216:219], a[56:59], v[112:115]
  v_mfma_f32_16x16x32_bf16 v[112:115], a[220:223], a[60:63], v[112:115]
  s_nop 7
  v_max3_f32 v27, v27, v108, v109
  v_max3_f32 v27, v27, v110, v111
  v_max3_f32 v27, v27, v112, v113
  v_max3_f32 v27, v27, v114, v115
  s_nop 1
  s_add_u32 s60, s60, 8192
  s_cmp_lt_u32 s60, 524288
  s_cbranch_scc1 L_fix_max
  s_add_u32 s60, s93, 0
  s_mov_b32 s67, 0
L_fix_t0:
  s_cmp_ge_u32 s67, s68
  s_cbranch_scc1 L_fix_t0_done
  buffer_load_dwordx4 v[96:99], v15, s[32:35], s60 offen offset:0 sc1
  buffer_load_dwordx4 v[100:103], v15, s[32:35], s60 offen offset:1024 sc1
  buffer_load_dwordx4 v[104:107], v15, s[32:35], s60 offen offset:2048 sc1
  s_waitcnt vmcnt(0)
  s_add_u32 m0, s64, 0
  s_nop 0
  buffer_load_dwordx4 v96, s[20:23], 0 offen offset:0 lds
  buffer_load_dwordx4 v97, s[20:23], 0 offen offset:1024 lds
  buffer_load_dwordx4 v98, s[20:23], 0 offen offset:2048 lds
  buffer_load_dwordx4 v99, s[20:23], 0 offen offset:3072 lds
  s_add_u32 m0, s64, 4096
  s_nop 0
  buffer_load_dwordx4 v100, s[20:23], 0 offen offset:0 lds
  buffer_load_dwordx4 v101, s[20:23], 0 offen offset:1024 lds
  buffer_load_dwordx4 v102, s[20:23], 0 offen offset:2048 lds
  buffer_load_dwordx4 v103, s[20:23], 0 offen offset:3072 lds
  s_waitcnt vmcnt(0)
  ds_read_b128 a[192:195], v84 offset:0
  ds_read_b128 a[196:199], v85 offset:0
  ds_read_b128 a[200:203], v86 offset:0
  ds_read_b128 a[204:207], v87 offset:0
  ds_read_b128 a[208:211], v84 offset:4096
  ds_read_b128 a[212:215], v85 offset:4096
  ds_read_b128 a[216:219], v86 offset:4096
  ds_read_b128 a[220:223], v87 offset:4096
  s_waitcnt lgkmcnt(0)
  v_mfma_f32_16x16x32_bf16 v[108:111], a[192:195], a[0:3], 0
  v_mfma_f32_16x16x32_bf16 v[108:111], a[196:199], a[4:7], v[108:111]
  v_mfma_f32_16x16x32_bf16 v[108:111], a[200:203], a[8:11], v[108:111]
  v_mfma_f32_16x16x32_bf16 v[108:111], a[204:207], a[12:15], v[108:111]
  v_mfma_f32_16x16x32_bf16 v[112:115], a[208:211], a[0:3], 0
  v_mfma_f32_16x16x32_bf16 v[112:115], a[212:215], a[4:7], v[112:115]
  v_mfma_f32_16x16x32_bf16 v[112:115], a[216:219], a[8:11], v[112:115]
  v_mfma_f32_16x16x32_bf16 v[112:115], a[220:223], a[12:15], v[112:115]
  s_nop 7
  v_mov_b32 v3, 0xff800000
  v_bfe_i32 v2, v104, 0, 1
  v_bfi_b32 v2, v2, v108, v3
  v_max_f32 v24, v24, v2
  v_bfe_i32 v2, v104, 16, 1
  v_bfi_b32 v2, v2, v109, v3
  v_max_f32 v24, v24, v2
  v_bfe_i32 v2, v105, 0, 1
  v_bfi_b32 v2, v2, v110, v3
  v_max_f32 v24, v24, v2
  v_bfe_i32 v2, v105, 16, 1
  v_bfi_b32 v2, v2, v111, v3
  v_max_f32 v24, v24, v2
  v_bfe_i32 v2, v106, 0, 1
  v_bfi_b32 v2, v2, v112, v3
  v_max_f32 v24, v24, v2
  v_bfe_i32 v2, v106, 16, 1
  v_bfi_b32 v2, v2, v113, v3
  v_max_f32 v24, v24, v2
  v_bfe_i32 v2, v107, 0, 1
  v_bfi_b32 v2, v2, v114, v3
  v_max_f32 v24, v24, v2
  v_bfe_i32 v2, v107, 16, 1
  v_bfi_b32 v2, v2, v115, v3
  v_max_f32 v24, v24, v2
  s_add_u32 s60, s60, 786432
  s_add_u32 s67, s67, 1
  s_branch L_fix_t0
L_fix_t0_done:
  s_add_u32 s60, s93, 3072
  s_mov_b32 s67, 0
L_fix_t1:
  s_cmp_ge_u32 s67, s69
  s_cbranch_scc1 L_fix_t1_done
  buffer_load_dwordx4 v[96:99], v15, s[32:35], s60 offen offset:0 sc1
  buffer_load_dwordx4 v[100:103], v15, s[32:35], s60 offen offset:1024 sc1
  buffer_load_dwordx4 v[104:107], v15, s[32:35], s60 offen offset:2048 sc1
  s_waitcnt vmcnt(0)
  s_add_u32 m0, s64, 0
  s_nop 0
  buffer_load_dwordx4 v96, s[20:23], 0 offen offset:0 lds
  buffer_load_dwordx4 v97, s[20:23], 0 offen offset:1024 lds
  buffer_load_dwordx4 v98, s[20:23], 0 offen offset:2048 lds
  buffer_load_dwordx4 v99, s[20:23], 0 offen offset:3072 lds
  s_add_u32 m0, s64, 4096
  s_nop 0
  buffer_load_dwordx4 v100, s[20:23], 0 offen offset:0 lds
  buffer_load_dwordx4 v101, s[20:23], 0 offen offset:1024 lds
  buffer_load_dwordx4 v102, s[20:23], 0 offen offset:2048 lds
  buffer_load_dwordx4 v103, s[20:23], 0 offen offset:3072 lds
  s_waitcnt vmcnt(0)
  ds_read_b128 a[192:195], v84 offset:0
  ds_read_b128 a[196:199], v85 offset:0
  ds_read_b128 a[200:203], v86 offset:0
  ds_read_b128 a[204:207], v87 offset:0
  ds_read_b128 a[208:211], v84 offset:4096
  ds_read_b128 a[212:215], v85 offset:4096
  ds_read_b128 a[216:219], v86 offset:4096
  ds_read_b128 a[220:223], v87 offset:4096
  s_waitcnt lgkmcnt(0)
  v_mfma_f32_16x16x32_bf16 v[108:111], a[192:195], a[16:19], 0
  v_mfma_f32_16x16x32_bf16 v[108:111], a[196:199], a[20:23], v[108:111]
  v_mfma_f32_16x16x32_bf16 v[108:111], a[200:203], a[24:27], v[108:111]
  v_mfma_f32_16x16x32_bf16 v[108:111], a[204:207], a[28:31], v[108:111]
  v_mfma_f32_16x16x32_bf16 v[112:115], a[208:211], a[16:19], 0
  v_mfma_f32_16x16x32_bf16 v[112:115], a[212:215], a[20:23], v[112:115]
  v_mfma_f32_16x16x32_bf16 v[112:115], a[216:219], a[24:27], v[112:115]
  v_mfma_f32_16x16x32_bf16 v[112:115], a[220:223], a[28:31], v[112:115]
  s_nop 7
  v_mov_b32 v3, 0xff800000
  v_bfe_i32 v2, v104, 0, 1
  v_bfi_b32 v2, v2, v108, v3
  v_max_f32 v25, v25, v2
  v_bfe_i32 v2, v104, 16, 1
  v_bfi_b32 v2, v2, v109, v3
  v_max_f32 v25, v25, v2
  v_bfe_i32 v2, v105, 0, 1
  v_bfi_b32 v2, v2, v110, v3
  v_max_f32 v25, v25, v2
  v_bfe_i32 v2, v105, 16, 1
  v_bfi_b32 v2, v2, v111, v3
  v_max_f32 v25, v25, v2
  v_bfe_i32 v2, v106, 0, 1
  v_bfi_b32 v2, v2, v112, v3
  v_max_f32 v25, v25, v2
  v_bfe_i32 v2, v106, 16, 1
  v_bfi_b32 v2, v2, v113, v3
  v_max_f32 v25, v25, v2
  v_bfe_i32 v2, v107, 0, 1
  v_bfi_b32 v2, v2, v114, v3
  v_max_f32 v25, v25, v2
  v_bfe_i32 v2, v107, 16, 1
  v_bfi_b32 v2, v2, v115, v3
  v_max_f32 v25, v25, v2
  s_add_u32 s60, s60, 786432
  s_add_u32 s67, s67, 1
  s_branch L_fix_t1
L_fix_t1_done:
  s_add_u32 s60, s93, 6144
  s_mov_b32 s67, 0
L_fix_t2:
  s_cmp_ge_u32 s67, s70
  s_cbranch_scc1 L_fix_t2_done
  buffer_load_dwordx4 v[96:99], v15, s[32:35], s60 offen offset:0 sc1
  buffer_load_dwordx4 v[100:103], v15, s[32:35], s60 offen offset:1024 sc1
  buffer_load_dwordx4 v[104:107], v15, s[32:35], s60 offen offset:2048 sc1
  s_waitcnt vmcnt(0)
  s_add_u32 m0, s64, 0
  s_nop 0
  buffer_load_dwordx4 v96, s[20:23], 0 offen offset:0 lds
  buffer_load_dwordx4 v97, s[20:23], 0 offen offset:1024 lds
  buffer_load_dwordx4 v98, s[20:23], 0 offen offset:2048 lds
  buffer_load_dwordx4 v99, s[20:23], 0 offen offset:3072 lds
  s_add_u32 m0, s64, 4096
  s_nop 0
  buffer_load_dwordx4 v100, s[20:23], 0 offen offset:0 lds
  buffer_load_dwordx4 v101, s[20:23], 0 offen offset:1024 lds
  buffer_load_dwordx4 v102, s[20:23], 0 offen offset:2048 lds
  buffer_load_dwordx4 v103, s[20:23], 0 offen offset:3072 lds
  s_waitcnt vmcnt(0)
  ds_read_b128 a[192:195], v84 offset:0
  ds_read_b128 a[196:199], v85 offset:0
  ds_read_b128 a[200:203], v86 offset:0
  ds_read_b128 a[204:207], v87 offset:0
  ds_read_b128 a[208:211], v84 offset:4096
  ds_read_b128 a[212:215], v85 offset:4096
  ds_read_b128 a[216:219], v86 offset:4096
  ds_read_b128 a[220:223], v87 offset:4096
  s_waitcnt lgkmcnt(0)
  v_mfma_f32_16x16x32_bf16 v[108:111], a[192:195], a[32:35], 0
  v_mfma_f32_16x16x32_bf16 v[108:111], a[196:199], a[36:39], v[108:111]
  v_mfma_f32_16x16x32_bf16 v[108:111], a[200:203], a[40:43], v[108:111]
  v_mfma_f32_16x16x32_bf16 v[108:111], a[204:207], a[44:47], v[108:111]
  v_mfma_f32_16x16x32_bf16 v[112:115], a[208:211], a[32:35], 0
  v_mfma_f32_16x16x32_bf16 v[112:115], a[212:215], a[36:39], v[112:115]
  v_mfma_f32_16x16x32_bf16 v[112:115], a[216:219], a[40:43], v[112:115]
  v_mfma_f32_16x16x32_bf16 v[112:115], a[220:223], a[44:47], v[112:115]
  s_nop 7
  v_mov_b32 v3, 0xff800000
  v_bfe_i32 v2, v104, 0, 1
  v_bfi_b32 v2, v2, v108, v3
  v_max_f32 v26, v26, v2
  v_bfe_i32 v2, v104, 16, 1
  v_bfi_b32 v2, v2, v109, v3
  v_max_f32 v26, v26, v2
  v_bfe_i32 v2, v105, 0, 1
  v_bfi_b32 v2, v2, v110, v3
  v_max_f32 v26, v26, v2
  v_bfe_i32 v2, v105, 16, 1
  v_bfi_b32 v2, v2, v111, v3
  v_max_f32 v26, v26, v2
  v_bfe_i32 v2, v106, 0, 1
  v_bfi_b32 v2, v2, v112, v3
  v_max_f32 v26, v26, v2
  v_bfe_i32 v2, v106, 16, 1
  v_bfi_b32 v2, v2, v113, v3
  v_max_f32 v26, v26, v2
  v_bfe_i32 v2, v107, 0, 1
  v_bfi_b32 v2, v2, v114, v3
  v_max_f32 v26, v26, v2
  v_bfe_i32 v2, v107, 16, 1
  v_bfi_b32 v2, v2, v115, v3
  v_max_f32 v26, v26, v2
  s_add_u32 s60, s60, 786432
  s_add_u32 s67, s67, 1
  s_branch L_fix_t2
L_fix_t2_done:
  s_add_u32 s60, s93, 9216
  s_mov_b32 s67, 0
L_fix_t3:
  s_cmp_ge_u32 s67, s71
  s_cbranch_scc1 L_fix_t3_done
  buffer_load_dwordx4 v[96:99], v15, s[32:35], s60 offen offset:0 sc1
  buffer_load_dwordx4 v[100:103], v15, s[32:35], s60 offen offset:1024 sc1
  buffer_load_dwordx4 v[104:107], v15, s[32:35], s60 offen offset:2048 sc1
  s_waitcnt vmcnt(0)
  s_add_u32 m0, s64, 0
  s_nop 0
  buffer_load_dwordx4 v96, s[20:23], 0 offen offset:0 lds
  buffer_load_dwordx4 v97, s[20:23], 0 offen offset:1024 lds
  buffer_load_dwordx4 v98, s[20:23], 0 offen offset:2048 lds
  buffer_load_dwordx4 v99, s[20:23], 0 offen offset:3072 lds
  s_add_u32 m0, s64, 4096
  s_nop 0
  buffer_load_dwordx4 v100, s[20:23], 0 offen offset:0 lds
  buffer_load_dwordx4 v101, s[20:23], 0 offen offset:1024 lds
  buffer_load_dwordx4 v102, s[20:23], 0 offen offset:2048 lds
  buffer_load_dwordx4 v103, s[20:23], 0 offen offset:3072 lds
  s_waitcnt vmcnt(0)
  ds_read_b128 a[192:195], v84 offset:0
  ds_read_b128 a[196:199], v85 offset:0
  ds_read_b128 a[200:203], v86 offset:0
  ds_read_b128 a[204:207], v87 offset:0
  ds_read_b128 a[208:211], v84 offset:4096
  ds_read_b128 a[212:215], v85 offset:4096
  ds_read_b128 a[216:219], v86 offset:4096
  ds_read_b128 a[220:223], v87 offset:4096
  s_waitcnt lgkmcnt(0)
  v_mfma_f32_16x16x32_bf16 v[108:111], a[192:195], a[48:51], 0
  v_mfma_f32_16x16x32_bf16 v[108:111], a[196:199], a[52:55], v[108:111]
  v_mfma_f32_16x16x32_bf16 v[108:111], a[200:203], a[56:59], v[108:111]
  v_mfma_f32_16x16x32_bf16 v[108:111], a[204:207], a[60:63], v[108:111]
  v_mfma_f32_16x16x32_bf16 v[112:115], a[208:211], a[48:51], 0
  v_mfma_f32_16x16x32_bf16 v[112:115], a[212:215], a[52:55], v[112:115]
  v_mfma_f32_16x16x32_bf16 v[112:115], a[216:219], a[56:59], v[112:115]
  v_mfma_f32_16x16x32_bf16 v[112:115], a[220:223], a[60:63], v[112:115]
  s_nop 7
  v_mov_b32 v3, 0xff800000
  v_bfe_i32 v2, v104, 0, 1
  v_bfi_b32 v2, v2, v108, v3
  v_max_f32 v27, v27, v2
  v_bfe_i32 v2, v104, 16, 1
  v_bfi_b32 v2, v2, v109, v3
  v_max_f32 v27, v27, v2
  v_bfe_i32 v2, v105, 0, 1
  v_bfi_b32 v2, v2, v110, v3
  v_max_f32 v27, v27, v2
  v_bfe_i32 v2, v105, 16, 1
  v_bfi_b32 v2, v2, v111, v3
  v_max_f32 v27, v27, v2
  v_bfe_i32 v2, v106, 0, 1
  v_bfi_b32 v2, v2, v112, v3
  v_max_f32 v27, v27, v2
  v_bfe_i32 v2, v106, 16, 1
  v_bfi_b32 v2, v2, v113, v3
  v_max_f32 v27, v27, v2
  v_bfe_i32 v2, v107, 0, 1
  v_bfi_b32 v2, v2, v114, v3
  v_max_f32 v27, v27, v2
  v_bfe_i32 v2, v107, 16, 1
  v_bfi_b32 v2, v2, v115, v3
  v_max_f32 v27, v27, v2
  s_add_u32 s60, s60, 786432
  s_add_u32 s67, s67, 1
  s_branch L_fix_t3
L_fix_t3_done:
  v_mov_b32 v2, v24
  v_mov_b32 v3, v25
  v_mov_b32 v4, v26
  v_mov_b32 v5, v27
  s_nop 1
  v_permlane16_swap_b32 v24, v2
  v_permlane16_swap_b32 v25, v3
  v_permlane16_swap_b32 v26, v4
  v_permlane16_swap_b32 v27, v5
  v_max_f32 v24, v24, v2
  v_max_f32 v25, v25, v3
  v_max_f32 v26, v26, v4
  v_max_f32 v27, v27, v5
  v_mov_b32 v2, v24
  v_mov_b32 v3, v25
  v_mov_b32 v4, v26
  v_mov_b32 v5, v27
  s_nop 1
  v_permlane32_swap_b32 v24, v2
  v_permlane32_swap_b32 v25, v3
  v_permlane32_swap_b32 v26, v4
  v_permlane32_swap_b32 v27, v5
  v_max_f32 v24, v24, v2
  v_max_f32 v25, v25, v3
  v_max_f32 v26, v26, v4
  v_max_f32 v27, v27, v5
  v_sub_f32 v52, 0, v24
  v_sub_f32 v53, 0, v24
  v_sub_f32 v54, 0, v24
  v_sub_f32 v55, 0, v24
  v_sub_f32 v56, 0, v25
  v_sub_f32 v57, 0, v25
  v_sub_f32 v58, 0, v25
  v_sub_f32 v59, 0, v25
  v_sub_f32 v60, 0, v26
  v_sub_f32 v61, 0, v26
  v_sub_f32 v62, 0, v26
  v_sub_f32 v63, 0, v26
  v_sub_f32 v64, 0, v27
  v_sub_f32 v65, 0, v27
  v_sub_f32 v66, 0, v27
  v_sub_f32 v67, 0, v27
  v_mov_b32 v48, 0
  v_mov_b32 v49, 0
  v_mov_b32 v50, 0
  v_mov_b32 v51, 0
  v_mov_b32 v120, 0
  v_mov_b32 v121, 0
  v_mov_b32 v122, 0
  v_mov_b32 v123, 0
  v_mov_b32 v128, 0
  v_mov_b32 v129, 0
  v_mov_b32 v130, 0
  v_mov_b32 v131, 0
  v_mov_b32 v132, 0
  v_mov_b32 v133, 0
  v_mov_b32 v134, 0
  v_mov_b32 v135, 0
  v_mov_b32 v136, 0
  v_mov_b32 v137, 0
  v_mov_b32 v138, 0
  v_mov_b32 v139, 0
  v_mov_b32 v140, 0
  v_mov_b32 v141, 0
  v_mov_b32 v142, 0
  v_mov_b32 v143, 0
  v_mov_b32 v144, 0
  v_mov_b32 v145, 0
  v_mov_b32 v146, 0
  v_mov_b32 v147, 0
  v_mov_b32 v148, 0
  v_mov_b32 v149, 0
  v_mov_b32 v150, 0
  v_mov_b32 v151, 0
  v_mov_b32 v152, 0
  v_mov_b32 v153, 0
  v_mov_b32 v154, 0
  v_mov_b32 v155, 0
  v_mov_b32 v156, 0
  v_mov_b32 v157, 0
  v_mov_b32 v158, 0
  v_mov_b32 v159, 0
  v_mov_b32 v160, 0
  v_mov_b32 v161, 0
  v_mov_b32 v162, 0
  v_mov_b32 v163, 0
  v_mov_b32 v164, 0
  v_mov_b32 v165, 0
  v_mov_b32 v166, 0
  v_mov_b32 v167, 0
  v_mov_b32 v168, 0
  v_mov_b32 v169, 0
  v_mov_b32 v170, 0
  v_mov_b32 v171, 0
  v_mov_b32 v172, 0
  v_mov_b32 v173, 0
  v_mov_b32 v174, 0
  v_mov_b32 v175, 0
  v_mov_b32 v176, 0
  v_mov_b32 v177, 0
  v_mov_b32 v178, 0
  v_mov_b32 v179, 0
  v_mov_b32 v180, 0
  v_mov_b32 v181, 0
  v_mov_b32 v182, 0
  v_mov_b32 v183, 0
  v_mov_b32 v184, 0
  v_mov_b32 v185, 0
  v_mov_b32 v186, 0
  v_mov_b32 v187, 0
  v_mov_b32 v188, 0
  v_mov_b32 v189, 0
  v_mov_b32 v190, 0
  v_mov_b32 v191, 0
  v_mov_b32 v192, 0
  v_mov_b32 v193, 0
  v_mov_b32 v194, 0
  v_mov_b32 v195, 0
  v_mov_b32 v196, 0
  v_mov_b32 v197, 0
  v_mov_b32 v198, 0
  v_mov_b32 v199, 0
  v_mov_b32 v200, 0
  v_mov_b32 v201, 0
  v_mov_b32 v202, 0
  v_mov_b32 v203, 0
  v_mov_b32 v204, 0
  v_mov_b32 v205, 0
  v_mov_b32 v206, 0
  v_mov_b32 v207, 0
  v_mov_b32 v208, 0
  v_mov_b32 v209, 0
  v_mov_b32 v210, 0
  v_mov_b32 v211, 0
  v_mov_b32 v212, 0
  v_mov_b32 v213, 0
  v_mov_b32 v214, 0
  v_mov_b32 v215, 0
  v_mov_b32 v216, 0
  v_mov_b32 v217, 0
  v_mov_b32 v218, 0
  v_mov_b32 v219, 0
  v_mov_b32 v220, 0
  v_mov_b32 v221, 0
  v_mov_b32 v222, 0
  v_mov_b32 v223, 0
  v_mov_b32 v224, 0
  v_mov_b32 v225, 0
  v_mov_b32 v226, 0
  v_mov_b32 v227, 0
  v_mov_b32 v228, 0
  v_mov_b32 v229, 0
  v_mov_b32 v230, 0
  v_mov_b32 v231, 0
  v_mov_b32 v232, 0
  v_mov_b32 v233, 0
  v_mov_b32 v234, 0
  v_mov_b32 v235, 0
  v_mov_b32 v236, 0
  v_mov_b32 v237, 0
  v_mov_b32 v238, 0
  v_mov_b32 v239, 0
  v_mov_b32 v240, 0
  v_mov_b32 v241, 0
  v_mov_b32 v242, 0
  v_mov_b32 v243, 0
  v_mov_b32 v244, 0
  v_mov_b32 v245, 0
  v_mov_b32 v246, 0
  v_mov_b32 v247, 0
  v_mov_b32 v248, 0
  v_mov_b32 v249, 0
  v_mov_b32 v250, 0
  v_mov_b32 v251, 0
  v_mov_b32 v252, 0
  v_mov_b32 v253, 0
  v_mov_b32 v254, 0
  v_mov_b32 v255, 0
  s_mov_b32 s60, 0
L_fix_acc:
  s_add_u32 m0, s64, 0
  s_nop 0
  buffer_load_dwordx4 v16, s[8:11], s60 offen lds
  s_add_u32 m0, s64, 1024
  s_nop 0
  buffer_load_dwordx4 v17, s[8:11], s60 offen lds
  s_add_u32 m0, s64, 2048
  s_nop 0
  buffer_load_dwordx4 v18, s[8:11], s60 offen lds
  s_add_u32 m0, s64, 3072
  s_nop 0
  buffer_load_dwordx4 v19, s[8:11], s60 offen lds
  s_add_u32 m0, s64, 4096
  s_nop 0
  buffer_load_dwordx4 v20, s[8:11], s60 offen lds
  s_add_u32 m0, s64, 5120
  s_nop 0
  buffer_load_dwordx4 v21, s[8:11], s60 offen lds
  s_add_u32 m0, s64, 6144
  s_nop 0
  buffer_load_dwordx4 v22, s[8:11], s60 offen lds
  s_add_u32 m0, s64, 7168
  s_nop 0
  buffer_load_dwordx4 v23, s[8:11], s60 offen lds
  s_add_u32 m0, s64, 8192
  s_nop 0
  buffer_load_dwordx4 v16, s[12:15], s60 offen lds
  s_add_u32 m0, s64, 9216
  s_nop 0
  buffer_load_dwordx4 v17, s[12:15], s60 offen lds
  s_add_u32 m0, s64, 10240
  s_nop 0
  buffer_load_dwordx4 v18, s[12:15], s60 offen lds
  s_add_u32 m0, s64, 11264
  s_nop 0
  buffer_load_dwordx4 v19, s[12:15], s60 offen lds
  s_add_u32 m0, s64, 12288
  s_nop 0
  buffer_load_dwordx4 v20, s[12:15], s60 offen lds
  s_add_u32 m0, s64, 13312
  s_nop 0
  buffer_load_dwordx4 v21, s[12:15], s60 offen lds
  s_add_u32 m0, s64, 14336
  s_nop 0
  buffer_load_dwordx4 v22, s[12:15], s60 offen lds
  s_add_u32 m0, s64, 15360
  s_nop 0
  buffer_load_dwordx4 v23, s[12:15], s60 offen lds
  s_waitcnt vmcnt(0)
  ds_read_b128 a[192:195], v84 offset:0
  ds_read_b128 a[196:199], v85 offset:0
  ds_read_b128 a[200:203], v86 offset:0
  ds_read_b128 a[204:207], v87 offset:0
  ds_read_b128 a[208:211], v84 offset:4096
  ds_read_b128 a[212:215], v85 offset:4096
  ds_read_b128 a[216:219], v86 offset:4096
  ds_read_b128 a[220:223], v87 offset:4096
  ds_read_b64_tr_b16 a[224:225], v88 offset:0
  ds_read_b64_tr_b16 a[226:227], v88 offset:4096
  ds_read_b64_tr_b16 a[228:229], v89 offset:0
  ds_read_b64_tr_b16 a[230:231], v89 offset:4096
  ds_read_b64_tr_b16 a[232:233], v90 offset:0
  ds_read_b64_tr_b16 a[234:235], v90 offset:4096
  ds_read_b64_tr_b16 a[236:237], v91 offset:0
  ds_read_b64_tr_b16 a[238:239], v91 offset:4096
  ds_read_b64_tr_b16 a[240:241], v92 offset:0
  ds_read_b64_tr_b16 a[242:243], v92 offset:4096
  ds_read_b64_tr_b16 a[244:245], v93 offset:0
  ds_read_b64_tr_b16 a[246:247], v93 offset:4096
  ds_read_b64_tr_b16 a[248:249], v94 offset:0
  ds_read_b64_tr_b16 a[250:251], v94 offset:4096
  ds_read_b64_tr_b16 a[252:253], v95 offset:0
  ds_read_b64_tr_b16 a[254:255], v95 offset:4096
  s_waitcnt lgkmcnt(0)
  v_mfma_f32_16x16x32_bf16 v[108:111], a[192:195], a[0:3], v[52:55]
  v_mfma_f32_16x16x32_bf16 v[108:111], a[196:199], a[4:7], v[108:111]
  v_mfma_f32_16x16x32_bf16 v[108:111], a[200:203], a[8:11], v[108:111]
  v_mfma_f32_16x16x32_bf16 v[108:111], a[204:207], a[12:15], v[108:111]
  v_mfma_f32_16x16x32_bf16 v[112:115], a[208:211], a[0:3], v[52:55]
  v_mfma_f32_16x16x32_bf16 v[112:115], a[212:215], a[4:7], v[112:115]
  v_mfma_f32_16x16x32_bf16 v[112:115], a[216:219], a[8:11], v[112:115]
  v_mfma_f32_16x16x32_bf16 v[112:115], a[220:223], a[12:15], v[112:115]
  s_nop 7
  v_exp_f32 v40, v108
  v_exp_f32 v41, v109
  v_exp_f32 v42, v110
  v_exp_f32 v43, v111
  v_exp_f32 v44, v112
  v_exp_f32 v45, v113
  v_exp_f32 v46, v114
  v_exp_f32 v47, v115
  s_nop 0
  v_cvt_pk_bf16_f32 v116, v40, v41
  v_cvt_pk_bf16_f32 v117, v42, v43
  v_cvt_pk_bf16_f32 v118, v44, v45
  v_cvt_pk_bf16_f32 v119, v46, v47
  s_nop 1
  v_mfma_f32_16x16x32_bf16 v[48:51], v[124:127], v[116:119], v[48:51]
  v_mfma_f32_16x16x32_bf16 v[128:131], a[224:227], v[116:119], v[128:131]
  v_mfma_f32_16x16x32_bf16 v[132:135], a[228:231], v[116:119], v[132:135]
  v_mfma_f32_16x16x32_bf16 v[136:139], a[232:235], v[116:119], v[136:139]
  v_mfma_f32_16x16x32_bf16 v[140:143], a[236:239], v[116:119], v[140:143]
  v_mfma_f32_16x16x32_bf16 v[144:147], a[240:243], v[116:119], v[144:147]
  v_mfma_f32_16x16x32_bf16 v[148:151], a[244:247], v[116:119], v[148:151]
  v_mfma_f32_16x16x32_bf16 v[152:155], a[248:251], v[116:119], v[152:155]
  v_mfma_f32_16x16x32_bf16 v[156:159], a[252:255], v[116:119], v[156:159]
  v_mfma_f32_16x16x32_bf16 v[108:111], a[192:195], a[16:19], v[56:59]
  v_mfma_f32_16x16x32_bf16 v[108:111], a[196:199], a[20:23], v[108:111]
  v_mfma_f32_16x16x32_bf16 v[108:111], a[200:203], a[24:27], v[108:111]
  v_mfma_f32_16x16x32_bf16 v[108:111], a[204:207], a[28:31], v[108:111]
  v_mfma_f32_16x16x32_bf16 v[112:115], a[208:211], a[16:19], v[56:59]
  v_mfma_f32_16x16x32_bf16 v[112:115], a[212:215], a[20:23], v[112:115]
  v_mfma_f32_16x16x32_bf16 v[112:115], a[216:219], a[24:27], v[112:115]
  v_mfma_f32_16x16x32_bf16 v[112:115], a[220:223], a[28:31], v[112:115]
  s_nop 7
  v_exp_f32 v40, v108
  v_exp_f32 v41, v109
  v_exp_f32 v42, v110
  v_exp_f32 v43, v111
  v_exp_f32 v44, v112
  v_exp_f32 v45, v113
  v_exp_f32 v46, v114
  v_exp_f32 v47, v115
  s_nop 0
  v_cvt_pk_bf16_f32 v116, v40, v41
  v_cvt_pk_bf16_f32 v117, v42, v43
  v_cvt_pk_bf16_f32 v118, v44, v45
  v_cvt_pk_bf16_f32 v119, v46, v47
  s_nop 1
  v_mfma_f32_16x16x32_bf16 v[48:51], v[8:11], v[116:119], v[48:51]
  v_mfma_f32_16x16x32_bf16 v[160:163], a[224:227], v[116:119], v[160:163]
  v_mfma_f32_16x16x32_bf16 v[164:167], a[228:231], v[116:119], v[164:167]
  v_mfma_f32_16x16x32_bf16 v[168:171], a[232:235], v[116:119], v[168:171]
  v_mfma_f32_16x16x32_bf16 v[172:175], a[236:239], v[116:119], v[172:175]
  v_mfma_f32_16x16x32_bf16 v[176:179], a[240:243], v[116:119], v[176:179]
  v_mfma_f32_16x16x32_bf16 v[180:183], a[244:247], v[116:119], v[180:183]
  v_mfma_f32_16x16x32_bf16 v[184:187], a[248:251], v[116:119], v[184:187]
  v_mfma_f32_16x16x32_bf16 v[188:191], a[252:255], v[116:119], v[188:191]
  v_mfma_f32_16x16x32_bf16 v[108:111], a[192:195], a[32:35], v[60:63]
  v_mfma_f32_16x16x32_bf16 v[108:111], a[196:199], a[36:39], v[108:111]
  v_mfma_f32_16x16x32_bf16 v[108:111], a[200:203], a[40:43], v[108:111]
  v_mfma_f32_16x16x32_bf16 v[108:111], a[204:207], a[44:47], v[108:111]
  v_mfma_f32_16x16x32_bf16 v[112:115], a[208:211], a[32:35], v[60:63]
  v_mfma_f32_16x16x32_bf16 v[112:115], a[212:215], a[36:39], v[112:115]
  v_mfma_f32_16x16x32_bf16 v[112:115], a[216:219], a[40:43], v[112:115]
  v_mfma_f32_16x16x32_bf16 v[112:115], a[220:223], a[44:47], v[112:115]
  s_nop 7
  v_exp_f32 v40, v108
  v_exp_f32 v41, v109
  v_exp_f32 v42, v110
  v_exp_f32 v43, v111
  v_exp_f32 v44, v112
  v_exp_f32 v45, v113
  v_exp_f32 v46, v114
  v_exp_f32 v47, v115
  s_nop 0
  v_cvt_pk_bf16_f32 v116, v40, v41
  v_cvt_pk_bf16_f32 v117, v42, v43
  v_cvt_pk_bf16_f32 v118, v44, v45
  v_cvt_pk_bf16_f32 v119, v46, v47
  s_nop 1
  v_mfma_f32_16x16x32_bf16 v[120:123], v[124:127], v[116:119], v[120:123]
  v_mfma_f32_16x16x32_bf16 v[192:195], a[224:227], v[116:119], v[192:195]
  v_mfma_f32_16x16x32_bf16 v[196:199], a[228:231], v[116:119], v[196:199]
  v_mfma_f32_16x16x32_bf16 v[200:203], a[232:235], v[116:119], v[200:203]
  v_mfma_f32_16x16x32_bf16 v[204:207], a[236:239], v[116:119], v[204:207]
  v_mfma_f32_16x16x32_bf16 v[208:211], a[240:243], v[116:119], v[208:211]
  v_mfma_f32_16x16x32_bf16 v[212:215], a[244:247], v[116:119], v[212:215]
  v_mfma_f32_16x16x32_bf16 v[216:219], a[248:251], v[116:119], v[216:219]
  v_mfma_f32_16x16x32_bf16 v[220:223], a[252:255], v[116:119], v[220:223]
  v_mfma_f32_16x16x32_bf16 v[108:111], a[192:195], a[48:51], v[64:67]
  v_mfma_f32_16x16x32_bf16 v[108:111], a[196:199], a[52:55], v[108:111]
  v_mfma_f32_16x16x32_bf16 v[108:111], a[200:203], a[56:59], v[108:111]
  v_mfma_f32_16x16x32_bf16 v[108:111], a[204:207], a[60:63], v[108:111]
  v_mfma_f32_16x16x32_bf16 v[112:115], a[208:211], a[48:51], v[64:67]
  v_mfma_f32_16x16x32_bf16 v[112:115], a[212:215], a[52:55], v[112:115]
  v_mfma_f32_16x16x32_bf16 v[112:115], a[216:219], a[56:59], v[112:115]
  v_mfma_f32_16x16x32_bf16 v[112:115], a[220:223], a[60:63], v[112:115]
  s_nop 7
  v_exp_f32 v40, v108
  v_exp_f32 v41, v109
  v_exp_f32 v42, v110
  v_exp_f32 v43, v111
  v_exp_f32 v44, v112
  v_exp_f32 v45, v113
  v_exp_f32 v46, v114
  v_exp_f32 v47, v115
  s_nop 0
  v_cvt_pk_bf16_f32 v116, v40, v41
  v_cvt_pk_bf16_f32 v117, v42, v43
  v_cvt_pk_bf16_f32 v118, v44, v45
  v_cvt_pk_bf16_f32 v119, v46, v47
  s_nop 1
  v_mfma_f32_16x16x32_bf16 v[120:123], v[8:11], v[116:119], v[120:123]
  v_mfma_f32_16x16x32_bf16 v[224:227], a[224:227], v[116:119], v[224:227]
  v_mfma_f32_16x16x32_bf16 v[228:231], a[228:231], v[116:119], v[228:231]
  v_mfma_f32_16x16x32_bf16 v[232:235], a[232:235], v[116:119], v[232:235]
  v_mfma_f32_16x16x32_bf16 v[236:239], a[236:239], v[116:119], v[236:239]
  v_mfma_f32_16x16x32_bf16 v[240:243], a[240:243], v[116:119], v[240:243]
  v_mfma_f32_16x16x32_bf16 v[244:247], a[244:247], v[116:119], v[244:247]
  v_mfma_f32_16x16x32_bf16 v[248:251], a[248:251], v[116:119], v[248:251]
  v_mfma_f32_16x16x32_bf16 v[252:255], a[252:255], v[116:119], v[252:255]
  s_add_u32 s60, s60, 8192
  s_cmp_lt_u32 s60, 524288
  s_cbranch_scc1 L_fix_acc
  s_mov_b64 s[76:77], -1
  s_nop 7
  s_branch L_tail
.section .rodata,"a"
.p2align 6
.amdhsa_kernel standalone__tree_speculative_verify_tree_attention_over_candidate_token_tree__prompt_kernel
  .amdhsa_next_free_vgpr 512
  .amdhsa_next_free_sgpr 102
  .amdhsa_accum_offset 256
  .amdhsa_group_segment_fixed_size 0
  .amdhsa_kernarg_size 72
  .amdhsa_user_sgpr_count 2
  .amdhsa_user_sgpr_kernarg_segment_ptr 1
  .amdhsa_system_sgpr_workgroup_id_x 1
.end_amdhsa_kernel
```
